```python
import torch

def _softmax(x, axis=-1):
    return torch.softmax(x, dim=axis)

def _gelu(x):
    return torch.nn.functional.gelu(x, approximate='tanh')

def _silu(x):
    return torch.nn.functional.silu(x)

def _sigmoid(x):
    return torch.sigmoid(x)

def _layernorm(x, axis=-1, eps=1e-05):
    m = x.mean(dim=axis, keepdim=True)
    v = x.var(dim=axis, keepdim=True, unbiased=False)
    return (x - m) / torch.sqrt(v + eps)

def _scatter_add(tgt, idx, src, axis=0):
    return tgt.clone().index_add_(axis, idx, src)

def _segment_sum(src, seg, n):
    out = torch.zeros((n,) + src.shape[1:], dtype=src.dtype)
    return out.index_add_(0, seg, src)

def _pad(x, pw):
    flat = tuple((v for pair in reversed(pw) for v in pair))
    return torch.nn.functional.pad(x, flat)
kernel_name = 'adaLN_cond__spectral_gfnet__glu_gated_swiglu__prompt'

def setup_inputs():

    _w = lambda a: (lambda t: t.to(torch.bfloat16) if t.is_floating_point() else t)(torch.as_tensor(a))

    def _A_setup():
        B, S, D = (1, 2048, 640)
        Df = D // 2 + 1
        return {'x': _w((lambda *s: torch.randn(*s, dtype=torch.bfloat16) * 0.05)(B, S, D)), 'w_r': _w((lambda *s: torch.randn(*s, dtype=torch.bfloat16) * 1.6)(S, Df) * 0.02), 'w_i': _w((lambda *s: torch.randn(*s, dtype=torch.bfloat16) * 1.6)(S, Df) * 0.02)}
    _A_in = _A_setup()

    def _B_setup():
        B, S, D, F = (1, 2048, 640, 1728)
        return {'x': _w((lambda *s: torch.randn(*s, dtype=torch.bfloat16) * 0.05)(B, S, D)), 'w1': _w((lambda *s: torch.randn(*s, dtype=torch.bfloat16) * 0.4)(D, F) * (2.0 / D) ** 0.5), 'w3': _w((lambda *s: torch.randn(*s, dtype=torch.bfloat16) * 0.4)(D, F) * (2.0 / D) ** 0.5), 'w2': _w((lambda *s: torch.randn(*s, dtype=torch.bfloat16) * 0.4)(F, D) * (2.0 / F) ** 0.5)}
    _B_in = _B_setup()
    return {'A_x': _A_in['x'], 'A_w_r': _A_in['w_r'], 'A_w_i': _A_in['w_i'], 'B_x': _B_in['x'], 'B_w1': _B_in['w1'], 'B_w3': _B_in['w3'], 'B_w2': _B_in['w2'], 'c': _w((lambda *s: torch.randn(*s, dtype=torch.bfloat16) * 0.1)(1, 640) * 8.0), 'w_mod': _w((lambda *s: torch.randn(*s, dtype=torch.bfloat16) * 0.1)(640, 6 * 640) * 640 ** (-0.5) * 8.0)}

def reference(A_x, A_w_r, A_w_i, B_x, B_w1, B_w3, B_w2, c, w_mod):

    def _A_ref(x, w_r, w_i):
        B, S, D = x.shape
        X = (lambda x, axes=(-2, -1): torch.fft.rfft2(x.float(), dim=axes))(x, axes=(-2, -1))
        W = w_r + 1j * w_i
        X = X * W
        y = (lambda x, s, axes=(-2, -1): torch.fft.irfft2(x, s=s, dim=axes).to(torch.bfloat16))(X, (S, D), axes=(-2, -1))
        return y

    def _B_ref(x, w1, w3, w2):
        gate = torch.einsum('bsd,df->bsf', x, w1)
        up = torch.einsum('bsd,df->bsf', x, w3)
        h = _silu(gate) * up
        out = torch.einsum('bsf,fd->bsd', h, w2)
        return out
    x = A_x
    mod = (_silu(c) @ w_mod).reshape(c.shape[0], 6, 1, -1)
    sa, ca, ga, sb, cb, gb = (mod[:, 0].clone(), mod[:, 1].clone(), mod[:, 2].clone(), mod[:, 3].clone(), mod[:, 4].clone(), mod[:, 5].clone())
    h = _layernorm(x, axis=-1) * (1 + ca) + sa
    x = x + ga * _A_ref(h, A_w_r, A_w_i)
    h = _layernorm(x, axis=-1) * (1 + cb) + sb
    x = x + gb * _B_ref(h, B_w1, B_w3, B_w2)
    return x
```

```asm
; @launch grid=(256,1,1) block=(256,1,1) lds=157056
.amdgcn_target "amdgcn-amd-amdhsa--gfx950"
.text
.globl adaLN_cond__spectral_gfnet__glu_gated_swiglu__prompt_kernel
.p2align 8
.type adaLN_cond__spectral_gfnet__glu_gated_swiglu__prompt_kernel,@function
adaLN_cond__spectral_gfnet__glu_gated_swiglu__prompt_kernel:
s_cmp_ge_u32 s2, 256
s_cbranch_scc1 all_end
s_load_dwordx2 s[4:5], s[0:1], 88
s_load_dwordx4 s[28:31], s[0:1], 56
s_load_dwordx2 s[6:7], s[0:1], 0
s_load_dwordx4 s[16:19], s[0:1], 8
s_load_dwordx4 s[20:23], s[0:1], 32
s_load_dwordx2 s[24:25], s[0:1], 48
s_load_dwordx2 s[8:9], s[0:1], 72
s_mov_b32 s53, 0
v_and_b32 v1, 63, v0
v_and_b32 v2, 31, v0
v_lshrrev_b32 v3, 5, v1
v_lshrrev_b32 v4, 6, v0
    s_nop 0
v_readfirstlane_b32 s3, v4
s_and_b32 s48, s2, 7
s_lshr_b32 s49, s2, 3
s_mul_i32 s26, s48, 10
s_add_u32 s26, s26, s49
s_mul_i32 s27, s48, 20
s_add_u32 s27, s27, s49
s_add_u32 s27, s27, 70
s_cmp_lt_u32 s49, 10
s_cselect_b32 s54, s26, s27
s_lshl_b32 s26, s54, 5
s_cmp_lt_u32 s49, 30
s_cselect_b32 s26, s26, 0x40000000
v_lshrrev_b32 v4, 1, v0
v_and_b32 v5, 1, v0
v_mul_u32_u24 v56, 7680, v4
v_lshl_add_u32 v56, v5, 4, v56
v_add_u32 v56, s26, v56
v_lshlrev_b32 v57, 1, v4
s_lshl_b32 s80, s48, 3
s_and_b32 s26, s49, 7
s_add_u32 s80, s80, s26
s_lshr_b32 s26, s2, 7
s_lshl_b32 s26, s26, 4
s_bfe_u32 s27, s2, 0x10006
s_lshl_b32 s27, s27, 2
s_add_u32 s26, s26, s27
s_lshr_b32 s27, s3, 1
s_lshl_b32 s27, s27, 3
s_add_u32 s26, s26, s27
s_and_b32 s27, s3, 1
s_lshl_b32 s27, s27, 1
s_add_u32 s26, s26, s27
s_lshl_b32 s26, s26, 6
s_add_u32 s26, s26, s80
s_mul_i32 s26, s26, 1280
v_mul_u32_u24 v58, 81920, v3
v_lshl_add_u32 v58, v2, 3, v58
v_add_u32 v58, s26, v58
s_lshr_b32 s26, s2, 6
s_lshl_b32 s26, s26, 6
s_add_u32 s80, s80, s26
s_mul_i32 s80, s80, 10368
s_waitcnt lgkmcnt(0)
s_cmp_ge_u32 s49, 30
s_cbranch_scc1 filler_1
s_mov_b32 s32, s28
s_mov_b32 s33, s29
s_mov_b32 s34, 0x500
s_mov_b32 s35, 0x20000
s_mov_b32 s36, s30
s_mov_b32 s37, s31
s_mov_b32 s38, 0x4b0000
s_mov_b32 s39, 0x20000
buffer_load_ushort v20, v57, s[32:35], 0 offen offset:0
buffer_load_ushort v21, v57, s[32:35], 0 offen offset:256
buffer_load_ushort v22, v57, s[32:35], 0 offen offset:512
buffer_load_ushort v23, v57, s[32:35], 0 offen offset:768
buffer_load_ushort v24, v57, s[32:35], 0 offen offset:1024
buffer_load_dwordx4 v[28:31], v56, s[36:39], 0 offen
s_mov_b32 s26, 983040
buffer_load_dwordx4 v[32:35], v56, s[36:39], s26 offen
s_mov_b32 s26, 1966080
buffer_load_dwordx4 v[36:39], v56, s[36:39], s26 offen
s_mov_b32 s26, 2949120
buffer_load_dwordx4 v[40:43], v56, s[36:39], s26 offen
s_mov_b32 s26, 3932160
buffer_load_dwordx4 v[44:47], v56, s[36:39], s26 offen
s_load_dword s55, s[4:5], 0x80000
s_lshl_b32 s26, s49, 2
s_add_u32 s26, s26, s3
s_mul_i32 s27, s26, 4370
s_lshr_b32 s27, s27, 16
s_mul_i32 s50, s27, 15
s_sub_u32 s26, s26, s50
s_mul_i32 s26, s26, 22
s_min_u32 s26, s26, 299
s_lshl_b32 s50, s48, 3
s_add_u32 s27, s27, s50
s_lshr_b32 s50, s27, 2
s_and_b32 s27, s27, 3
v_and_b32 v4, 7, v1
v_bfe_u32 v5, v1, 3, 2
v_lshl_add_u32 v6, v5, 5, v4
s_lshl_b32 s51, s50, 7
s_lshl_b32 s52, s27, 3
s_add_u32 s51, s51, s52
v_add_u32 v6, s51, v6
v_mul_u32_u24 v228, 642, v6
v_mul_u32_u24 v7, 20, v3
v_add_u32 v228, v228, v7
s_lshl_b32 s51, s26, 1
s_cmp_lt_u32 s49, 30
s_cselect_b32 s51, s51, 0x40000000
v_add_u32 v228, s51, v228
s_mul_i32 s51, s3, 2816
s_add_u32 s51, s51, 33024
v_mul_u32_u24 v229, 1280, v3
v_lshl_add_u32 v229, v4, 4, v229
v_lshl_add_u32 v229, v5, 2, v229
v_add_u32 v229, s51, v229
v_lshl_add_u32 v230, v1, 4, s51
s_lshl_b32 s26, s26, 13
s_lshl_b32 s50, s50, 9
s_add_u32 s26, s26, s50
s_lshl_b32 s27, s27, 7
s_add_u32 s26, s26, s27
s_cmp_lt_u32 s49, 30
s_cselect_b32 s26, s26, 0x40000000
v_lshrrev_b32 v5, 3, v1
v_lshlrev_b32 v231, 13, v5
v_lshl_add_u32 v231, v4, 4, v231
v_add_u32 v231, s26, v231
s_waitcnt lgkmcnt(0)
s_add_u32 s55, s55, 0x9e3779b9
s_add_u32 s12, s4, 0xb0000
s_addc_u32 s13, s5, 0
s_mov_b32 s14, 0x30000
s_mov_b32 s15, 0x20000
v_cvt_f32_u32 v7, v2
v_cvt_f32_u32 v19, v3
v_mul_f32 v212, 0x3d000000, v7
v_mul_f32 v213, v212, v19
v_mul_f32 v213, 0x41000000, v213
v_fmamk_f32 v214, v212, 0x0, v213
v_cos_f32 v60, v214
v_sin_f32 v62, -v214
v_fmamk_f32 v214, v212, 0x3f800000, v213
v_cos_f32 v61, v214
v_sin_f32 v63, -v214
v_cvt_pk_bf16_f32 v80, v60, v61
v_cvt_pk_bf16_f32 v88, v62, v63
s_mov_b32 s40, s6
s_mov_b32 s41, s7
s_mov_b32 s42, 0x280000
s_mov_b32 s43, 0x20000
buffer_load_dwordx2 v[8:9], v58, s[40:43], 0 offen offset:0
buffer_load_dwordx2 v[10:11], v58, s[40:43], 0 offen offset:256
buffer_load_dwordx2 v[12:13], v58, s[40:43], 0 offen offset:512
buffer_load_dwordx2 v[14:15], v58, s[40:43], 0 offen offset:768
buffer_load_dwordx2 v[16:17], v58, s[40:43], 0 offen offset:1024
v_fmamk_f32 v214, v212, 0x40000000, v213
v_cos_f32 v60, v214
v_sin_f32 v62, -v214
v_fmamk_f32 v214, v212, 0x40400000, v213
v_cos_f32 v61, v214
v_sin_f32 v63, -v214
v_cvt_pk_bf16_f32 v81, v60, v61
v_cvt_pk_bf16_f32 v89, v62, v63
v_fmamk_f32 v214, v212, 0x40800000, v213
v_cos_f32 v60, v214
v_sin_f32 v62, -v214
v_fmamk_f32 v214, v212, 0x40a00000, v213
v_cos_f32 v61, v214
v_sin_f32 v63, -v214
v_cvt_pk_bf16_f32 v82, v60, v61
v_cvt_pk_bf16_f32 v90, v62, v63
v_fmamk_f32 v214, v212, 0x40c00000, v213
v_cos_f32 v60, v214
v_sin_f32 v62, -v214
v_fmamk_f32 v214, v212, 0x40e00000, v213
v_cos_f32 v61, v214
v_sin_f32 v63, -v214
v_cvt_pk_bf16_f32 v83, v60, v61
v_cvt_pk_bf16_f32 v91, v62, v63
v_fmamk_f32 v214, v212, 0x41800000, v213
v_cos_f32 v60, v214
v_sin_f32 v62, -v214
v_fmamk_f32 v214, v212, 0x41880000, v213
v_cos_f32 v61, v214
v_sin_f32 v63, -v214
v_cvt_pk_bf16_f32 v84, v60, v61
v_cvt_pk_bf16_f32 v92, v62, v63
v_fmamk_f32 v214, v212, 0x41900000, v213
v_cos_f32 v60, v214
v_sin_f32 v62, -v214
v_fmamk_f32 v214, v212, 0x41980000, v213
v_cos_f32 v61, v214
v_sin_f32 v63, -v214
v_cvt_pk_bf16_f32 v85, v60, v61
v_cvt_pk_bf16_f32 v93, v62, v63
v_fmamk_f32 v214, v212, 0x41a00000, v213
v_cos_f32 v60, v214
v_sin_f32 v62, -v214
v_fmamk_f32 v214, v212, 0x41a80000, v213
v_cos_f32 v61, v214
v_sin_f32 v63, -v214
v_cvt_pk_bf16_f32 v86, v60, v61
v_cvt_pk_bf16_f32 v94, v62, v63
v_fmamk_f32 v214, v212, 0x41b00000, v213
v_cos_f32 v60, v214
v_sin_f32 v62, -v214
v_fmamk_f32 v214, v212, 0x41b80000, v213
v_cos_f32 v61, v214
v_sin_f32 v63, -v214
v_cvt_pk_bf16_f32 v87, v60, v61
v_cvt_pk_bf16_f32 v95, v62, v63
v_mul_f32 v212, 0x3acccccd, v7
v_mul_f32 v213, v212, v19
v_mul_f32 v213, 4.0, v213
v_fmamk_f32 v214, v212, 0x0, v213
v_cos_f32 v96, v214
v_sin_f32 v108, v214
v_fmamk_f32 v214, v212, 0x3f800000, v213
v_cos_f32 v97, v214
v_sin_f32 v109, v214
v_fmamk_f32 v214, v212, 0x40000000, v213
v_cos_f32 v98, v214
v_sin_f32 v110, v214
v_fmamk_f32 v214, v212, 0x40400000, v213
v_cos_f32 v99, v214
v_sin_f32 v111, v214
v_fmamk_f32 v214, v212, 0x41000000, v213
v_cos_f32 v100, v214
v_sin_f32 v112, v214
v_fmamk_f32 v214, v212, 0x41100000, v213
v_cos_f32 v101, v214
v_sin_f32 v113, v214
v_fmamk_f32 v214, v212, 0x41200000, v213
v_cos_f32 v102, v214
v_sin_f32 v114, v214
v_fmamk_f32 v214, v212, 0x41300000, v213
v_cos_f32 v103, v214
v_sin_f32 v115, v214
v_fmamk_f32 v214, v212, 0x41800000, v213
v_cos_f32 v104, v214
v_sin_f32 v116, v214
v_fmamk_f32 v214, v212, 0x41880000, v213
v_cos_f32 v105, v214
v_sin_f32 v117, v214
v_fmamk_f32 v214, v212, 0x41900000, v213
v_cos_f32 v106, v214
v_sin_f32 v118, v214
v_fmamk_f32 v214, v212, 0x41980000, v213
v_cos_f32 v107, v214
v_sin_f32 v119, v214
v_and_b32 v60, 15, v2
v_cvt_f32_u32 v60, v60
v_lshrrev_b32 v61, 4, v2
v_cvt_f32_u32 v61, v61
v_mul_f32 v212, 0x3d4ccccd, v60
v_mul_f32 v213, v212, v19
v_mul_f32 v213, 4.0, v213
v_fmamk_f32 v213, v61, 0x3e800000, v213
v_add_f32 v215, 0xbe800000, v213
v_fmamk_f32 v214, v212, 0x0, v213
v_cos_f32 v62, v214
v_fmamk_f32 v214, v212, 0x3f800000, v213
v_cos_f32 v63, v214
    s_nop 0
v_cvt_pk_bf16_f32 v120, v62, v63
v_fmamk_f32 v214, v212, 0x0, v215
v_cos_f32 v62, v214
v_fmamk_f32 v214, v212, 0x3f800000, v215
v_cos_f32 v63, v214
    s_nop 0
v_cvt_pk_bf16_f32 v124, v62, v63
v_fmamk_f32 v214, v212, 0x40000000, v213
v_cos_f32 v62, v214
v_fmamk_f32 v214, v212, 0x40400000, v213
v_cos_f32 v63, v214
    s_nop 0
v_cvt_pk_bf16_f32 v121, v62, v63
v_fmamk_f32 v214, v212, 0x40000000, v215
v_cos_f32 v62, v214
v_fmamk_f32 v214, v212, 0x40400000, v215
v_cos_f32 v63, v214
    s_nop 0
v_cvt_pk_bf16_f32 v125, v62, v63
v_fmamk_f32 v214, v212, 0x41000000, v213
v_cos_f32 v62, v214
v_fmamk_f32 v214, v212, 0x41100000, v213
v_cos_f32 v63, v214
    s_nop 0
v_cvt_pk_bf16_f32 v122, v62, v63
v_fmamk_f32 v214, v212, 0x41000000, v215
v_cos_f32 v62, v214
v_fmamk_f32 v214, v212, 0x41100000, v215
v_cos_f32 v63, v214
    s_nop 0
v_cvt_pk_bf16_f32 v126, v62, v63
v_fmamk_f32 v214, v212, 0x41200000, v213
v_cos_f32 v62, v214
v_fmamk_f32 v214, v212, 0x41300000, v213
v_cos_f32 v63, v214
    s_nop 0
v_cvt_pk_bf16_f32 v123, v62, v63
v_fmamk_f32 v214, v212, 0x41200000, v215
v_cos_f32 v62, v214
v_fmamk_f32 v214, v212, 0x41300000, v215
v_cos_f32 v63, v214
    s_nop 0
v_cvt_pk_bf16_f32 v127, v62, v63
v_fmamk_f32 v214, v212, 0x41800000, v213
v_cos_f32 v62, v214
v_fmamk_f32 v214, v212, 0x41880000, v213
v_cos_f32 v63, v214
    s_nop 0
v_cvt_pk_bf16_f32 v128, v62, v63
v_fmamk_f32 v214, v212, 0x41800000, v215
v_cos_f32 v62, v214
v_fmamk_f32 v214, v212, 0x41880000, v215
v_cos_f32 v63, v214
    s_nop 0
v_cvt_pk_bf16_f32 v130, v62, v63
v_fmamk_f32 v214, v212, 0x41900000, v213
v_cos_f32 v62, v214
v_fmamk_f32 v214, v212, 0x41980000, v213
v_cos_f32 v63, v214
    s_nop 0
v_cvt_pk_bf16_f32 v129, v62, v63
v_fmamk_f32 v214, v212, 0x41900000, v215
v_cos_f32 v62, v214
v_fmamk_f32 v214, v212, 0x41980000, v215
v_cos_f32 v63, v214
    s_nop 0
v_cvt_pk_bf16_f32 v131, v62, v63
v_cmp_eq_u32 vcc, 0, v3
    s_nop 1
v_cndmask_b32 v128, 0, v128, vcc
v_cndmask_b32 v129, 0, v129, vcc
v_cndmask_b32 v130, 0, v130, vcc
v_cndmask_b32 v131, 0, v131, vcc
s_mov_b32 s32, s16
s_mov_b32 s33, s17
s_mov_b32 s34, 0x141000
s_mov_b32 s35, 0x20000
s_mov_b32 s36, s18
s_mov_b32 s37, s19
s_mov_b32 s38, 0x141000
s_mov_b32 s39, 0x20000
buffer_load_dwordx4 v[216:219], v228, s[32:35], 0 offen
buffer_load_dwordx2 v[220:221], v228, s[32:35], 0 offen offset:16
buffer_load_dwordx4 v[222:225], v228, s[36:39], 0 offen
buffer_load_dwordx2 v[226:227], v228, s[36:39], 0 offen offset:16
s_waitcnt vmcnt(14)
v_lshlrev_b32 v20, 16, v20
v_mul_f32 v26, 0xbfb8aa3b, v20
v_exp_f32 v26, v26
    s_nop 0
v_add_f32 v26, 1.0, v26
v_rcp_f32 v26, v26
    s_nop 0
v_mul_f32 v20, v20, v26
v_cvt_pk_bf16_f32 v20, v20, v20
v_lshlrev_b32 v20, 16, v20
v_lshlrev_b32 v21, 16, v21
v_mul_f32 v26, 0xbfb8aa3b, v21
v_exp_f32 v26, v26
    s_nop 0
v_add_f32 v26, 1.0, v26
v_rcp_f32 v26, v26
    s_nop 0
v_mul_f32 v21, v21, v26
v_cvt_pk_bf16_f32 v21, v21, v21
v_lshlrev_b32 v21, 16, v21
v_lshlrev_b32 v22, 16, v22
v_mul_f32 v26, 0xbfb8aa3b, v22
v_exp_f32 v26, v26
    s_nop 0
v_add_f32 v26, 1.0, v26
v_rcp_f32 v26, v26
    s_nop 0
v_mul_f32 v22, v22, v26
v_cvt_pk_bf16_f32 v22, v22, v22
v_lshlrev_b32 v22, 16, v22
v_lshlrev_b32 v23, 16, v23
v_mul_f32 v26, 0xbfb8aa3b, v23
v_exp_f32 v26, v26
    s_nop 0
v_add_f32 v26, 1.0, v26
v_rcp_f32 v26, v26
    s_nop 0
v_mul_f32 v23, v23, v26
v_cvt_pk_bf16_f32 v23, v23, v23
v_lshlrev_b32 v23, 16, v23
v_lshlrev_b32 v24, 16, v24
v_mul_f32 v26, 0xbfb8aa3b, v24
v_exp_f32 v26, v26
    s_nop 0
v_add_f32 v26, 1.0, v26
v_rcp_f32 v26, v26
    s_nop 0
v_mul_f32 v24, v24, v26
v_cvt_pk_bf16_f32 v24, v24, v24
v_lshlrev_b32 v24, 16, v24
s_waitcnt vmcnt(13)
v_lshlrev_b32 v26, 16, v28
v_and_b32 v27, 0xffff0000, v28
v_mul_f32 v48, v20, v26
v_mul_f32 v49, v20, v27
v_lshlrev_b32 v26, 16, v29
v_and_b32 v27, 0xffff0000, v29
v_mul_f32 v50, v20, v26
v_mul_f32 v51, v20, v27
v_lshlrev_b32 v26, 16, v30
v_and_b32 v27, 0xffff0000, v30
v_mul_f32 v52, v20, v26
v_mul_f32 v53, v20, v27
v_lshlrev_b32 v26, 16, v31
v_and_b32 v27, 0xffff0000, v31
v_mul_f32 v54, v20, v26
v_mul_f32 v55, v20, v27
s_waitcnt vmcnt(12)
v_lshlrev_b32 v26, 16, v32
v_and_b32 v27, 0xffff0000, v32
v_fmac_f32 v48, v21, v26
v_fmac_f32 v49, v21, v27
v_lshlrev_b32 v26, 16, v33
v_and_b32 v27, 0xffff0000, v33
v_fmac_f32 v50, v21, v26
v_fmac_f32 v51, v21, v27
v_lshlrev_b32 v26, 16, v34
v_and_b32 v27, 0xffff0000, v34
v_fmac_f32 v52, v21, v26
v_fmac_f32 v53, v21, v27
v_lshlrev_b32 v26, 16, v35
v_and_b32 v27, 0xffff0000, v35
v_fmac_f32 v54, v21, v26
v_fmac_f32 v55, v21, v27
s_waitcnt vmcnt(11)
v_lshlrev_b32 v26, 16, v36
v_and_b32 v27, 0xffff0000, v36
v_fmac_f32 v48, v22, v26
v_fmac_f32 v49, v22, v27
v_lshlrev_b32 v26, 16, v37
v_and_b32 v27, 0xffff0000, v37
v_fmac_f32 v50, v22, v26
v_fmac_f32 v51, v22, v27
v_lshlrev_b32 v26, 16, v38
v_and_b32 v27, 0xffff0000, v38
v_fmac_f32 v52, v22, v26
v_fmac_f32 v53, v22, v27
v_lshlrev_b32 v26, 16, v39
v_and_b32 v27, 0xffff0000, v39
v_fmac_f32 v54, v22, v26
v_fmac_f32 v55, v22, v27
s_waitcnt vmcnt(10)
v_lshlrev_b32 v26, 16, v40
v_and_b32 v27, 0xffff0000, v40
v_fmac_f32 v48, v23, v26
v_fmac_f32 v49, v23, v27
v_lshlrev_b32 v26, 16, v41
v_and_b32 v27, 0xffff0000, v41
v_fmac_f32 v50, v23, v26
v_fmac_f32 v51, v23, v27
v_lshlrev_b32 v26, 16, v42
v_and_b32 v27, 0xffff0000, v42
v_fmac_f32 v52, v23, v26
v_fmac_f32 v53, v23, v27
v_lshlrev_b32 v26, 16, v43
v_and_b32 v27, 0xffff0000, v43
v_fmac_f32 v54, v23, v26
v_fmac_f32 v55, v23, v27
s_waitcnt vmcnt(9)
v_lshlrev_b32 v26, 16, v44
v_and_b32 v27, 0xffff0000, v44
v_fmac_f32 v48, v24, v26
v_fmac_f32 v49, v24, v27
v_lshlrev_b32 v26, 16, v45
v_and_b32 v27, 0xffff0000, v45
v_fmac_f32 v50, v24, v26
v_fmac_f32 v51, v24, v27
v_lshlrev_b32 v26, 16, v46
v_and_b32 v27, 0xffff0000, v46
v_fmac_f32 v52, v24, v26
v_fmac_f32 v53, v24, v27
v_lshlrev_b32 v26, 16, v47
v_and_b32 v27, 0xffff0000, v47
v_fmac_f32 v54, v24, v26
v_fmac_f32 v55, v24, v27
v_add_f32_dpp v48, v48, v48 quad_perm:[2,3,0,1] row_mask:0xf bank_mask:0xf
v_add_f32_dpp v49, v49, v49 quad_perm:[2,3,0,1] row_mask:0xf bank_mask:0xf
v_add_f32_dpp v50, v50, v50 quad_perm:[2,3,0,1] row_mask:0xf bank_mask:0xf
v_add_f32_dpp v51, v51, v51 quad_perm:[2,3,0,1] row_mask:0xf bank_mask:0xf
v_add_f32_dpp v52, v52, v52 quad_perm:[2,3,0,1] row_mask:0xf bank_mask:0xf
v_add_f32_dpp v53, v53, v53 quad_perm:[2,3,0,1] row_mask:0xf bank_mask:0xf
v_add_f32_dpp v54, v54, v54 quad_perm:[2,3,0,1] row_mask:0xf bank_mask:0xf
v_add_f32_dpp v55, v55, v55 quad_perm:[2,3,0,1] row_mask:0xf bank_mask:0xf
v_add_f32_dpp v48, v48, v48 row_ror:4 row_mask:0xf bank_mask:0xf
v_add_f32_dpp v49, v49, v49 row_ror:4 row_mask:0xf bank_mask:0xf
v_add_f32_dpp v50, v50, v50 row_ror:4 row_mask:0xf bank_mask:0xf
v_add_f32_dpp v51, v51, v51 row_ror:4 row_mask:0xf bank_mask:0xf
v_add_f32_dpp v52, v52, v52 row_ror:4 row_mask:0xf bank_mask:0xf
v_add_f32_dpp v53, v53, v53 row_ror:4 row_mask:0xf bank_mask:0xf
v_add_f32_dpp v54, v54, v54 row_ror:4 row_mask:0xf bank_mask:0xf
v_add_f32_dpp v55, v55, v55 row_ror:4 row_mask:0xf bank_mask:0xf
v_add_f32_dpp v48, v48, v48 row_ror:8 row_mask:0xf bank_mask:0xf
v_add_f32_dpp v49, v49, v49 row_ror:8 row_mask:0xf bank_mask:0xf
v_add_f32_dpp v50, v50, v50 row_ror:8 row_mask:0xf bank_mask:0xf
v_add_f32_dpp v51, v51, v51 row_ror:8 row_mask:0xf bank_mask:0xf
v_add_f32_dpp v52, v52, v52 row_ror:8 row_mask:0xf bank_mask:0xf
v_add_f32_dpp v53, v53, v53 row_ror:8 row_mask:0xf bank_mask:0xf
v_add_f32_dpp v54, v54, v54 row_ror:8 row_mask:0xf bank_mask:0xf
v_add_f32_dpp v55, v55, v55 row_ror:8 row_mask:0xf bank_mask:0xf
v_lshrrev_b32 v5, 4, v0
v_lshlrev_b32 v5, 6, v5
v_and_b32 v6, 1, v0
v_lshl_add_u32 v5, v6, 5, v5
v_and_b32 v6, 14, v0
v_cmp_eq_u32 vcc, 0, v6
s_and_saveexec_b64 s[26:27], vcc
ds_write_b128 v5, v[48:51] offset:26880
ds_write_b128 v5, v[52:55] offset:26896
s_mov_b64 exec, -1
s_waitcnt lgkmcnt(0)
s_barrier
s_cmp_lg_u32 s3, 0
s_cbranch_scc1 modfin_3
v_and_b32 v6, 15, v0
v_lshrrev_b32 v5, 4, v0
v_lshlrev_b32 v5, 8, v5
v_lshl_add_u32 v5, v6, 2, v5
v_add_u32 v5, 26880, v5
ds_read2_b32 v[20:21], v5 offset0:0 offset1:16
ds_read2_b32 v[22:23], v5 offset0:32 offset1:48
s_waitcnt lgkmcnt(0)
v_add_f32 v20, v20, v21
v_add_f32 v22, v22, v23
v_add_f32 v20, v20, v22
v_mov_b32 v21, v20
    s_nop 1
v_permlane16_swap_b32 v20, v21
v_add_f32 v20, v20, v21
v_mov_b32 v21, v20
    s_nop 1
v_permlane32_swap_b32 v20, v21
v_add_f32 v20, v20, v21
v_cvt_pk_bf16_f32 v20, v20, v20
v_lshlrev_b32 v20, 16, v20
s_cmp_ge_u32 s54, 160
s_cselect_b32 s26, 120, 0
s_sub_u32 s26, s54, s26
s_sub_u32 s26, s26, 40
v_add_f32 v21, 1.0, v20
v_cvt_pk_bf16_f32 v21, v21, v21
v_lshlrev_b32 v21, 16, v21
s_cmp_lt_u32 s26, 40
s_cselect_b64 vcc, -1, 0
v_cndmask_b32 v20, v20, v21, vcc
v_mov_b32 v21, s55
s_lshl_b32 s26, s54, 7
s_cmp_lt_u32 s54, 80
s_cselect_b32 s26, s26, 0x40000000
v_lshl_add_u32 v22, v6, 3, s26
s_lshl_b32 s26, s54, 6
s_cmp_ge_u32 s54, 80
s_cselect_b32 s26, s26, 0x40000000
s_cmp_lt_u32 s49, 30
s_cselect_b32 s26, s26, 0x40000000
v_lshl_add_u32 v23, v6, 2, s26
s_add_u32 s32, s4, 0xa0000
s_addc_u32 s33, s5, 0
s_mov_b32 s34, 0x2800
s_mov_b32 s35, 0x20000
s_mov_b32 s36, s4
s_mov_b32 s37, s5
s_mov_b32 s38, 0x3c00
s_mov_b32 s39, 0x20000
s_mov_b64 exec, 0xffff
buffer_store_dwordx2 v[20:21], v22, s[32:35], 0 offen sc0 sc1
buffer_store_dword v20, v23, s[36:39], 0 offen sc0 sc1
s_mov_b64 exec, -1
modfin_3:
s_waitcnt vmcnt(4)
v_lshlrev_b32 v60, 16, v8
v_and_b32 v61, 0xffff0000, v8
v_lshlrev_b32 v62, 16, v9
v_and_b32 v63, 0xffff0000, v9
v_lshlrev_b32 v64, 16, v10
v_and_b32 v65, 0xffff0000, v10
v_lshlrev_b32 v66, 16, v11
v_and_b32 v67, 0xffff0000, v11
v_lshlrev_b32 v68, 16, v12
v_and_b32 v69, 0xffff0000, v12
v_lshlrev_b32 v70, 16, v13
v_and_b32 v71, 0xffff0000, v13
v_lshlrev_b32 v72, 16, v14
v_and_b32 v73, 0xffff0000, v14
v_lshlrev_b32 v74, 16, v15
v_and_b32 v75, 0xffff0000, v15
v_lshlrev_b32 v76, 16, v16
v_and_b32 v77, 0xffff0000, v16
v_lshlrev_b32 v78, 16, v17
v_and_b32 v79, 0xffff0000, v17
v_add_f32 v212, v60, v61
v_add_f32 v213, v62, v63
v_add_f32 v212, v212, v64
v_add_f32 v213, v213, v65
v_add_f32 v212, v212, v66
v_add_f32 v213, v213, v67
v_add_f32 v212, v212, v68
v_add_f32 v213, v213, v69
v_add_f32 v212, v212, v70
v_add_f32 v213, v213, v71
v_add_f32 v212, v212, v72
v_add_f32 v213, v213, v73
v_add_f32 v212, v212, v74
v_add_f32 v213, v213, v75
v_add_f32 v212, v212, v76
v_add_f32 v213, v213, v77
v_add_f32 v212, v212, v78
v_add_f32 v213, v213, v79
v_add_f32 v212, v212, v213
    s_nop 1
v_add_f32_dpp v212, v212, v212 quad_perm:[1,0,3,2] row_mask:0xf bank_mask:0xf
    s_nop 1
v_add_f32_dpp v212, v212, v212 quad_perm:[2,3,0,1] row_mask:0xf bank_mask:0xf
    s_nop 1
v_add_f32_dpp v212, v212, v212 row_ror:4 row_mask:0xf bank_mask:0xf
    s_nop 1
v_add_f32_dpp v212, v212, v212 row_ror:8 row_mask:0xf bank_mask:0xf
v_mov_b32 v213, v212
    s_nop 1
v_permlane16_swap_b32 v212, v213
v_add_f32 v212, v212, v213
v_mul_f32 v212, 0x3acccccd, v212
v_sub_f32 v60, v60, v212
v_sub_f32 v61, v61, v212
v_sub_f32 v62, v62, v212
v_sub_f32 v63, v63, v212
v_sub_f32 v64, v64, v212
v_sub_f32 v65, v65, v212
v_sub_f32 v66, v66, v212
v_sub_f32 v67, v67, v212
v_sub_f32 v68, v68, v212
v_sub_f32 v69, v69, v212
v_sub_f32 v70, v70, v212
v_sub_f32 v71, v71, v212
v_sub_f32 v72, v72, v212
v_sub_f32 v73, v73, v212
v_sub_f32 v74, v74, v212
v_sub_f32 v75, v75, v212
v_sub_f32 v76, v76, v212
v_sub_f32 v77, v77, v212
v_sub_f32 v78, v78, v212
v_sub_f32 v79, v79, v212
v_mul_f32 v212, v60, v60
v_mul_f32 v213, v61, v61
v_fmac_f32 v212, v62, v62
v_fmac_f32 v213, v63, v63
v_fmac_f32 v212, v64, v64
v_fmac_f32 v213, v65, v65
v_fmac_f32 v212, v66, v66
v_fmac_f32 v213, v67, v67
v_fmac_f32 v212, v68, v68
v_fmac_f32 v213, v69, v69
v_fmac_f32 v212, v70, v70
v_fmac_f32 v213, v71, v71
v_fmac_f32 v212, v72, v72
v_fmac_f32 v213, v73, v73
v_fmac_f32 v212, v74, v74
v_fmac_f32 v213, v75, v75
v_fmac_f32 v212, v76, v76
v_fmac_f32 v213, v77, v77
v_fmac_f32 v212, v78, v78
v_fmac_f32 v213, v79, v79
v_add_f32 v212, v212, v213
    s_nop 1
v_add_f32_dpp v212, v212, v212 quad_perm:[1,0,3,2] row_mask:0xf bank_mask:0xf
    s_nop 1
v_add_f32_dpp v212, v212, v212 quad_perm:[2,3,0,1] row_mask:0xf bank_mask:0xf
    s_nop 1
v_add_f32_dpp v212, v212, v212 row_ror:4 row_mask:0xf bank_mask:0xf
    s_nop 1
v_add_f32_dpp v212, v212, v212 row_ror:8 row_mask:0xf bank_mask:0xf
v_mov_b32 v213, v212
    s_nop 1
v_permlane16_swap_b32 v212, v213
v_add_f32 v212, v212, v213
v_mov_b32 v213, 0x3727c5ac
v_fmac_f32 v213, 0x3acccccd, v212
v_rsq_f32 v212, v213
s_waitcnt vmcnt(0)
ds_write_b16 v229, v216 offset:0
ds_write_b16_d16_hi v229, v216 offset:128
ds_write_b16 v229, v217 offset:256
ds_write_b16_d16_hi v229, v217 offset:384
ds_write_b16 v229, v218 offset:512
ds_write_b16_d16_hi v229, v218 offset:640
ds_write_b16 v229, v219 offset:768
ds_write_b16_d16_hi v229, v219 offset:896
ds_write_b16 v229, v220 offset:1024
ds_write_b16_d16_hi v229, v220 offset:1152
ds_write_b16 v229, v221 offset:1280
ds_write_b16_d16_hi v229, v221 offset:1408
ds_write_b16 v229, v222 offset:2
ds_write_b16_d16_hi v229, v222 offset:130
ds_write_b16 v229, v223 offset:258
ds_write_b16_d16_hi v229, v223 offset:386
ds_write_b16 v229, v224 offset:514
ds_write_b16_d16_hi v229, v224 offset:642
ds_write_b16 v229, v225 offset:770
ds_write_b16_d16_hi v229, v225 offset:898
ds_write_b16 v229, v226 offset:1026
ds_write_b16_d16_hi v229, v226 offset:1154
ds_write_b16 v229, v227 offset:1282
ds_write_b16_d16_hi v229, v227 offset:1410
s_waitcnt lgkmcnt(0)
ds_read_b128 v[216:219], v230 offset:0
ds_read_b128 v[220:223], v230 offset:1024
ds_read_b128 v[224:227], v230 offset:2048
v_add_u32 v229, 0x40000000, v231
v_cmp_gt_u32 vcc, 48, v1
    s_nop 1
v_cndmask_b32 v229, v229, v231, vcc
v_accvgpr_write_b32 a12, -1
v_accvgpr_write_b32 a13, -1
v_accvgpr_write_b32 a14, -1
v_accvgpr_write_b32 a15, -1
s_waitcnt lgkmcnt(0)
s_branch p0join_2
filler_1:
s_mov_b32 s32, s6
s_mov_b32 s33, s7
s_mov_b32 s34, 0x280000
s_mov_b32 s35, 0x20000
buffer_load_dwordx2 v[8:9], v58, s[32:35], 0 offen offset:0
buffer_load_dwordx2 v[10:11], v58, s[32:35], 0 offen offset:256
buffer_load_dwordx2 v[12:13], v58, s[32:35], 0 offen offset:512
buffer_load_dwordx2 v[14:15], v58, s[32:35], 0 offen offset:768
buffer_load_dwordx2 v[16:17], v58, s[32:35], 0 offen offset:1024
s_load_dword s55, s[4:5], 0x80000
s_sub_u32 s26, s2, 240
s_lshl_b32 s26, s26, 12
v_lshl_add_u32 v59, v0, 4, s26
v_accvgpr_write_b32 a12, -1
v_accvgpr_write_b32 a13, -1
v_accvgpr_write_b32 a14, -1
v_accvgpr_write_b32 a15, -1
s_add_u32 s40, s4, 0x400000
s_addc_u32 s41, s5, 0
s_mov_b32 s42, 0x288000
s_mov_b32 s43, 0x20000
s_mov_b32 s81, 0
buffer_store_dwordx4 a[12:15], v59, s[40:43], s81 offen sc0 sc1
s_mov_b32 s81, 65536
buffer_store_dwordx4 a[12:15], v59, s[40:43], s81 offen sc0 sc1
s_mov_b32 s81, 131072
buffer_store_dwordx4 a[12:15], v59, s[40:43], s81 offen sc0 sc1
s_mov_b32 s81, 196608
buffer_store_dwordx4 a[12:15], v59, s[40:43], s81 offen sc0 sc1
s_waitcnt lgkmcnt(0)
s_add_u32 s55, s55, 0x9e3779b9
s_add_u32 s12, s4, 0xb0000
s_addc_u32 s13, s5, 0
s_mov_b32 s14, 0x30000
s_mov_b32 s15, 0x20000
v_cvt_f32_u32 v7, v2
v_cvt_f32_u32 v19, v3
v_mul_f32 v212, 0x3d000000, v7
v_mul_f32 v213, v212, v19
v_mul_f32 v213, 0x41000000, v213
v_fmamk_f32 v214, v212, 0x0, v213
v_cos_f32 v60, v214
v_sin_f32 v62, -v214
v_fmamk_f32 v214, v212, 0x3f800000, v213
v_cos_f32 v61, v214
v_sin_f32 v63, -v214
v_cvt_pk_bf16_f32 v80, v60, v61
v_cvt_pk_bf16_f32 v88, v62, v63
s_mov_b32 s81, 262144
buffer_store_dwordx4 a[12:15], v59, s[40:43], s81 offen sc0 sc1
v_fmamk_f32 v214, v212, 0x40000000, v213
v_cos_f32 v60, v214
v_sin_f32 v62, -v214
v_fmamk_f32 v214, v212, 0x40400000, v213
v_cos_f32 v61, v214
v_sin_f32 v63, -v214
v_cvt_pk_bf16_f32 v81, v60, v61
v_cvt_pk_bf16_f32 v89, v62, v63
s_mov_b32 s81, 327680
buffer_store_dwordx4 a[12:15], v59, s[40:43], s81 offen sc0 sc1
v_fmamk_f32 v214, v212, 0x40800000, v213
v_cos_f32 v60, v214
v_sin_f32 v62, -v214
v_fmamk_f32 v214, v212, 0x40a00000, v213
v_cos_f32 v61, v214
v_sin_f32 v63, -v214
v_cvt_pk_bf16_f32 v82, v60, v61
v_cvt_pk_bf16_f32 v90, v62, v63
s_mov_b32 s81, 393216
buffer_store_dwordx4 a[12:15], v59, s[40:43], s81 offen sc0 sc1
v_fmamk_f32 v214, v212, 0x40c00000, v213
v_cos_f32 v60, v214
v_sin_f32 v62, -v214
v_fmamk_f32 v214, v212, 0x40e00000, v213
v_cos_f32 v61, v214
v_sin_f32 v63, -v214
v_cvt_pk_bf16_f32 v83, v60, v61
v_cvt_pk_bf16_f32 v91, v62, v63
s_mov_b32 s81, 458752
buffer_store_dwordx4 a[12:15], v59, s[40:43], s81 offen sc0 sc1
v_fmamk_f32 v214, v212, 0x41800000, v213
v_cos_f32 v60, v214
v_sin_f32 v62, -v214
v_fmamk_f32 v214, v212, 0x41880000, v213
v_cos_f32 v61, v214
v_sin_f32 v63, -v214
v_cvt_pk_bf16_f32 v84, v60, v61
v_cvt_pk_bf16_f32 v92, v62, v63
s_mov_b32 s81, 524288
buffer_store_dwordx4 a[12:15], v59, s[40:43], s81 offen sc0 sc1
v_fmamk_f32 v214, v212, 0x41900000, v213
v_cos_f32 v60, v214
v_sin_f32 v62, -v214
v_fmamk_f32 v214, v212, 0x41980000, v213
v_cos_f32 v61, v214
v_sin_f32 v63, -v214
v_cvt_pk_bf16_f32 v85, v60, v61
v_cvt_pk_bf16_f32 v93, v62, v63
s_mov_b32 s81, 589824
buffer_store_dwordx4 a[12:15], v59, s[40:43], s81 offen sc0 sc1
v_fmamk_f32 v214, v212, 0x41a00000, v213
v_cos_f32 v60, v214
v_sin_f32 v62, -v214
v_fmamk_f32 v214, v212, 0x41a80000, v213
v_cos_f32 v61, v214
v_sin_f32 v63, -v214
v_cvt_pk_bf16_f32 v86, v60, v61
v_cvt_pk_bf16_f32 v94, v62, v63
s_mov_b32 s81, 655360
buffer_store_dwordx4 a[12:15], v59, s[40:43], s81 offen sc0 sc1
v_fmamk_f32 v214, v212, 0x41b00000, v213
v_cos_f32 v60, v214
v_sin_f32 v62, -v214
v_fmamk_f32 v214, v212, 0x41b80000, v213
v_cos_f32 v61, v214
v_sin_f32 v63, -v214
v_cvt_pk_bf16_f32 v87, v60, v61
v_cvt_pk_bf16_f32 v95, v62, v63
s_mov_b32 s81, 720896
buffer_store_dwordx4 a[12:15], v59, s[40:43], s81 offen sc0 sc1
v_mul_f32 v212, 0x3acccccd, v7
v_mul_f32 v213, v212, v19
v_mul_f32 v213, 4.0, v213
v_fmamk_f32 v214, v212, 0x0, v213
v_cos_f32 v96, v214
v_sin_f32 v108, v214
v_fmamk_f32 v214, v212, 0x3f800000, v213
v_cos_f32 v97, v214
v_sin_f32 v109, v214
s_mov_b32 s81, 786432
buffer_store_dwordx4 a[12:15], v59, s[40:43], s81 offen sc0 sc1
v_fmamk_f32 v214, v212, 0x40000000, v213
v_cos_f32 v98, v214
v_sin_f32 v110, v214
v_fmamk_f32 v214, v212, 0x40400000, v213
v_cos_f32 v99, v214
v_sin_f32 v111, v214
s_mov_b32 s81, 851968
buffer_store_dwordx4 a[12:15], v59, s[40:43], s81 offen sc0 sc1
v_fmamk_f32 v214, v212, 0x41000000, v213
v_cos_f32 v100, v214
v_sin_f32 v112, v214
v_fmamk_f32 v214, v212, 0x41100000, v213
v_cos_f32 v101, v214
v_sin_f32 v113, v214
s_mov_b32 s81, 917504
buffer_store_dwordx4 a[12:15], v59, s[40:43], s81 offen sc0 sc1
v_fmamk_f32 v214, v212, 0x41200000, v213
v_cos_f32 v102, v214
v_sin_f32 v114, v214
v_fmamk_f32 v214, v212, 0x41300000, v213
v_cos_f32 v103, v214
v_sin_f32 v115, v214
s_mov_b32 s81, 983040
buffer_store_dwordx4 a[12:15], v59, s[40:43], s81 offen sc0 sc1
v_fmamk_f32 v214, v212, 0x41800000, v213
v_cos_f32 v104, v214
v_sin_f32 v116, v214
v_fmamk_f32 v214, v212, 0x41880000, v213
v_cos_f32 v105, v214
v_sin_f32 v117, v214
s_mov_b32 s81, 1048576
buffer_store_dwordx4 a[12:15], v59, s[40:43], s81 offen sc0 sc1
v_fmamk_f32 v214, v212, 0x41900000, v213
v_cos_f32 v106, v214
v_sin_f32 v118, v214
v_fmamk_f32 v214, v212, 0x41980000, v213
v_cos_f32 v107, v214
v_sin_f32 v119, v214
s_mov_b32 s81, 1114112
buffer_store_dwordx4 a[12:15], v59, s[40:43], s81 offen sc0 sc1
v_and_b32 v60, 15, v2
v_cvt_f32_u32 v60, v60
v_lshrrev_b32 v61, 4, v2
v_cvt_f32_u32 v61, v61
v_mul_f32 v212, 0x3d4ccccd, v60
v_mul_f32 v213, v212, v19
v_mul_f32 v213, 4.0, v213
v_fmamk_f32 v213, v61, 0x3e800000, v213
v_add_f32 v215, 0xbe800000, v213
v_fmamk_f32 v214, v212, 0x0, v213
v_cos_f32 v62, v214
v_fmamk_f32 v214, v212, 0x3f800000, v213
v_cos_f32 v63, v214
    s_nop 0
v_cvt_pk_bf16_f32 v120, v62, v63
s_mov_b32 s81, 1179648
buffer_store_dwordx4 a[12:15], v59, s[40:43], s81 offen sc0 sc1
v_fmamk_f32 v214, v212, 0x0, v215
v_cos_f32 v62, v214
v_fmamk_f32 v214, v212, 0x3f800000, v215
v_cos_f32 v63, v214
    s_nop 0
v_cvt_pk_bf16_f32 v124, v62, v63
s_mov_b32 s81, 1245184
buffer_store_dwordx4 a[12:15], v59, s[40:43], s81 offen sc0 sc1
v_fmamk_f32 v214, v212, 0x40000000, v213
v_cos_f32 v62, v214
v_fmamk_f32 v214, v212, 0x40400000, v213
v_cos_f32 v63, v214
    s_nop 0
v_cvt_pk_bf16_f32 v121, v62, v63
s_mov_b32 s81, 1310720
buffer_store_dwordx4 a[12:15], v59, s[40:43], s81 offen sc0 sc1
v_fmamk_f32 v214, v212, 0x40000000, v215
v_cos_f32 v62, v214
v_fmamk_f32 v214, v212, 0x40400000, v215
v_cos_f32 v63, v214
    s_nop 0
v_cvt_pk_bf16_f32 v125, v62, v63
s_mov_b32 s81, 1376256
buffer_store_dwordx4 a[12:15], v59, s[40:43], s81 offen sc0 sc1
v_fmamk_f32 v214, v212, 0x41000000, v213
v_cos_f32 v62, v214
v_fmamk_f32 v214, v212, 0x41100000, v213
v_cos_f32 v63, v214
    s_nop 0
v_cvt_pk_bf16_f32 v122, v62, v63
s_mov_b32 s81, 1441792
buffer_store_dwordx4 a[12:15], v59, s[40:43], s81 offen sc0 sc1
v_fmamk_f32 v214, v212, 0x41000000, v215
v_cos_f32 v62, v214
v_fmamk_f32 v214, v212, 0x41100000, v215
v_cos_f32 v63, v214
    s_nop 0
v_cvt_pk_bf16_f32 v126, v62, v63
s_mov_b32 s81, 1507328
buffer_store_dwordx4 a[12:15], v59, s[40:43], s81 offen sc0 sc1
v_fmamk_f32 v214, v212, 0x41200000, v213
v_cos_f32 v62, v214
v_fmamk_f32 v214, v212, 0x41300000, v213
v_cos_f32 v63, v214
    s_nop 0
v_cvt_pk_bf16_f32 v123, v62, v63
s_mov_b32 s81, 1572864
buffer_store_dwordx4 a[12:15], v59, s[40:43], s81 offen sc0 sc1
v_fmamk_f32 v214, v212, 0x41200000, v215
v_cos_f32 v62, v214
v_fmamk_f32 v214, v212, 0x41300000, v215
v_cos_f32 v63, v214
    s_nop 0
v_cvt_pk_bf16_f32 v127, v62, v63
s_mov_b32 s81, 1638400
buffer_store_dwordx4 a[12:15], v59, s[40:43], s81 offen sc0 sc1
v_fmamk_f32 v214, v212, 0x41800000, v213
v_cos_f32 v62, v214
v_fmamk_f32 v214, v212, 0x41880000, v213
v_cos_f32 v63, v214
    s_nop 0
v_cvt_pk_bf16_f32 v128, v62, v63
s_mov_b32 s81, 1703936
buffer_store_dwordx4 a[12:15], v59, s[40:43], s81 offen sc0 sc1
v_fmamk_f32 v214, v212, 0x41800000, v215
v_cos_f32 v62, v214
v_fmamk_f32 v214, v212, 0x41880000, v215
v_cos_f32 v63, v214
    s_nop 0
v_cvt_pk_bf16_f32 v130, v62, v63
s_mov_b32 s81, 1769472
buffer_store_dwordx4 a[12:15], v59, s[40:43], s81 offen sc0 sc1
v_fmamk_f32 v214, v212, 0x41900000, v213
v_cos_f32 v62, v214
v_fmamk_f32 v214, v212, 0x41980000, v213
v_cos_f32 v63, v214
    s_nop 0
v_cvt_pk_bf16_f32 v129, v62, v63
s_mov_b32 s81, 1835008
buffer_store_dwordx4 a[12:15], v59, s[40:43], s81 offen sc0 sc1
v_fmamk_f32 v214, v212, 0x41900000, v215
v_cos_f32 v62, v214
v_fmamk_f32 v214, v212, 0x41980000, v215
v_cos_f32 v63, v214
    s_nop 0
v_cvt_pk_bf16_f32 v131, v62, v63
s_mov_b32 s81, 1900544
buffer_store_dwordx4 a[12:15], v59, s[40:43], s81 offen sc0 sc1
v_cmp_eq_u32 vcc, 0, v3
    s_nop 1
v_cndmask_b32 v128, 0, v128, vcc
v_cndmask_b32 v129, 0, v129, vcc
v_cndmask_b32 v130, 0, v130, vcc
v_cndmask_b32 v131, 0, v131, vcc
s_waitcnt vmcnt(30)
v_lshlrev_b32 v60, 16, v8
v_and_b32 v61, 0xffff0000, v8
v_lshlrev_b32 v62, 16, v9
v_and_b32 v63, 0xffff0000, v9
v_lshlrev_b32 v64, 16, v10
v_and_b32 v65, 0xffff0000, v10
v_lshlrev_b32 v66, 16, v11
v_and_b32 v67, 0xffff0000, v11
v_lshlrev_b32 v68, 16, v12
v_and_b32 v69, 0xffff0000, v12
v_lshlrev_b32 v70, 16, v13
v_and_b32 v71, 0xffff0000, v13
v_lshlrev_b32 v72, 16, v14
v_and_b32 v73, 0xffff0000, v14
v_lshlrev_b32 v74, 16, v15
v_and_b32 v75, 0xffff0000, v15
v_lshlrev_b32 v76, 16, v16
v_and_b32 v77, 0xffff0000, v16
v_lshlrev_b32 v78, 16, v17
v_and_b32 v79, 0xffff0000, v17
s_mov_b32 s81, 1966080
buffer_store_dwordx4 a[12:15], v59, s[40:43], s81 offen sc0 sc1
s_mov_b32 s81, 2031616
buffer_store_dwordx4 a[12:15], v59, s[40:43], s81 offen sc0 sc1
v_add_f32 v212, v60, v61
v_add_f32 v213, v62, v63
v_add_f32 v212, v212, v64
v_add_f32 v213, v213, v65
v_add_f32 v212, v212, v66
v_add_f32 v213, v213, v67
v_add_f32 v212, v212, v68
v_add_f32 v213, v213, v69
v_add_f32 v212, v212, v70
v_add_f32 v213, v213, v71
v_add_f32 v212, v212, v72
v_add_f32 v213, v213, v73
v_add_f32 v212, v212, v74
v_add_f32 v213, v213, v75
v_add_f32 v212, v212, v76
v_add_f32 v213, v213, v77
v_add_f32 v212, v212, v78
v_add_f32 v213, v213, v79
v_add_f32 v212, v212, v213
    s_nop 1
v_add_f32_dpp v212, v212, v212 quad_perm:[1,0,3,2] row_mask:0xf bank_mask:0xf
    s_nop 1
v_add_f32_dpp v212, v212, v212 quad_perm:[2,3,0,1] row_mask:0xf bank_mask:0xf
    s_nop 1
v_add_f32_dpp v212, v212, v212 row_ror:4 row_mask:0xf bank_mask:0xf
    s_nop 1
v_add_f32_dpp v212, v212, v212 row_ror:8 row_mask:0xf bank_mask:0xf
v_mov_b32 v213, v212
    s_nop 1
v_permlane16_swap_b32 v212, v213
v_add_f32 v212, v212, v213
v_mul_f32 v212, 0x3acccccd, v212
v_sub_f32 v60, v60, v212
v_sub_f32 v61, v61, v212
v_sub_f32 v62, v62, v212
v_sub_f32 v63, v63, v212
v_sub_f32 v64, v64, v212
v_sub_f32 v65, v65, v212
v_sub_f32 v66, v66, v212
v_sub_f32 v67, v67, v212
v_sub_f32 v68, v68, v212
v_sub_f32 v69, v69, v212
v_sub_f32 v70, v70, v212
v_sub_f32 v71, v71, v212
v_sub_f32 v72, v72, v212
v_sub_f32 v73, v73, v212
v_sub_f32 v74, v74, v212
v_sub_f32 v75, v75, v212
v_sub_f32 v76, v76, v212
v_sub_f32 v77, v77, v212
v_sub_f32 v78, v78, v212
v_sub_f32 v79, v79, v212
v_mul_f32 v212, v60, v60
v_mul_f32 v213, v61, v61
v_fmac_f32 v212, v62, v62
v_fmac_f32 v213, v63, v63
v_fmac_f32 v212, v64, v64
v_fmac_f32 v213, v65, v65
v_fmac_f32 v212, v66, v66
v_fmac_f32 v213, v67, v67
v_fmac_f32 v212, v68, v68
v_fmac_f32 v213, v69, v69
v_fmac_f32 v212, v70, v70
v_fmac_f32 v213, v71, v71
v_fmac_f32 v212, v72, v72
v_fmac_f32 v213, v73, v73
v_fmac_f32 v212, v74, v74
v_fmac_f32 v213, v75, v75
v_fmac_f32 v212, v76, v76
v_fmac_f32 v213, v77, v77
v_fmac_f32 v212, v78, v78
v_fmac_f32 v213, v79, v79
v_add_f32 v212, v212, v213
    s_nop 1
v_add_f32_dpp v212, v212, v212 quad_perm:[1,0,3,2] row_mask:0xf bank_mask:0xf
    s_nop 1
v_add_f32_dpp v212, v212, v212 quad_perm:[2,3,0,1] row_mask:0xf bank_mask:0xf
    s_nop 1
v_add_f32_dpp v212, v212, v212 row_ror:4 row_mask:0xf bank_mask:0xf
    s_nop 1
v_add_f32_dpp v212, v212, v212 row_ror:8 row_mask:0xf bank_mask:0xf
v_mov_b32 v213, v212
    s_nop 1
v_permlane16_swap_b32 v212, v213
v_add_f32 v212, v212, v213
v_mov_b32 v213, 0x3727c5ac
v_fmac_f32 v213, 0x3acccccd, v212
v_rsq_f32 v212, v213
s_mov_b32 s81, 2097152
buffer_store_dwordx4 a[12:15], v59, s[40:43], s81 offen sc0 sc1
s_mov_b32 s81, 2162688
buffer_store_dwordx4 a[12:15], v59, s[40:43], s81 offen sc0 sc1
s_mov_b32 s81, 2228224
buffer_store_dwordx4 a[12:15], v59, s[40:43], s81 offen sc0 sc1
s_mov_b32 s81, 2293760
buffer_store_dwordx4 a[12:15], v59, s[40:43], s81 offen sc0 sc1
s_mov_b32 s81, 2359296
buffer_store_dwordx4 a[12:15], v59, s[40:43], s81 offen sc0 sc1
s_mov_b32 s81, 2424832
buffer_store_dwordx4 a[12:15], v59, s[40:43], s81 offen sc0 sc1
s_mov_b32 s81, 2490368
buffer_store_dwordx4 a[12:15], v59, s[40:43], s81 offen sc0 sc1
s_mov_b32 s81, 2555904
buffer_store_dwordx4 a[12:15], v59, s[40:43], s81 offen sc0 sc1
s_mov_b32 s81, 2621440
buffer_store_dwordx4 a[12:15], v59, s[40:43], s81 offen sc0 sc1
v_mov_b32 v231, 0x40000000
v_mov_b32 v229, 0x40000000
s_waitcnt vmcnt(0)
s_barrier
s_cmp_lg_u32 s3, 0
s_cbranch_scc1 fl_5
s_lshl_b32 s50, s2, 5
s_add_u32 s50, s50, 0
v_mov_b32 v4, s50
v_mov_b32 v5, s55
s_mov_b64 exec, 1
buffer_store_dword v5, v4, s[12:15], 0 offen sc0 sc1
s_mov_b64 exec, -1
fl_5:
p0join_2:
v_lshlrev_b32 v245, 4, v0
v_add_u32 v246, 8192, v245
v_add_u32 v247, 4096, v245
v_cmp_gt_u32 vcc, 128, v0
    s_nop 1
v_cndmask_b32 v246, v247, v246, vcc
v_and_b32 v247, 15, v0
v_add_u32 v247, 240, v247
v_lshlrev_b32 v247, 5, v247
s_add_u32 s32, s4, 0xa0000
s_addc_u32 s33, s5, 0
s_mov_b32 s34, 0x2800
s_mov_b32 s35, 0x20000
s_movk_i32 s26, 4096
buffer_load_dwordx4 v[232:235], v245, s[32:35], 0 offen sc1
buffer_load_dwordx4 v[236:239], v245, s[32:35], s26 offen sc1
buffer_load_dwordx4 v[240:243], v246, s[32:35], 0 offen sc1
s_lshr_b32 s50, s2, 3
s_mov_b64 exec, 0
s_cmp_eq_u32 s3, 1
s_cbranch_scc1 wu_t1
s_cmp_eq_u32 s3, 2
s_cbranch_scc1 wu_t2
s_cmp_eq_u32 s3, 3
s_cbranch_scc1 wu_t3
wu_t0:
s_cmp_eq_u32 s50, 30
s_cbranch_scc1 wu_0
s_cmp_eq_u32 s50, 31
s_cbranch_scc1 wu_4
s_cmp_eq_u32 s50, 0
s_cbranch_scc1 wu_8
s_cmp_eq_u32 s50, 1
s_cbranch_scc1 wu_12
s_cmp_eq_u32 s50, 2
s_cbranch_scc1 wu_16
s_cmp_eq_u32 s50, 3
s_cbranch_scc1 wu_20
s_cmp_eq_u32 s50, 4
s_cbranch_scc1 wu_24
s_cmp_eq_u32 s50, 5
s_cbranch_scc1 wu_28
s_cmp_eq_u32 s50, 6
s_cbranch_scc1 wu_32
s_cmp_eq_u32 s50, 7
s_cbranch_scc1 wu_36
s_cmp_eq_u32 s50, 8
s_cbranch_scc1 wu_40
s_cmp_eq_u32 s50, 9
s_cbranch_scc1 wu_44
s_cmp_eq_u32 s50, 10
s_cbranch_scc1 wu_48
s_cmp_eq_u32 s50, 11
s_cbranch_scc1 wu_52
s_cmp_eq_u32 s50, 12
s_cbranch_scc1 wu_56
s_cmp_eq_u32 s50, 13
s_cbranch_scc1 wu_60
s_cmp_eq_u32 s50, 14
s_cbranch_scc1 wu_64
s_cmp_eq_u32 s50, 15
s_cbranch_scc1 wu_68
s_cmp_eq_u32 s50, 16
s_cbranch_scc1 wu_72
s_cmp_eq_u32 s50, 17
s_cbranch_scc1 wu_76
s_cmp_eq_u32 s50, 18
s_cbranch_scc1 wu_80
s_cmp_eq_u32 s50, 19
s_cbranch_scc1 wu_84
s_branch wu_ret2
wu_t1:
s_cmp_eq_u32 s50, 30
s_cbranch_scc1 wu_1
s_cmp_eq_u32 s50, 31
s_cbranch_scc1 wu_5
s_cmp_eq_u32 s50, 0
s_cbranch_scc1 wu_9
s_cmp_eq_u32 s50, 1
s_cbranch_scc1 wu_13
s_cmp_eq_u32 s50, 2
s_cbranch_scc1 wu_17
s_cmp_eq_u32 s50, 3
s_cbranch_scc1 wu_21
s_cmp_eq_u32 s50, 4
s_cbranch_scc1 wu_25
s_cmp_eq_u32 s50, 5
s_cbranch_scc1 wu_29
s_cmp_eq_u32 s50, 6
s_cbranch_scc1 wu_33
s_cmp_eq_u32 s50, 7
s_cbranch_scc1 wu_37
s_cmp_eq_u32 s50, 8
s_cbranch_scc1 wu_41
s_cmp_eq_u32 s50, 9
s_cbranch_scc1 wu_45
s_cmp_eq_u32 s50, 10
s_cbranch_scc1 wu_49
s_cmp_eq_u32 s50, 11
s_cbranch_scc1 wu_53
s_cmp_eq_u32 s50, 12
s_cbranch_scc1 wu_57
s_cmp_eq_u32 s50, 13
s_cbranch_scc1 wu_61
s_cmp_eq_u32 s50, 14
s_cbranch_scc1 wu_65
s_cmp_eq_u32 s50, 15
s_cbranch_scc1 wu_69
s_cmp_eq_u32 s50, 16
s_cbranch_scc1 wu_73
s_cmp_eq_u32 s50, 17
s_cbranch_scc1 wu_77
s_cmp_eq_u32 s50, 18
s_cbranch_scc1 wu_81
s_branch wu_ret2
wu_t2:
s_cmp_eq_u32 s50, 30
s_cbranch_scc1 wu_2
s_cmp_eq_u32 s50, 31
s_cbranch_scc1 wu_6
s_cmp_eq_u32 s50, 0
s_cbranch_scc1 wu_10
s_cmp_eq_u32 s50, 1
s_cbranch_scc1 wu_14
s_cmp_eq_u32 s50, 2
s_cbranch_scc1 wu_18
s_cmp_eq_u32 s50, 3
s_cbranch_scc1 wu_22
s_cmp_eq_u32 s50, 4
s_cbranch_scc1 wu_26
s_cmp_eq_u32 s50, 5
s_cbranch_scc1 wu_30
s_cmp_eq_u32 s50, 6
s_cbranch_scc1 wu_34
s_cmp_eq_u32 s50, 7
s_cbranch_scc1 wu_38
s_cmp_eq_u32 s50, 8
s_cbranch_scc1 wu_42
s_cmp_eq_u32 s50, 9
s_cbranch_scc1 wu_46
s_cmp_eq_u32 s50, 10
s_cbranch_scc1 wu_50
s_cmp_eq_u32 s50, 11
s_cbranch_scc1 wu_54
s_cmp_eq_u32 s50, 12
s_cbranch_scc1 wu_58
s_cmp_eq_u32 s50, 13
s_cbranch_scc1 wu_62
s_cmp_eq_u32 s50, 14
s_cbranch_scc1 wu_66
s_cmp_eq_u32 s50, 15
s_cbranch_scc1 wu_70
s_cmp_eq_u32 s50, 16
s_cbranch_scc1 wu_74
s_cmp_eq_u32 s50, 17
s_cbranch_scc1 wu_78
s_cmp_eq_u32 s50, 18
s_cbranch_scc1 wu_82
s_branch wu_ret2
wu_t3:
s_cmp_eq_u32 s50, 30
s_cbranch_scc1 wu_3
s_cmp_eq_u32 s50, 31
s_cbranch_scc1 wu_7
s_cmp_eq_u32 s50, 0
s_cbranch_scc1 wu_11
s_cmp_eq_u32 s50, 1
s_cbranch_scc1 wu_15
s_cmp_eq_u32 s50, 2
s_cbranch_scc1 wu_19
s_cmp_eq_u32 s50, 3
s_cbranch_scc1 wu_23
s_cmp_eq_u32 s50, 4
s_cbranch_scc1 wu_27
s_cmp_eq_u32 s50, 5
s_cbranch_scc1 wu_31
s_cmp_eq_u32 s50, 6
s_cbranch_scc1 wu_35
s_cmp_eq_u32 s50, 7
s_cbranch_scc1 wu_39
s_cmp_eq_u32 s50, 8
s_cbranch_scc1 wu_43
s_cmp_eq_u32 s50, 9
s_cbranch_scc1 wu_47
s_cmp_eq_u32 s50, 10
s_cbranch_scc1 wu_51
s_cmp_eq_u32 s50, 11
s_cbranch_scc1 wu_55
s_cmp_eq_u32 s50, 12
s_cbranch_scc1 wu_59
s_cmp_eq_u32 s50, 13
s_cbranch_scc1 wu_63
s_cmp_eq_u32 s50, 14
s_cbranch_scc1 wu_67
s_cmp_eq_u32 s50, 15
s_cbranch_scc1 wu_71
s_cmp_eq_u32 s50, 16
s_cbranch_scc1 wu_75
s_cmp_eq_u32 s50, 17
s_cbranch_scc1 wu_79
s_cmp_eq_u32 s50, 18
s_cbranch_scc1 wu_83
wu_ret2:
s_mov_b64 exec, -1
s_branch wu_poll
rt_6:
buffer_load_dwordx4 v[232:235], v245, s[32:35], 0 offen sc1
buffer_load_dwordx4 v[236:239], v245, s[32:35], s26 offen sc1
buffer_load_dwordx4 v[240:243], v246, s[32:35], 0 offen sc1
wu_poll:
s_add_u32 s53, s53, 1
s_waitcnt vmcnt(0)
v_min3_u32 v4, v233, v235, v237
v_max3_u32 v5, v233, v235, v237
v_min3_u32 v4, v4, v239, v241
v_max3_u32 v5, v5, v239, v241
v_min_u32 v4, v4, v243
v_max_u32 v5, v5, v243
v_cmp_ne_u32 vcc, v4, v5
v_cmp_ne_u32 s[50:51], s55, v5
s_or_b64 vcc, vcc, s[50:51]
s_cmp_ge_u32 s53, 4000000
s_cbranch_scc1 rt_6_x
s_cbranch_vccnz rt_6
rt_6_x:
modok_4:
v_lshrrev_b32 v4, 1, v245
v_lshrrev_b32 v5, 1, v246
v_add_u32 v4, 27904, v4
v_add_u32 v5, 27904, v5
v_add_u32 v6, 2048, v4
ds_write2_b32 v4, v232, v234 offset0:0 offset1:1
ds_write2_b32 v6, v236, v238 offset0:0 offset1:1
wu_0:
s_cbranch_execz wu_ret2
ds_write2_b32 v5, v240, v242 offset0:0 offset1:1
buffer_load_dword v244, v247, s[12:15], 0 offen offset:0 sc1
s_add_u32 s28, s4, 0x100000
s_addc_u32 s29, s5, 0
s_mov_b32 s30, 0x282000
s_mov_b32 s31, 0x20000
s_lshl_b32 s26, s2, 12
v_lshl_add_u32 v245, v0, 4, s26
s_add_u32 s32, s4, 0x700000
s_addc_u32 s33, s5, 0
s_mov_b32 s34, 0x282000
s_mov_b32 s35, 0x20000
buffer_store_dwordx4 a[12:15], v245, s[32:35], 0 offen sc0 sc1
s_mov_b32 s26, 1048576
buffer_store_dwordx4 a[12:15], v245, s[32:35], s26 offen sc0 sc1
s_mov_b32 s26, 2097152
buffer_store_dwordx4 a[12:15], v245, s[32:35], s26 offen sc0 sc1
s_add_u32 s32, s4, 0xd00000
s_addc_u32 s33, s5, 0
s_mov_b32 s34, 0x280000
s_mov_b32 s35, 0x20000
buffer_store_dwordx4 a[12:15], v245, s[32:35], 0 offen sc0 sc1
s_mov_b32 s26, 1048576
buffer_store_dwordx4 a[12:15], v245, s[32:35], s26 offen sc0 sc1
s_mov_b32 s26, 2097152
buffer_store_dwordx4 a[12:15], v245, s[32:35], s26 offen sc0 sc1
s_waitcnt lgkmcnt(0)
s_barrier
v_lshlrev_b32 v6, 4, v2
v_add_u32 v6, 27904, v6
ds_read_b128 v[20:23], v6 offset:2560
ds_read_b128 v[24:27], v6 offset:3072
ds_read_b128 v[28:31], v6 offset:3584
ds_read_b128 v[32:35], v6 offset:4096
ds_read_b128 v[36:39], v6 offset:4608
ds_read_b128 v[40:43], v6 offset:0
ds_read_b128 v[44:47], v6 offset:512
ds_read_b128 v[48:51], v6 offset:1024
ds_read_b128 v[52:55], v6 offset:1536
ds_read_b128 v[56:59], v6 offset:2048
s_mul_i32 s26, s3, 2624
v_mul_u32_u24 v4, 1312, v3
v_lshl_add_u32 v4, v2, 3, v4
v_add_u32 v4, s26, v4
v_bfe_u32 v5, v1, 2, 2
v_lshl_add_u32 v5, v3, 3, v5
v_mul_u32_u24 v5, 40, v5
v_bfe_u32 v6, v1, 4, 1
v_lshl_add_u32 v5, v6, 5, v5
v_and_b32 v6, 3, v1
v_lshl_add_u32 v5, v6, 3, v5
v_add_u32 v5, s26, v5
s_waitcnt lgkmcnt(9)
v_pk_mul_f32 v[20:21], v[20:21], v[212:213] op_sel_hi:[1,0]
v_pk_mul_f32 v[22:23], v[22:23], v[212:213] op_sel_hi:[1,0]
s_waitcnt lgkmcnt(8)
v_pk_mul_f32 v[24:25], v[24:25], v[212:213] op_sel_hi:[1,0]
v_pk_mul_f32 v[26:27], v[26:27], v[212:213] op_sel_hi:[1,0]
s_waitcnt lgkmcnt(7)
v_pk_mul_f32 v[28:29], v[28:29], v[212:213] op_sel_hi:[1,0]
v_pk_mul_f32 v[30:31], v[30:31], v[212:213] op_sel_hi:[1,0]
s_waitcnt lgkmcnt(6)
v_pk_mul_f32 v[32:33], v[32:33], v[212:213] op_sel_hi:[1,0]
v_pk_mul_f32 v[34:35], v[34:35], v[212:213] op_sel_hi:[1,0]
s_waitcnt lgkmcnt(5)
v_pk_mul_f32 v[36:37], v[36:37], v[212:213] op_sel_hi:[1,0]
v_pk_mul_f32 v[38:39], v[38:39], v[212:213] op_sel_hi:[1,0]
s_waitcnt lgkmcnt(4)
v_pk_fma_f32 v[60:61], v[60:61], v[20:21], v[40:41]
v_pk_fma_f32 v[62:63], v[62:63], v[22:23], v[42:43]
v_cvt_pk_bf16_f32 v8, v60, v61
v_cvt_pk_bf16_f32 v9, v62, v63
wu_1:
s_cbranch_execz wu_ret2
ds_write_b64 v4, v[8:9] offset:0
s_waitcnt lgkmcnt(3)
v_pk_fma_f32 v[64:65], v[64:65], v[24:25], v[44:45]
v_pk_fma_f32 v[66:67], v[66:67], v[26:27], v[46:47]
v_cvt_pk_bf16_f32 v10, v64, v65
v_cvt_pk_bf16_f32 v11, v66, v67
ds_write_b64 v4, v[10:11] offset:256
s_waitcnt lgkmcnt(2)
v_pk_fma_f32 v[68:69], v[68:69], v[28:29], v[48:49]
v_pk_fma_f32 v[70:71], v[70:71], v[30:31], v[50:51]
v_cvt_pk_bf16_f32 v12, v68, v69
v_cvt_pk_bf16_f32 v13, v70, v71
ds_write_b64 v4, v[12:13] offset:512
s_waitcnt lgkmcnt(1)
v_pk_fma_f32 v[72:73], v[72:73], v[32:33], v[52:53]
v_pk_fma_f32 v[74:75], v[74:75], v[34:35], v[54:55]
v_cvt_pk_bf16_f32 v14, v72, v73
v_cvt_pk_bf16_f32 v15, v74, v75
ds_write_b64 v4, v[14:15] offset:768
s_waitcnt lgkmcnt(0)
v_pk_fma_f32 v[76:77], v[76:77], v[36:37], v[56:57]
v_pk_fma_f32 v[78:79], v[78:79], v[38:39], v[58:59]
v_cvt_pk_bf16_f32 v16, v76, v77
v_cvt_pk_bf16_f32 v17, v78, v79
ds_write_b64 v4, v[16:17] offset:1024
buffer_store_dwordx4 v[216:219], v231, s[28:31], 0 offen sc0 sc1
v_mov_b32 v18, 0
v_mov_b32 v19, 0
v_cmp_eq_u32 vcc, 0, v2
s_and_saveexec_b64 s[26:27], vcc
ds_write_b64 v4, v[18:19] offset:1280
s_mov_b64 exec, -1
s_waitcnt lgkmcnt(0)
ds_read_b64_tr_b16 v[132:133], v5 offset:0
ds_read_b64_tr_b16 v[134:135], v5 offset:160
ds_read_b64_tr_b16 v[136:137], v5 offset:640
ds_read_b64_tr_b16 v[138:139], v5 offset:800
ds_read_b64_tr_b16 v[140:141], v5 offset:1312
ds_read_b64_tr_b16 v[142:143], v5 offset:1472
ds_read_b64_tr_b16 v[144:145], v5 offset:1952
ds_read_b64_tr_b16 v[146:147], v5 offset:2112
s_waitcnt lgkmcnt(0)
v_mfma_f32_32x32x16_bf16 v[148:163], v[132:135], v[80:83], 0
v_mfma_f32_32x32x16_bf16 v[164:179], v[132:135], v[88:91], 0
v_mfma_f32_32x32x16_bf16 v[180:195], v[140:143], v[80:83], 0
v_mfma_f32_32x32x16_bf16 v[196:211], v[140:143], v[88:91], 0
v_mfma_f32_32x32x16_bf16 v[148:163], v[136:139], v[84:87], v[148:163]
v_mfma_f32_32x32x16_bf16 v[164:179], v[136:139], v[92:95], v[164:179]
v_mfma_f32_32x32x16_bf16 v[180:195], v[144:147], v[84:87], v[180:195]
v_mfma_f32_32x32x16_bf16 v[196:211], v[144:147], v[92:95], v[196:211]
s_mov_b32 s81, 65536
buffer_store_dwordx4 v[220:223], v231, s[28:31], s81 offen sc0 sc1
v_bfe_u32 v4, v2, 3, 1
v_lshlrev_b32 v5, 5, v2
v_lshl_add_u32 v5, v3, 12, v5
s_lshl_b32 s26, s3, 2
s_add_u32 s26, s26, 10496
v_add_u32 v5, s26, v5
v_lshl_add_u32 v4, v4, 4, v5
v_bfe_u32 v6, v2, 3, 1
v_xor_b32 v6, 1, v6
v_lshl_add_u32 v5, v6, 4, v5
v_pk_mul_f32 v[60:61], v[148:149], v[96:97]
v_pk_mul_f32 v[62:63], v[164:165], v[96:97]
v_pk_fma_f32 v[60:61], v[164:165], v[108:109], v[60:61]
v_pk_fma_f32 v[62:63], v[148:149], v[108:109], v[62:63] neg_lo:[1,0,0] neg_hi:[1,0,0]
v_cvt_pk_bf16_f32 v20, v60, v61
v_cvt_pk_bf16_f32 v24, v62, v63
v_pk_mul_f32 v[60:61], v[150:151], v[98:99]
v_pk_mul_f32 v[62:63], v[166:167], v[98:99]
v_pk_fma_f32 v[60:61], v[166:167], v[110:111], v[60:61]
wu_2:
s_cbranch_execz wu_ret2
v_pk_fma_f32 v[62:63], v[150:151], v[110:111], v[62:63] neg_lo:[1,0,0] neg_hi:[1,0,0]
v_cvt_pk_bf16_f32 v21, v60, v61
v_cvt_pk_bf16_f32 v25, v62, v63
v_pk_mul_f32 v[60:61], v[152:153], v[100:101]
v_pk_mul_f32 v[62:63], v[168:169], v[100:101]
v_pk_fma_f32 v[60:61], v[168:169], v[112:113], v[60:61]
v_pk_fma_f32 v[62:63], v[152:153], v[112:113], v[62:63] neg_lo:[1,0,0] neg_hi:[1,0,0]
v_cvt_pk_bf16_f32 v22, v60, v61
v_cvt_pk_bf16_f32 v26, v62, v63
v_pk_mul_f32 v[60:61], v[154:155], v[102:103]
v_pk_mul_f32 v[62:63], v[170:171], v[102:103]
v_pk_fma_f32 v[60:61], v[170:171], v[114:115], v[60:61]
v_pk_fma_f32 v[62:63], v[154:155], v[114:115], v[62:63] neg_lo:[1,0,0] neg_hi:[1,0,0]
v_cvt_pk_bf16_f32 v23, v60, v61
v_cvt_pk_bf16_f32 v27, v62, v63
v_pk_mul_f32 v[60:61], v[156:157], v[104:105]
v_pk_mul_f32 v[62:63], v[172:173], v[104:105]
v_pk_fma_f32 v[60:61], v[172:173], v[116:117], v[60:61]
v_pk_fma_f32 v[62:63], v[156:157], v[116:117], v[62:63] neg_lo:[1,0,0] neg_hi:[1,0,0]
v_cvt_pk_bf16_f32 v28, v60, v61
v_cvt_pk_bf16_f32 v30, v62, v63
v_pk_mul_f32 v[60:61], v[158:159], v[106:107]
v_pk_mul_f32 v[62:63], v[174:175], v[106:107]
v_pk_fma_f32 v[60:61], v[174:175], v[118:119], v[60:61]
v_pk_fma_f32 v[62:63], v[158:159], v[118:119], v[62:63] neg_lo:[1,0,0] neg_hi:[1,0,0]
v_cvt_pk_bf16_f32 v29, v60, v61
v_cvt_pk_bf16_f32 v31, v62, v63
v_pk_mul_f32 v[60:61], v[180:181], v[96:97]
v_pk_mul_f32 v[62:63], v[196:197], v[96:97]
v_pk_fma_f32 v[60:61], v[196:197], v[108:109], v[60:61]
v_pk_fma_f32 v[62:63], v[180:181], v[108:109], v[62:63] neg_lo:[1,0,0] neg_hi:[1,0,0]
v_cvt_pk_bf16_f32 v32, v60, v61
v_cvt_pk_bf16_f32 v36, v62, v63
v_pk_mul_f32 v[60:61], v[182:183], v[98:99]
v_pk_mul_f32 v[62:63], v[198:199], v[98:99]
v_pk_fma_f32 v[60:61], v[198:199], v[110:111], v[60:61]
v_pk_fma_f32 v[62:63], v[182:183], v[110:111], v[62:63] neg_lo:[1,0,0] neg_hi:[1,0,0]
v_cvt_pk_bf16_f32 v33, v60, v61
v_cvt_pk_bf16_f32 v37, v62, v63
v_pk_mul_f32 v[60:61], v[184:185], v[100:101]
v_pk_mul_f32 v[62:63], v[200:201], v[100:101]
v_pk_fma_f32 v[60:61], v[200:201], v[112:113], v[60:61]
v_pk_fma_f32 v[62:63], v[184:185], v[112:113], v[62:63] neg_lo:[1,0,0] neg_hi:[1,0,0]
v_cvt_pk_bf16_f32 v34, v60, v61
v_cvt_pk_bf16_f32 v38, v62, v63
v_pk_mul_f32 v[60:61], v[186:187], v[102:103]
v_pk_mul_f32 v[62:63], v[202:203], v[102:103]
v_pk_fma_f32 v[60:61], v[202:203], v[114:115], v[60:61]
v_pk_fma_f32 v[62:63], v[186:187], v[114:115], v[62:63] neg_lo:[1,0,0] neg_hi:[1,0,0]
v_cvt_pk_bf16_f32 v35, v60, v61
v_cvt_pk_bf16_f32 v39, v62, v63
v_pk_mul_f32 v[60:61], v[188:189], v[104:105]
v_pk_mul_f32 v[62:63], v[204:205], v[104:105]
v_pk_fma_f32 v[60:61], v[204:205], v[116:117], v[60:61]
v_pk_fma_f32 v[62:63], v[188:189], v[116:117], v[62:63] neg_lo:[1,0,0] neg_hi:[1,0,0]
v_cvt_pk_bf16_f32 v40, v60, v61
v_cvt_pk_bf16_f32 v42, v62, v63
v_pk_mul_f32 v[60:61], v[190:191], v[106:107]
v_pk_mul_f32 v[62:63], v[206:207], v[106:107]
v_pk_fma_f32 v[60:61], v[206:207], v[118:119], v[60:61]
v_pk_fma_f32 v[62:63], v[190:191], v[118:119], v[62:63] neg_lo:[1,0,0] neg_hi:[1,0,0]
v_cvt_pk_bf16_f32 v41, v60, v61
v_cvt_pk_bf16_f32 v43, v62, v63
wu_3:
s_cbranch_execz wu_ret2
s_mov_b32 s81, 131072
buffer_store_dwordx4 v[224:227], v229, s[28:31], s81 offen sc0 sc1
v_mfma_f32_32x32x16_bf16 v[148:163], v[120:123], v[20:23], 0
v_mfma_f32_32x32x16_bf16 v[180:195], v[120:123], v[32:35], 0
v_mfma_f32_32x32x16_bf16 v[148:163], v[124:127], v[24:27], v[148:163]
v_mfma_f32_32x32x16_bf16 v[180:195], v[124:127], v[36:39], v[180:195]
v_mfma_f32_32x32x16_bf16 v[148:163], v[128:131], v[28:31], v[148:163]
v_mfma_f32_32x32x16_bf16 v[180:195], v[128:131], v[40:43], v[180:195]
v_bfe_u32 v6, v0, 4, 1
v_xor_b32 v6, v0, v6
v_lshlrev_b32 v6, 4, v6
v_add_u32 v6, 10496, v6
v_lshl_add_u32 v7, v0, 4, s80
v_add_u32 v44, 0x40000000, v7
s_movk_i32 s26, 136
v_cmp_gt_u32 vcc, s26, v0
    s_nop 1
v_cndmask_b32 v44, v44, v7, vcc
s_add_u32 s32, s4, 0x400000
s_addc_u32 s33, s5, 0
s_mov_b32 s34, 0x288000
s_mov_b32 s35, 0x20000
v_cvt_pk_bf16_f32 v60, v148, v180
ds_write_b32 v4, v60 offset:0
v_cvt_pk_bf16_f32 v61, v149, v181
ds_write_b32 v4, v61 offset:1024
v_cvt_pk_bf16_f32 v62, v150, v182
ds_write_b32 v4, v62 offset:2048
v_cvt_pk_bf16_f32 v63, v151, v183
ds_write_b32 v4, v63 offset:3072
v_cvt_pk_bf16_f32 v64, v152, v184
ds_write_b32 v4, v64 offset:8192
v_cvt_pk_bf16_f32 v65, v153, v185
ds_write_b32 v4, v65 offset:9216
v_cvt_pk_bf16_f32 v66, v154, v186
ds_write_b32 v4, v66 offset:10240
v_cvt_pk_bf16_f32 v67, v156, v188
ds_write_b32 v5, v67 offset:0
v_cvt_pk_bf16_f32 v68, v157, v189
ds_write_b32 v5, v68 offset:1024
v_cvt_pk_bf16_f32 v69, v158, v190
ds_write_b32 v5, v69 offset:2048
v_cvt_pk_bf16_f32 v70, v159, v191
ds_write_b32 v5, v70 offset:3072
v_cvt_pk_bf16_f32 v71, v160, v192
ds_write_b32 v5, v71 offset:8192
v_cvt_pk_bf16_f32 v72, v161, v193
ds_write_b32 v5, v72 offset:9216
v_cvt_pk_bf16_f32 v73, v162, v194
ds_write_b32 v5, v73 offset:10240
s_waitcnt vmcnt(9)
v_cmp_ne_u32 vcc, s55, v244
s_cbranch_vccnz fa_7
fa_7_b:
s_movk_i32 s26, 4096
s_movk_i32 s27, 8192
s_waitcnt lgkmcnt(0)
s_barrier
ds_read_b128 v[8:11], v6 offset:0
ds_read_b128 v[12:15], v6 offset:4096
ds_read_b128 v[16:19], v6 offset:8192
s_waitcnt lgkmcnt(2)
buffer_store_dwordx4 v[8:11], v7, s[32:35], 0 offen sc0 sc1
s_waitcnt lgkmcnt(1)
buffer_store_dwordx4 v[12:15], v7, s[32:35], s26 offen sc0 sc1
s_waitcnt lgkmcnt(0)
buffer_store_dwordx4 v[16:19], v44, s[32:35], s27 offen sc0 sc1
s_lshl_b32 s26, s48, 3
s_and_b32 s27, s49, 7
s_add_u32 s26, s26, s27
s_lshr_b32 s27, s49, 3
s_lshl_b32 s27, s27, 3
s_lshl_b32 s50, s3, 1
s_add_u32 s27, s27, s50
s_lshl_b32 s27, s27, 6
s_add_u32 s27, s27, s26
s_mul_i32 s27, s27, 1280
v_mul_u32_u24 v249, 40, v2
v_lshl_add_u32 v249, v3, 3, v249
wu_4:
s_cbranch_execz wu_ret2
v_add_u32 v249, s27, v249
v_lshlrev_b32 v252, 5, v0
s_cmp_gt_u32 s2, 160
s_cbranch_scc1 b_skip_8
s_mul_i32 s20, s48, 20
s_add_u32 s20, s20, s49
s_cmp_eq_u32 s2, 160
s_cselect_b32 s20, 160, s20
s_lshl_b32 s21, s20, 1
s_lshr_b32 s22, s3, 1
s_add_u32 s21, s21, s22
s_and_b32 s23, s3, 1
s_lshl_b32 s24, s21, 13
s_lshl_b32 s25, s23, 12
s_add_u32 s24, s24, s25
s_add_u32 s36, s4, 0x700000
s_addc_u32 s37, s5, 0
s_mov_b32 s38, 0x282000
s_mov_b32 s39, 0x20000
v_cvt_f32_u32 v246, v3
v_cvt_f32_u32 v247, v2
v_cvt_f32_u32 v5, s23
v_mov_b32 v176, 1.0
v_mov_b32 v180, 0
v_lshrrev_b32 v4, 2, v1
s_lshl_b32 s26, s3, 6
v_add_u32 v4, s26, v4
v_and_b32 v6, 3, v1
v_mul_u32_u24 v8, 10368, v4
v_lshl_add_u32 v8, v6, 4, v8
s_lshl_b32 s26, s20, 6
v_add_u32 v8, s26, v8
v_bfe_u32 v7, v4, 1, 2
v_xor_b32 v7, v7, v6
v_lshlrev_b32 v9, 6, v4
v_lshl_add_u32 v9, v7, 4, v9
v_add_u32 v9, 114688, v9
s_lshl_b32 s26, s23, 5
v_lshl_add_u32 v11, v3, 6, v2
v_add_u32 v11, s26, v11
v_lshlrev_b32 v11, 6, v11
v_add_u32 v11, 114688, v11
v_bfe_u32 v7, v2, 1, 2
s_and_b32 s26, s3, 2
v_xor_b32 v7, s26, v7
v_xor_b32 v12, 1, v7
v_lshl_add_u32 v12, v12, 4, v11
v_lshl_add_u32 v11, v7, 4, v11
s_add_u32 s16, s4, 0x400000
s_addc_u32 s17, s5, 0
s_mov_b32 s18, 0x288000
s_mov_b32 s19, 0x20000
s_add_u32 s32, s4, 0x100000
s_addc_u32 s33, s5, 0
s_mov_b32 s34, 0x282000
s_mov_b32 s35, 0x20000
s_waitcnt vmcnt(3)
s_barrier
s_cmp_lg_u32 s3, 0
s_cbranch_scc1 fl_10
s_lshl_b32 s50, s2, 5
s_add_u32 s50, s50, 32768
v_mov_b32 v13, s50
v_mov_b32 v14, s55
s_mov_b64 exec, 1
buffer_store_dword v14, v13, s[12:15], 0 offen sc0 sc1
s_mov_b64 exec, -1
fl_10:
v_mul_f32 v198, 0x3d000000, v247
v_mul_f32 v199, v198, v246
v_mul_f32 v199, 4.0, v199
v_add_f32 v188, v198, v198
v_mul_f32 v189, 0x40400000, v198
v_cos_f32 v177, v198
v_sin_f32 v181, v198
v_cos_f32 v178, v188
v_sin_f32 v182, v188
v_cos_f32 v179, v189
v_sin_f32 v183, v189
v_cos_f32 v184, v199
v_sin_f32 v185, v199
v_fmamk_f32 v189, v198, 0x41000000, v199
v_cos_f32 v186, v189
v_sin_f32 v187, v189
v_pk_mul_f32 v[190:191], v[176:177], v[184:185] op_sel_hi:[1,0]
v_pk_mul_f32 v[192:193], v[176:177], v[184:185] op_sel:[0,1] op_sel_hi:[1,1]
v_pk_fma_f32 v[190:191], v[180:181], v[184:185], v[190:191] op_sel:[0,1,0] op_sel_hi:[1,1,1] neg_lo:[1,0,0] neg_hi:[1,0,0]
v_pk_fma_f32 v[192:193], v[180:181], v[184:185], v[192:193] op_sel:[0,0,0] op_sel_hi:[1,0,1]
v_cvt_pk_bf16_f32 v40, v190, v191
v_cvt_pk_bf16_f32 v48, v192, v193
v_xor_b32 v56, 0x80008000, v48
v_pk_mul_f32 v[194:195], v[178:179], v[184:185] op_sel_hi:[1,0]
wu_5:
s_cbranch_execz wu_ret2
v_pk_mul_f32 v[196:197], v[178:179], v[184:185] op_sel:[0,1] op_sel_hi:[1,1]
v_pk_fma_f32 v[194:195], v[182:183], v[184:185], v[194:195] op_sel:[0,1,0] op_sel_hi:[1,1,1] neg_lo:[1,0,0] neg_hi:[1,0,0]
v_pk_fma_f32 v[196:197], v[182:183], v[184:185], v[196:197] op_sel:[0,0,0] op_sel_hi:[1,0,1]
v_cvt_pk_bf16_f32 v41, v194, v195
v_cvt_pk_bf16_f32 v49, v196, v197
v_xor_b32 v57, 0x80008000, v49
v_fmamk_f32 v188, v198, 0x41800000, v199
v_cos_f32 v184, v188
v_sin_f32 v185, v188
v_pk_mul_f32 v[190:191], v[176:177], v[186:187] op_sel_hi:[1,0]
v_pk_mul_f32 v[192:193], v[176:177], v[186:187] op_sel:[0,1] op_sel_hi:[1,1]
v_pk_fma_f32 v[190:191], v[180:181], v[186:187], v[190:191] op_sel:[0,1,0] op_sel_hi:[1,1,1] neg_lo:[1,0,0] neg_hi:[1,0,0]
v_pk_fma_f32 v[192:193], v[180:181], v[186:187], v[192:193] op_sel:[0,0,0] op_sel_hi:[1,0,1]
v_cvt_pk_bf16_f32 v42, v190, v191
v_cvt_pk_bf16_f32 v50, v192, v193
v_xor_b32 v58, 0x80008000, v50
v_pk_mul_f32 v[194:195], v[178:179], v[186:187] op_sel_hi:[1,0]
v_pk_mul_f32 v[196:197], v[178:179], v[186:187] op_sel:[0,1] op_sel_hi:[1,1]
v_pk_fma_f32 v[194:195], v[182:183], v[186:187], v[194:195] op_sel:[0,1,0] op_sel_hi:[1,1,1] neg_lo:[1,0,0] neg_hi:[1,0,0]
v_pk_fma_f32 v[196:197], v[182:183], v[186:187], v[196:197] op_sel:[0,0,0] op_sel_hi:[1,0,1]
v_cvt_pk_bf16_f32 v43, v194, v195
v_cvt_pk_bf16_f32 v51, v196, v197
v_xor_b32 v59, 0x80008000, v51
v_fmamk_f32 v189, v198, 0x41c00000, v199
v_cos_f32 v186, v189
v_sin_f32 v187, v189
v_pk_mul_f32 v[190:191], v[176:177], v[184:185] op_sel_hi:[1,0]
v_pk_mul_f32 v[192:193], v[176:177], v[184:185] op_sel:[0,1] op_sel_hi:[1,1]
v_pk_fma_f32 v[190:191], v[180:181], v[184:185], v[190:191] op_sel:[0,1,0] op_sel_hi:[1,1,1] neg_lo:[1,0,0] neg_hi:[1,0,0]
v_pk_fma_f32 v[192:193], v[180:181], v[184:185], v[192:193] op_sel:[0,0,0] op_sel_hi:[1,0,1]
v_cvt_pk_bf16_f32 v44, v190, v191
v_cvt_pk_bf16_f32 v52, v192, v193
v_xor_b32 v60, 0x80008000, v52
v_pk_mul_f32 v[194:195], v[178:179], v[184:185] op_sel_hi:[1,0]
v_pk_mul_f32 v[196:197], v[178:179], v[184:185] op_sel:[0,1] op_sel_hi:[1,1]
v_pk_fma_f32 v[194:195], v[182:183], v[184:185], v[194:195] op_sel:[0,1,0] op_sel_hi:[1,1,1] neg_lo:[1,0,0] neg_hi:[1,0,0]
v_pk_fma_f32 v[196:197], v[182:183], v[184:185], v[196:197] op_sel:[0,0,0] op_sel_hi:[1,0,1]
v_cvt_pk_bf16_f32 v45, v194, v195
v_cvt_pk_bf16_f32 v53, v196, v197
v_xor_b32 v61, 0x80008000, v53
v_pk_mul_f32 v[190:191], v[176:177], v[186:187] op_sel_hi:[1,0]
v_pk_mul_f32 v[192:193], v[176:177], v[186:187] op_sel:[0,1] op_sel_hi:[1,1]
v_pk_fma_f32 v[190:191], v[180:181], v[186:187], v[190:191] op_sel:[0,1,0] op_sel_hi:[1,1,1] neg_lo:[1,0,0] neg_hi:[1,0,0]
v_pk_fma_f32 v[192:193], v[180:181], v[186:187], v[192:193] op_sel:[0,0,0] op_sel_hi:[1,0,1]
v_cvt_pk_bf16_f32 v46, v190, v191
v_cvt_pk_bf16_f32 v54, v192, v193
v_xor_b32 v62, 0x80008000, v54
v_pk_mul_f32 v[194:195], v[178:179], v[186:187] op_sel_hi:[1,0]
v_pk_mul_f32 v[196:197], v[178:179], v[186:187] op_sel:[0,1] op_sel_hi:[1,1]
v_pk_fma_f32 v[194:195], v[182:183], v[186:187], v[194:195] op_sel:[0,1,0] op_sel_hi:[1,1,1] neg_lo:[1,0,0] neg_hi:[1,0,0]
v_pk_fma_f32 v[196:197], v[182:183], v[186:187], v[196:197] op_sel:[0,0,0] op_sel_hi:[1,0,1]
v_cvt_pk_bf16_f32 v47, v194, v195
v_cvt_pk_bf16_f32 v55, v196, v197
v_xor_b32 v63, 0x80008000, v55
v_mul_f32 v6, 0x41000000, v5
v_add_f32 v6, v6, v246
v_mul_f32 v6, 4.0, v6
v_mul_f32 v198, 0x3a000000, v247
v_mul_f32 v199, v6, v198
v_add_f32 v188, v198, v198
v_mul_f32 v189, 0x40400000, v198
v_cos_f32 v177, v198
v_sin_f32 v181, v198
v_cos_f32 v178, v188
v_sin_f32 v182, v188
v_cos_f32 v179, v189
v_sin_f32 v183, v189
v_cos_f32 v184, v199
v_sin_f32 v185, v199
v_fmamk_f32 v189, v198, 0x41000000, v199
v_cos_f32 v186, v189
v_sin_f32 v187, v189
v_pk_mul_f32 v[96:97], v[176:177], v[184:185] op_sel_hi:[1,0]
wu_6:
s_cbranch_execz wu_ret2
v_pk_mul_f32 v[112:113], v[176:177], v[184:185] op_sel:[0,1] op_sel_hi:[1,1]
v_pk_fma_f32 v[96:97], v[180:181], v[184:185], v[96:97] op_sel:[0,1,0] op_sel_hi:[1,1,1] neg_lo:[1,0,0] neg_hi:[1,0,0]
v_pk_fma_f32 v[112:113], v[180:181], v[184:185], v[112:113] op_sel:[0,0,0] op_sel_hi:[1,0,1]
v_pk_mul_f32 v[98:99], v[178:179], v[184:185] op_sel_hi:[1,0]
v_pk_mul_f32 v[114:115], v[178:179], v[184:185] op_sel:[0,1] op_sel_hi:[1,1]
v_pk_fma_f32 v[98:99], v[182:183], v[184:185], v[98:99] op_sel:[0,1,0] op_sel_hi:[1,1,1] neg_lo:[1,0,0] neg_hi:[1,0,0]
v_pk_fma_f32 v[114:115], v[182:183], v[184:185], v[114:115] op_sel:[0,0,0] op_sel_hi:[1,0,1]
v_fmamk_f32 v188, v198, 0x41800000, v199
v_cos_f32 v184, v188
v_sin_f32 v185, v188
v_pk_mul_f32 v[100:101], v[176:177], v[186:187] op_sel_hi:[1,0]
v_pk_mul_f32 v[116:117], v[176:177], v[186:187] op_sel:[0,1] op_sel_hi:[1,1]
v_pk_fma_f32 v[100:101], v[180:181], v[186:187], v[100:101] op_sel:[0,1,0] op_sel_hi:[1,1,1] neg_lo:[1,0,0] neg_hi:[1,0,0]
v_pk_fma_f32 v[116:117], v[180:181], v[186:187], v[116:117] op_sel:[0,0,0] op_sel_hi:[1,0,1]
v_pk_mul_f32 v[102:103], v[178:179], v[186:187] op_sel_hi:[1,0]
v_pk_mul_f32 v[118:119], v[178:179], v[186:187] op_sel:[0,1] op_sel_hi:[1,1]
v_pk_fma_f32 v[102:103], v[182:183], v[186:187], v[102:103] op_sel:[0,1,0] op_sel_hi:[1,1,1] neg_lo:[1,0,0] neg_hi:[1,0,0]
v_pk_fma_f32 v[118:119], v[182:183], v[186:187], v[118:119] op_sel:[0,0,0] op_sel_hi:[1,0,1]
v_fmamk_f32 v189, v198, 0x41c00000, v199
v_cos_f32 v186, v189
v_sin_f32 v187, v189
v_pk_mul_f32 v[104:105], v[176:177], v[184:185] op_sel_hi:[1,0]
v_pk_mul_f32 v[120:121], v[176:177], v[184:185] op_sel:[0,1] op_sel_hi:[1,1]
v_pk_fma_f32 v[104:105], v[180:181], v[184:185], v[104:105] op_sel:[0,1,0] op_sel_hi:[1,1,1] neg_lo:[1,0,0] neg_hi:[1,0,0]
v_pk_fma_f32 v[120:121], v[180:181], v[184:185], v[120:121] op_sel:[0,0,0] op_sel_hi:[1,0,1]
v_pk_mul_f32 v[106:107], v[178:179], v[184:185] op_sel_hi:[1,0]
v_pk_mul_f32 v[122:123], v[178:179], v[184:185] op_sel:[0,1] op_sel_hi:[1,1]
v_pk_fma_f32 v[106:107], v[182:183], v[184:185], v[106:107] op_sel:[0,1,0] op_sel_hi:[1,1,1] neg_lo:[1,0,0] neg_hi:[1,0,0]
v_pk_fma_f32 v[122:123], v[182:183], v[184:185], v[122:123] op_sel:[0,0,0] op_sel_hi:[1,0,1]
v_pk_mul_f32 v[108:109], v[176:177], v[186:187] op_sel_hi:[1,0]
v_pk_mul_f32 v[124:125], v[176:177], v[186:187] op_sel:[0,1] op_sel_hi:[1,1]
v_pk_fma_f32 v[108:109], v[180:181], v[186:187], v[108:109] op_sel:[0,1,0] op_sel_hi:[1,1,1] neg_lo:[1,0,0] neg_hi:[1,0,0]
v_pk_fma_f32 v[124:125], v[180:181], v[186:187], v[124:125] op_sel:[0,0,0] op_sel_hi:[1,0,1]
v_pk_mul_f32 v[110:111], v[178:179], v[186:187] op_sel_hi:[1,0]
v_pk_mul_f32 v[126:127], v[178:179], v[186:187] op_sel:[0,1] op_sel_hi:[1,1]
v_pk_fma_f32 v[110:111], v[182:183], v[186:187], v[110:111] op_sel:[0,1,0] op_sel_hi:[1,1,1] neg_lo:[1,0,0] neg_hi:[1,0,0]
v_pk_fma_f32 v[126:127], v[182:183], v[186:187], v[126:127] op_sel:[0,0,0] op_sel_hi:[1,0,1]
v_mul_f32 v7, 0x42000000, v5
v_add_f32 v245, v7, v247
v_mul_f32 v198, 0x3c800000, v245
v_mul_f32 v199, v6, v198
v_add_f32 v188, v198, v198
v_mul_f32 v189, 0x40400000, v198
v_cos_f32 v177, v198
v_sin_f32 v181, v198
v_cos_f32 v178, v188
v_sin_f32 v182, v188
v_cos_f32 v179, v189
v_sin_f32 v183, v189
v_cos_f32 v184, v199
v_sin_f32 v185, v199
v_fmamk_f32 v189, v198, 0x41000000, v199
v_cos_f32 v186, v189
v_sin_f32 v187, v189
v_pk_mul_f32 v[190:191], v[176:177], v[184:185] op_sel_hi:[1,0]
v_pk_mul_f32 v[192:193], v[176:177], v[184:185] op_sel:[0,1] op_sel_hi:[1,1]
v_pk_fma_f32 v[190:191], v[180:181], v[184:185], v[190:191] op_sel:[0,1,0] op_sel_hi:[1,1,1] neg_lo:[1,0,0] neg_hi:[1,0,0]
v_pk_fma_f32 v[192:193], v[180:181], v[184:185], v[192:193] op_sel:[0,0,0] op_sel_hi:[1,0,1]
v_cvt_pk_bf16_f32 v64, v190, v191
v_cvt_pk_bf16_f32 v80, v192, v193
v_pk_mul_f32 v[194:195], v[178:179], v[184:185] op_sel_hi:[1,0]
v_pk_mul_f32 v[196:197], v[178:179], v[184:185] op_sel:[0,1] op_sel_hi:[1,1]
v_pk_fma_f32 v[194:195], v[182:183], v[184:185], v[194:195] op_sel:[0,1,0] op_sel_hi:[1,1,1] neg_lo:[1,0,0] neg_hi:[1,0,0]
v_pk_fma_f32 v[196:197], v[182:183], v[184:185], v[196:197] op_sel:[0,0,0] op_sel_hi:[1,0,1]
v_cvt_pk_bf16_f32 v65, v194, v195
v_cvt_pk_bf16_f32 v81, v196, v197
v_fmamk_f32 v188, v198, 0x41800000, v199
v_cos_f32 v184, v188
v_sin_f32 v185, v188
v_pk_mul_f32 v[190:191], v[176:177], v[186:187] op_sel_hi:[1,0]
v_pk_mul_f32 v[192:193], v[176:177], v[186:187] op_sel:[0,1] op_sel_hi:[1,1]
v_pk_fma_f32 v[190:191], v[180:181], v[186:187], v[190:191] op_sel:[0,1,0] op_sel_hi:[1,1,1] neg_lo:[1,0,0] neg_hi:[1,0,0]
v_pk_fma_f32 v[192:193], v[180:181], v[186:187], v[192:193] op_sel:[0,0,0] op_sel_hi:[1,0,1]
wu_7:
s_cbranch_execz wu_ret2
v_cvt_pk_bf16_f32 v66, v190, v191
v_cvt_pk_bf16_f32 v82, v192, v193
v_pk_mul_f32 v[194:195], v[178:179], v[186:187] op_sel_hi:[1,0]
v_pk_mul_f32 v[196:197], v[178:179], v[186:187] op_sel:[0,1] op_sel_hi:[1,1]
v_pk_fma_f32 v[194:195], v[182:183], v[186:187], v[194:195] op_sel:[0,1,0] op_sel_hi:[1,1,1] neg_lo:[1,0,0] neg_hi:[1,0,0]
v_pk_fma_f32 v[196:197], v[182:183], v[186:187], v[196:197] op_sel:[0,0,0] op_sel_hi:[1,0,1]
v_cvt_pk_bf16_f32 v67, v194, v195
v_cvt_pk_bf16_f32 v83, v196, v197
v_fmamk_f32 v189, v198, 0x41c00000, v199
v_cos_f32 v186, v189
v_sin_f32 v187, v189
v_pk_mul_f32 v[190:191], v[176:177], v[184:185] op_sel_hi:[1,0]
v_pk_mul_f32 v[192:193], v[176:177], v[184:185] op_sel:[0,1] op_sel_hi:[1,1]
v_pk_fma_f32 v[190:191], v[180:181], v[184:185], v[190:191] op_sel:[0,1,0] op_sel_hi:[1,1,1] neg_lo:[1,0,0] neg_hi:[1,0,0]
v_pk_fma_f32 v[192:193], v[180:181], v[184:185], v[192:193] op_sel:[0,0,0] op_sel_hi:[1,0,1]
v_cvt_pk_bf16_f32 v68, v190, v191
v_cvt_pk_bf16_f32 v84, v192, v193
v_pk_mul_f32 v[194:195], v[178:179], v[184:185] op_sel_hi:[1,0]
v_pk_mul_f32 v[196:197], v[178:179], v[184:185] op_sel:[0,1] op_sel_hi:[1,1]
v_pk_fma_f32 v[194:195], v[182:183], v[184:185], v[194:195] op_sel:[0,1,0] op_sel_hi:[1,1,1] neg_lo:[1,0,0] neg_hi:[1,0,0]
v_pk_fma_f32 v[196:197], v[182:183], v[184:185], v[196:197] op_sel:[0,0,0] op_sel_hi:[1,0,1]
v_cvt_pk_bf16_f32 v69, v194, v195
v_cvt_pk_bf16_f32 v85, v196, v197
v_pk_mul_f32 v[190:191], v[176:177], v[186:187] op_sel_hi:[1,0]
v_pk_mul_f32 v[192:193], v[176:177], v[186:187] op_sel:[0,1] op_sel_hi:[1,1]
v_pk_fma_f32 v[190:191], v[180:181], v[186:187], v[190:191] op_sel:[0,1,0] op_sel_hi:[1,1,1] neg_lo:[1,0,0] neg_hi:[1,0,0]
v_pk_fma_f32 v[192:193], v[180:181], v[186:187], v[192:193] op_sel:[0,0,0] op_sel_hi:[1,0,1]
v_cvt_pk_bf16_f32 v70, v190, v191
v_cvt_pk_bf16_f32 v86, v192, v193
v_pk_mul_f32 v[194:195], v[178:179], v[186:187] op_sel_hi:[1,0]
v_pk_mul_f32 v[196:197], v[178:179], v[186:187] op_sel:[0,1] op_sel_hi:[1,1]
v_pk_fma_f32 v[194:195], v[182:183], v[186:187], v[194:195] op_sel:[0,1,0] op_sel_hi:[1,1,1] neg_lo:[1,0,0] neg_hi:[1,0,0]
v_pk_fma_f32 v[196:197], v[182:183], v[186:187], v[196:197] op_sel:[0,0,0] op_sel_hi:[1,0,1]
v_cvt_pk_bf16_f32 v71, v194, v195
v_cvt_pk_bf16_f32 v87, v196, v197
v_and_b32 v7, 1, v2
v_mul_u32_u24 v7, 0x8000, v7
v_lshl_or_b32 v7, v7, 16, v7
v_xor_b32 v72, v7, v64
v_xor_b32 v88, v7, v80
v_xor_b32 v73, v7, v65
v_xor_b32 v89, v7, v81
v_xor_b32 v74, v7, v66
v_xor_b32 v90, v7, v82
v_xor_b32 v75, v7, v67
v_xor_b32 v91, v7, v83
v_xor_b32 v76, v7, v68
v_xor_b32 v92, v7, v84
v_xor_b32 v77, v7, v69
v_xor_b32 v93, v7, v85
v_xor_b32 v78, v7, v70
v_xor_b32 v94, v7, v86
v_xor_b32 v79, v7, v71
v_xor_b32 v95, v7, v87
buffer_load_dwordx4 v[24:27], v8, s[16:19], 0 offen sc1
s_mov_b32 s26, 165888
buffer_load_dwordx4 v[28:31], v8, s[16:19], s26 offen sc1
s_mov_b32 s26, 331776
buffer_load_dwordx4 v[32:35], v8, s[16:19], s26 offen sc1
s_mov_b32 s26, 497664
buffer_load_dwordx4 v[36:39], v8, s[16:19], s26 offen sc1
s_mov_b32 s26, 32768
buffer_load_dword v253, v252, s[12:15], s26 offen sc1
s_cmp_eq_u32 s21, 0
s_cselect_b32 s26, 1, 0
s_cmp_eq_u32 s21, 320
s_cselect_b32 s26, 1, s26
s_cmp_eq_u32 s26, 1
s_mov_b32 s26, 0x35cccccd
s_cselect_b32 s26, 0x354ccccd, s26
v_mul_f32 v198, 0x3a000000, v245
v_mul_f32 v199, v198, v246
v_mul_f32 v199, 4.0, v199
v_add_f32 v188, v198, v198
v_mul_f32 v189, 0x40400000, v198
v_cos_f32 v177, v198
v_sin_f32 v181, v198
wu_8:
s_cbranch_execz wu_ret2
v_cos_f32 v178, v188
v_sin_f32 v182, v188
v_cos_f32 v179, v189
v_sin_f32 v183, v189
v_cos_f32 v184, v199
v_sin_f32 v185, v199
    s_nop 0
v_pk_mul_f32 v[184:185], v[184:185], s[26:27] op_sel_hi:[1,0]
v_fmamk_f32 v189, v198, 0x41000000, v199
v_cos_f32 v186, v189
v_sin_f32 v187, v189
    s_nop 0
v_pk_mul_f32 v[186:187], v[186:187], s[26:27] op_sel_hi:[1,0]
v_pk_mul_f32 v[208:209], v[176:177], v[184:185] op_sel_hi:[1,0]
v_pk_mul_f32 v[224:225], v[176:177], v[184:185] op_sel:[0,1] op_sel_hi:[1,1]
v_pk_fma_f32 v[208:209], v[180:181], v[184:185], v[208:209] op_sel:[0,1,0] op_sel_hi:[1,1,1] neg_lo:[1,0,0] neg_hi:[1,0,0]
v_pk_fma_f32 v[224:225], v[180:181], v[184:185], v[224:225] op_sel:[0,0,0] op_sel_hi:[1,0,1]
v_pk_mul_f32 v[210:211], v[178:179], v[184:185] op_sel_hi:[1,0]
v_pk_mul_f32 v[226:227], v[178:179], v[184:185] op_sel:[0,1] op_sel_hi:[1,1]
v_pk_fma_f32 v[210:211], v[182:183], v[184:185], v[210:211] op_sel:[0,1,0] op_sel_hi:[1,1,1] neg_lo:[1,0,0] neg_hi:[1,0,0]
v_pk_fma_f32 v[226:227], v[182:183], v[184:185], v[226:227] op_sel:[0,0,0] op_sel_hi:[1,0,1]
v_fmamk_f32 v188, v198, 0x41800000, v199
v_cos_f32 v184, v188
v_sin_f32 v185, v188
    s_nop 0
v_pk_mul_f32 v[184:185], v[184:185], s[26:27] op_sel_hi:[1,0]
v_pk_mul_f32 v[212:213], v[176:177], v[186:187] op_sel_hi:[1,0]
v_pk_mul_f32 v[228:229], v[176:177], v[186:187] op_sel:[0,1] op_sel_hi:[1,1]
v_pk_fma_f32 v[212:213], v[180:181], v[186:187], v[212:213] op_sel:[0,1,0] op_sel_hi:[1,1,1] neg_lo:[1,0,0] neg_hi:[1,0,0]
v_pk_fma_f32 v[228:229], v[180:181], v[186:187], v[228:229] op_sel:[0,0,0] op_sel_hi:[1,0,1]
v_pk_mul_f32 v[214:215], v[178:179], v[186:187] op_sel_hi:[1,0]
v_pk_mul_f32 v[230:231], v[178:179], v[186:187] op_sel:[0,1] op_sel_hi:[1,1]
v_pk_fma_f32 v[214:215], v[182:183], v[186:187], v[214:215] op_sel:[0,1,0] op_sel_hi:[1,1,1] neg_lo:[1,0,0] neg_hi:[1,0,0]
v_pk_fma_f32 v[230:231], v[182:183], v[186:187], v[230:231] op_sel:[0,0,0] op_sel_hi:[1,0,1]
v_fmamk_f32 v189, v198, 0x41c00000, v199
v_cos_f32 v186, v189
v_sin_f32 v187, v189
    s_nop 0
v_pk_mul_f32 v[186:187], v[186:187], s[26:27] op_sel_hi:[1,0]
v_pk_mul_f32 v[216:217], v[176:177], v[184:185] op_sel_hi:[1,0]
v_pk_mul_f32 v[232:233], v[176:177], v[184:185] op_sel:[0,1] op_sel_hi:[1,1]
v_pk_fma_f32 v[216:217], v[180:181], v[184:185], v[216:217] op_sel:[0,1,0] op_sel_hi:[1,1,1] neg_lo:[1,0,0] neg_hi:[1,0,0]
v_pk_fma_f32 v[232:233], v[180:181], v[184:185], v[232:233] op_sel:[0,0,0] op_sel_hi:[1,0,1]
v_pk_mul_f32 v[218:219], v[178:179], v[184:185] op_sel_hi:[1,0]
v_pk_mul_f32 v[234:235], v[178:179], v[184:185] op_sel:[0,1] op_sel_hi:[1,1]
v_pk_fma_f32 v[218:219], v[182:183], v[184:185], v[218:219] op_sel:[0,1,0] op_sel_hi:[1,1,1] neg_lo:[1,0,0] neg_hi:[1,0,0]
v_pk_fma_f32 v[234:235], v[182:183], v[184:185], v[234:235] op_sel:[0,0,0] op_sel_hi:[1,0,1]
v_pk_mul_f32 v[220:221], v[176:177], v[186:187] op_sel_hi:[1,0]
v_pk_mul_f32 v[236:237], v[176:177], v[186:187] op_sel:[0,1] op_sel_hi:[1,1]
v_pk_fma_f32 v[220:221], v[180:181], v[186:187], v[220:221] op_sel:[0,1,0] op_sel_hi:[1,1,1] neg_lo:[1,0,0] neg_hi:[1,0,0]
v_pk_fma_f32 v[236:237], v[180:181], v[186:187], v[236:237] op_sel:[0,0,0] op_sel_hi:[1,0,1]
v_pk_mul_f32 v[222:223], v[178:179], v[186:187] op_sel_hi:[1,0]
v_pk_mul_f32 v[238:239], v[178:179], v[186:187] op_sel:[0,1] op_sel_hi:[1,1]
v_pk_fma_f32 v[222:223], v[182:183], v[186:187], v[222:223] op_sel:[0,1,0] op_sel_hi:[1,1,1] neg_lo:[1,0,0] neg_hi:[1,0,0]
v_pk_fma_f32 v[238:239], v[182:183], v[186:187], v[238:239] op_sel:[0,0,0] op_sel_hi:[1,0,1]
s_waitcnt vmcnt(0)
v_max3_u32 v255, v24, v25, v26
v_max3_u32 v255, v255, v27, v28
v_max3_u32 v255, v255, v29, v30
v_max3_u32 v255, v255, v31, v32
v_max3_u32 v255, v255, v33, v34
v_max3_u32 v255, v255, v35, v36
v_max3_u32 v255, v255, v37, v38
v_max_u32 v255, v255, v39
v_cmp_eq_u32 vcc, -1, v255
v_cmp_ne_u32 s[50:51], s55, v253
s_or_b64 vcc, vcc, s[50:51]
s_cbranch_vccz yp_11
rt_12:
buffer_load_dwordx4 v[24:27], v8, s[16:19], 0 offen sc1
s_mov_b32 s26, 165888
buffer_load_dwordx4 v[28:31], v8, s[16:19], s26 offen sc1
s_mov_b32 s26, 331776
buffer_load_dwordx4 v[32:35], v8, s[16:19], s26 offen sc1
s_mov_b32 s26, 497664
wu_9:
s_cbranch_execz wu_ret2
buffer_load_dwordx4 v[36:39], v8, s[16:19], s26 offen sc1
s_mov_b32 s26, 32768
buffer_load_dword v253, v252, s[12:15], s26 offen sc1
s_add_u32 s53, s53, 1
s_waitcnt vmcnt(0)
v_max3_u32 v255, v24, v25, v26
v_max3_u32 v255, v255, v27, v28
v_max3_u32 v255, v255, v29, v30
v_max3_u32 v255, v255, v31, v32
v_max3_u32 v255, v255, v33, v34
v_max3_u32 v255, v255, v35, v36
v_max3_u32 v255, v255, v37, v38
v_max_u32 v255, v255, v39
v_cmp_eq_u32 vcc, -1, v255
v_cmp_ne_u32 s[50:51], s55, v253
s_or_b64 vcc, vcc, s[50:51]
s_cmp_ge_u32 s53, 4000000
s_cbranch_scc1 rt_12_x
s_cbranch_vccnz rt_12
rt_12_x:
yp_11:
ds_write_b128 v9, v[24:27] offset:0
ds_write_b128 v9, v[28:31] offset:1024
ds_write_b128 v9, v[32:35] offset:2048
ds_write_b128 v9, v[36:39] offset:3072
v_lshlrev_b32 v4, 4, v1
v_add_u32 v4, s24, v4
s_waitcnt lgkmcnt(0)
s_barrier
v_mov_b32 v6, v11
v_mov_b32 v7, v12
ds_read_b128 v[8:11], v6 offset:0
ds_read_b128 v[16:19], v7 offset:0
ds_read_b128 v[12:15], v6 offset:8192
ds_read_b128 v[20:23], v7 offset:8192
buffer_load_dwordx4 v[24:27], v4, s[32:35], 0 offen offset:0 sc1
buffer_load_dwordx4 v[28:31], v4, s[32:35], 0 offen offset:1024 sc1
buffer_load_dwordx4 v[32:35], v4, s[32:35], 0 offen offset:2048 sc1
s_waitcnt lgkmcnt(2)
v_mfma_f32_32x32x16_bf16 v[128:143], v[8:11], v[40:43], 0
buffer_load_dwordx4 v[36:39], v4, s[32:35], 0 offen offset:3072 sc1
v_mfma_f32_32x32x16_bf16 v[144:159], v[16:19], v[40:43], 0
s_mov_b32 s28, s6
s_mov_b32 s29, s7
s_mov_b32 s30, 0x280000
s_mov_b32 s31, 0x20000
v_mfma_f32_32x32x16_bf16 v[128:143], v[16:19], v[48:51], v[128:143]
s_mov_b32 s81, 81920
v_mfma_f32_32x32x16_bf16 v[144:159], v[8:11], v[56:59], v[144:159]
s_waitcnt lgkmcnt(0)
v_mfma_f32_32x32x16_bf16 v[128:143], v[12:15], v[44:47], v[128:143]
buffer_load_dwordx2 a[0:1], v249, s[28:31], 0 offen offset:0
v_mfma_f32_32x32x16_bf16 v[144:159], v[20:23], v[44:47], v[144:159]
buffer_load_dwordx2 a[2:3], v249, s[28:31], 0 offen offset:16
v_mfma_f32_32x32x16_bf16 v[128:143], v[20:23], v[52:55], v[128:143]
buffer_load_dwordx2 a[4:5], v249, s[28:31], 0 offen offset:32
v_mfma_f32_32x32x16_bf16 v[144:159], v[12:15], v[60:63], v[144:159]
s_lshl_b32 s26, s3, 12
s_add_u32 s26, s26, 114688
s_xor_b32 s27, s26, 0x1000
v_lshlrev_b32 v6, 4, v1
v_add_u32 v7, s27, v6
v_add_u32 v6, s26, v6
    s_nop 3
v_pk_mul_f32 v[240:241], v[128:129], v[96:97]
    s_nop 0
v_pk_mul_f32 v[242:243], v[144:145], v[96:97]
v_pk_fma_f32 v[240:241], v[144:145], v[112:113], v[240:241]
v_pk_fma_f32 v[242:243], v[128:129], v[112:113], v[242:243] neg_lo:[1,0,0] neg_hi:[1,0,0]
v_cvt_pk_bf16_f32 v160, v240, v241
v_cvt_pk_bf16_f32 v168, v242, v243
buffer_load_dwordx2 a[6:7], v249, s[28:31], s81 offen offset:0
v_pk_mul_f32 v[240:241], v[130:131], v[98:99]
v_pk_mul_f32 v[242:243], v[146:147], v[98:99]
v_pk_fma_f32 v[240:241], v[146:147], v[114:115], v[240:241]
v_pk_fma_f32 v[242:243], v[130:131], v[114:115], v[242:243] neg_lo:[1,0,0] neg_hi:[1,0,0]
v_cvt_pk_bf16_f32 v161, v240, v241
wu_10:
s_cbranch_execz wu_ret2
v_cvt_pk_bf16_f32 v169, v242, v243
buffer_load_dwordx2 a[8:9], v249, s[28:31], s81 offen offset:16
v_pk_mul_f32 v[240:241], v[132:133], v[100:101]
v_pk_mul_f32 v[242:243], v[148:149], v[100:101]
v_pk_fma_f32 v[240:241], v[148:149], v[116:117], v[240:241]
v_pk_fma_f32 v[242:243], v[132:133], v[116:117], v[242:243] neg_lo:[1,0,0] neg_hi:[1,0,0]
v_cvt_pk_bf16_f32 v162, v240, v241
v_cvt_pk_bf16_f32 v170, v242, v243
buffer_load_dwordx2 a[10:11], v249, s[28:31], s81 offen offset:32
v_pk_mul_f32 v[240:241], v[134:135], v[102:103]
v_pk_mul_f32 v[242:243], v[150:151], v[102:103]
v_pk_fma_f32 v[240:241], v[150:151], v[118:119], v[240:241]
v_pk_fma_f32 v[242:243], v[134:135], v[118:119], v[242:243] neg_lo:[1,0,0] neg_hi:[1,0,0]
v_cvt_pk_bf16_f32 v163, v240, v241
v_cvt_pk_bf16_f32 v171, v242, v243
s_mov_b32 s44, s4
s_mov_b32 s45, s5
s_mov_b32 s46, 0x3c00
s_mov_b32 s47, 0x20000
v_lshlrev_b32 v255, 4, v1
s_lshl_b32 s83, s3, 11
v_pk_mul_f32 v[240:241], v[136:137], v[104:105]
v_pk_mul_f32 v[242:243], v[152:153], v[104:105]
v_pk_fma_f32 v[240:241], v[152:153], v[120:121], v[240:241]
v_pk_fma_f32 v[242:243], v[136:137], v[120:121], v[242:243] neg_lo:[1,0,0] neg_hi:[1,0,0]
v_cvt_pk_bf16_f32 v164, v240, v241
v_cvt_pk_bf16_f32 v172, v242, v243
s_add_u32 m0, s83, 148864
s_add_u32 s43, s83, 5120
buffer_load_dwordx4 v255, s[44:47], s43 offen sc1 lds
v_pk_mul_f32 v[240:241], v[138:139], v[106:107]
v_pk_mul_f32 v[242:243], v[154:155], v[106:107]
v_pk_fma_f32 v[240:241], v[154:155], v[122:123], v[240:241]
v_pk_fma_f32 v[242:243], v[138:139], v[122:123], v[242:243] neg_lo:[1,0,0] neg_hi:[1,0,0]
v_cvt_pk_bf16_f32 v165, v240, v241
v_cvt_pk_bf16_f32 v173, v242, v243
s_add_u32 m0, s83, 149888
s_add_u32 s43, s83, 6144
buffer_load_dwordx4 v255, s[44:47], s43 offen sc1 lds
v_pk_mul_f32 v[240:241], v[140:141], v[108:109]
v_pk_mul_f32 v[242:243], v[156:157], v[108:109]
v_pk_fma_f32 v[240:241], v[156:157], v[124:125], v[240:241]
v_pk_fma_f32 v[242:243], v[140:141], v[124:125], v[242:243] neg_lo:[1,0,0] neg_hi:[1,0,0]
v_cvt_pk_bf16_f32 v166, v240, v241
v_cvt_pk_bf16_f32 v174, v242, v243
v_pk_mul_f32 v[240:241], v[142:143], v[110:111]
v_pk_mul_f32 v[242:243], v[158:159], v[110:111]
v_pk_fma_f32 v[240:241], v[158:159], v[126:127], v[240:241]
v_pk_fma_f32 v[242:243], v[142:143], v[126:127], v[242:243] neg_lo:[1,0,0] neg_hi:[1,0,0]
v_cvt_pk_bf16_f32 v167, v240, v241
v_cvt_pk_bf16_f32 v175, v242, v243
ds_write_b128 v6, v[160:163] offset:16384
ds_write_b128 v6, v[168:171] offset:18432
ds_write_b128 v6, v[164:167] offset:17408
ds_write_b128 v6, v[172:175] offset:19456
s_waitcnt lgkmcnt(0)
s_barrier
ds_read_b128 v[184:187], v7 offset:16384
ds_read_b128 v[192:195], v7 offset:18432
ds_read_b128 v[188:191], v7 offset:17408
ds_read_b128 v[196:199], v7 offset:19456
v_xor_b32 v176, 0x80008000, v160
v_xor_b32 v177, 0x80008000, v161
v_xor_b32 v178, 0x80008000, v162
v_xor_b32 v179, 0x80008000, v163
v_xor_b32 v180, 0x80008000, v164
v_xor_b32 v181, 0x80008000, v165
wu_11:
s_cbranch_execz wu_ret2
v_xor_b32 v182, 0x80008000, v166
v_xor_b32 v183, 0x80008000, v167
v_mfma_f32_32x32x16_bf16 v[128:143], v[64:67], v[160:163], 0
v_mfma_f32_32x32x16_bf16 v[144:159], v[64:67], v[168:171], 0
v_mfma_f32_32x32x16_bf16 v[128:143], v[80:83], v[168:171], v[128:143]
v_mfma_f32_32x32x16_bf16 v[144:159], v[80:83], v[176:179], v[144:159]
v_mfma_f32_32x32x16_bf16 v[128:143], v[68:71], v[164:167], v[128:143]
v_mfma_f32_32x32x16_bf16 v[144:159], v[68:71], v[172:175], v[144:159]
v_mfma_f32_32x32x16_bf16 v[128:143], v[84:87], v[172:175], v[128:143]
v_mfma_f32_32x32x16_bf16 v[144:159], v[84:87], v[180:183], v[144:159]
s_waitcnt lgkmcnt(0)
v_xor_b32 v200, 0x80008000, v184
v_xor_b32 v201, 0x80008000, v185
v_xor_b32 v202, 0x80008000, v186
v_xor_b32 v203, 0x80008000, v187
v_xor_b32 v204, 0x80008000, v188
v_xor_b32 v205, 0x80008000, v189
v_xor_b32 v206, 0x80008000, v190
v_xor_b32 v207, 0x80008000, v191
v_mfma_f32_32x32x16_bf16 v[128:143], v[72:75], v[184:187], v[128:143]
v_mfma_f32_32x32x16_bf16 v[144:159], v[72:75], v[192:195], v[144:159]
v_mfma_f32_32x32x16_bf16 v[128:143], v[88:91], v[192:195], v[128:143]
v_mfma_f32_32x32x16_bf16 v[144:159], v[88:91], v[200:203], v[144:159]
v_mfma_f32_32x32x16_bf16 v[128:143], v[76:79], v[188:191], v[128:143]
v_mfma_f32_32x32x16_bf16 v[144:159], v[76:79], v[196:199], v[144:159]
v_mfma_f32_32x32x16_bf16 v[128:143], v[92:95], v[196:199], v[128:143]
v_mfma_f32_32x32x16_bf16 v[144:159], v[92:95], v[204:207], v[144:159]
s_waitcnt vmcnt(8)
v_lshlrev_b32 v8, 16, v24
v_lshlrev_b32 v9, 16, v25
v_and_b32 v10, 0xffff0000, v24
v_and_b32 v11, 0xffff0000, v25
    s_nop 5
v_pk_mul_f32 v[240:241], v[128:129], v[8:9]
v_pk_mul_f32 v[242:243], v[144:145], v[8:9]
v_pk_fma_f32 v[240:241], v[144:145], v[10:11], v[240:241] neg_lo:[1,0,0] neg_hi:[1,0,0]
v_pk_fma_f32 v[242:243], v[128:129], v[10:11], v[242:243]
v_cvt_pk_bf16_f32 v160, v240, v241
v_cvt_pk_bf16_f32 v168, v242, v243
v_lshlrev_b32 v8, 16, v26
v_lshlrev_b32 v9, 16, v27
v_and_b32 v10, 0xffff0000, v26
v_and_b32 v11, 0xffff0000, v27
v_pk_mul_f32 v[240:241], v[130:131], v[8:9]
v_pk_mul_f32 v[242:243], v[146:147], v[8:9]
v_pk_fma_f32 v[240:241], v[146:147], v[10:11], v[240:241] neg_lo:[1,0,0] neg_hi:[1,0,0]
v_pk_fma_f32 v[242:243], v[130:131], v[10:11], v[242:243]
v_cvt_pk_bf16_f32 v161, v240, v241
v_cvt_pk_bf16_f32 v169, v242, v243
v_lshlrev_b32 v8, 16, v28
v_lshlrev_b32 v9, 16, v29
v_and_b32 v10, 0xffff0000, v28
v_and_b32 v11, 0xffff0000, v29
v_pk_mul_f32 v[240:241], v[132:133], v[8:9]
v_pk_mul_f32 v[242:243], v[148:149], v[8:9]
v_pk_fma_f32 v[240:241], v[148:149], v[10:11], v[240:241] neg_lo:[1,0,0] neg_hi:[1,0,0]
v_pk_fma_f32 v[242:243], v[132:133], v[10:11], v[242:243]
v_cvt_pk_bf16_f32 v162, v240, v241
v_cvt_pk_bf16_f32 v170, v242, v243
v_lshlrev_b32 v8, 16, v30
v_lshlrev_b32 v9, 16, v31
v_and_b32 v10, 0xffff0000, v30
v_and_b32 v11, 0xffff0000, v31
v_pk_mul_f32 v[240:241], v[134:135], v[8:9]
v_pk_mul_f32 v[242:243], v[150:151], v[8:9]
v_pk_fma_f32 v[240:241], v[150:151], v[10:11], v[240:241] neg_lo:[1,0,0] neg_hi:[1,0,0]
v_pk_fma_f32 v[242:243], v[134:135], v[10:11], v[242:243]
v_cvt_pk_bf16_f32 v163, v240, v241
v_cvt_pk_bf16_f32 v171, v242, v243
wu_12:
s_cbranch_execz wu_ret2
v_lshlrev_b32 v8, 16, v32
v_lshlrev_b32 v9, 16, v33
v_and_b32 v10, 0xffff0000, v32
v_and_b32 v11, 0xffff0000, v33
v_pk_mul_f32 v[240:241], v[136:137], v[8:9]
v_pk_mul_f32 v[242:243], v[152:153], v[8:9]
v_pk_fma_f32 v[240:241], v[152:153], v[10:11], v[240:241] neg_lo:[1,0,0] neg_hi:[1,0,0]
v_pk_fma_f32 v[242:243], v[136:137], v[10:11], v[242:243]
v_cvt_pk_bf16_f32 v164, v240, v241
v_cvt_pk_bf16_f32 v172, v242, v243
v_lshlrev_b32 v8, 16, v34
v_lshlrev_b32 v9, 16, v35
v_and_b32 v10, 0xffff0000, v34
v_and_b32 v11, 0xffff0000, v35
v_pk_mul_f32 v[240:241], v[138:139], v[8:9]
v_pk_mul_f32 v[242:243], v[154:155], v[8:9]
v_pk_fma_f32 v[240:241], v[154:155], v[10:11], v[240:241] neg_lo:[1,0,0] neg_hi:[1,0,0]
v_pk_fma_f32 v[242:243], v[138:139], v[10:11], v[242:243]
v_cvt_pk_bf16_f32 v165, v240, v241
v_cvt_pk_bf16_f32 v173, v242, v243
v_lshlrev_b32 v8, 16, v36
v_lshlrev_b32 v9, 16, v37
v_and_b32 v10, 0xffff0000, v36
v_and_b32 v11, 0xffff0000, v37
v_pk_mul_f32 v[240:241], v[140:141], v[8:9]
v_pk_mul_f32 v[242:243], v[156:157], v[8:9]
v_pk_fma_f32 v[240:241], v[156:157], v[10:11], v[240:241] neg_lo:[1,0,0] neg_hi:[1,0,0]
v_pk_fma_f32 v[242:243], v[140:141], v[10:11], v[242:243]
v_cvt_pk_bf16_f32 v166, v240, v241
v_cvt_pk_bf16_f32 v174, v242, v243
v_lshlrev_b32 v8, 16, v38
v_lshlrev_b32 v9, 16, v39
v_and_b32 v10, 0xffff0000, v38
v_and_b32 v11, 0xffff0000, v39
v_pk_mul_f32 v[240:241], v[142:143], v[8:9]
v_pk_mul_f32 v[242:243], v[158:159], v[8:9]
v_pk_fma_f32 v[240:241], v[158:159], v[10:11], v[240:241] neg_lo:[1,0,0] neg_hi:[1,0,0]
v_pk_fma_f32 v[242:243], v[142:143], v[10:11], v[242:243]
v_cvt_pk_bf16_f32 v167, v240, v241
v_cvt_pk_bf16_f32 v175, v242, v243
ds_write_b128 v6, v[160:163] offset:0
ds_write_b128 v6, v[168:171] offset:2048
ds_write_b128 v6, v[164:167] offset:1024
ds_write_b128 v6, v[172:175] offset:3072
s_waitcnt lgkmcnt(0)
s_barrier
ds_read_b128 v[184:187], v7 offset:0
ds_read_b128 v[192:195], v7 offset:2048
ds_read_b128 v[188:191], v7 offset:1024
ds_read_b128 v[196:199], v7 offset:3072
v_xor_b32 v176, 0x80008000, v168
v_xor_b32 v177, 0x80008000, v169
v_xor_b32 v178, 0x80008000, v170
v_xor_b32 v179, 0x80008000, v171
v_xor_b32 v180, 0x80008000, v172
v_xor_b32 v181, 0x80008000, v173
v_xor_b32 v182, 0x80008000, v174
v_xor_b32 v183, 0x80008000, v175
v_mfma_f32_32x32x16_bf16 v[128:143], v[160:163], v[64:67], 0
v_mfma_f32_32x32x16_bf16 v[144:159], v[168:171], v[64:67], 0
v_mfma_f32_32x32x16_bf16 v[128:143], v[176:179], v[80:83], v[128:143]
v_mfma_f32_32x32x16_bf16 v[144:159], v[160:163], v[80:83], v[144:159]
v_mfma_f32_32x32x16_bf16 v[128:143], v[164:167], v[68:71], v[128:143]
v_mfma_f32_32x32x16_bf16 v[144:159], v[172:175], v[68:71], v[144:159]
v_mfma_f32_32x32x16_bf16 v[128:143], v[180:183], v[84:87], v[128:143]
v_mfma_f32_32x32x16_bf16 v[144:159], v[164:167], v[84:87], v[144:159]
s_waitcnt lgkmcnt(0)
v_xor_b32 v200, 0x80008000, v192
v_xor_b32 v201, 0x80008000, v193
wu_13:
s_cbranch_execz wu_ret2
v_xor_b32 v202, 0x80008000, v194
v_xor_b32 v203, 0x80008000, v195
v_xor_b32 v204, 0x80008000, v196
v_xor_b32 v205, 0x80008000, v197
v_xor_b32 v206, 0x80008000, v198
v_xor_b32 v207, 0x80008000, v199
v_mfma_f32_32x32x16_bf16 v[128:143], v[184:187], v[72:75], v[128:143]
v_mfma_f32_32x32x16_bf16 v[144:159], v[192:195], v[72:75], v[144:159]
v_mfma_f32_32x32x16_bf16 v[128:143], v[200:203], v[88:91], v[128:143]
v_mfma_f32_32x32x16_bf16 v[144:159], v[184:187], v[88:91], v[144:159]
v_mfma_f32_32x32x16_bf16 v[128:143], v[188:191], v[76:79], v[128:143]
v_mfma_f32_32x32x16_bf16 v[144:159], v[196:199], v[76:79], v[144:159]
v_mfma_f32_32x32x16_bf16 v[128:143], v[204:207], v[92:95], v[128:143]
v_mfma_f32_32x32x16_bf16 v[144:159], v[188:191], v[92:95], v[144:159]
    s_nop 10
v_pk_mul_f32 v[240:241], v[128:129], v[208:209]
v_pk_mul_f32 v[242:243], v[144:145], v[208:209]
v_pk_fma_f32 v[240:241], v[144:145], v[224:225], v[240:241] neg_lo:[1,0,0] neg_hi:[1,0,0]
v_pk_fma_f32 v[242:243], v[128:129], v[224:225], v[242:243]
v_cvt_pk_bf16_f32 v160, v240, v241
v_cvt_pk_bf16_f32 v168, v242, v243
v_pk_mul_f32 v[240:241], v[130:131], v[210:211]
v_pk_mul_f32 v[242:243], v[146:147], v[210:211]
v_pk_fma_f32 v[240:241], v[146:147], v[226:227], v[240:241] neg_lo:[1,0,0] neg_hi:[1,0,0]
v_pk_fma_f32 v[242:243], v[130:131], v[226:227], v[242:243]
v_cvt_pk_bf16_f32 v161, v240, v241
v_cvt_pk_bf16_f32 v169, v242, v243
v_pk_mul_f32 v[240:241], v[132:133], v[212:213]
v_pk_mul_f32 v[242:243], v[148:149], v[212:213]
v_pk_fma_f32 v[240:241], v[148:149], v[228:229], v[240:241] neg_lo:[1,0,0] neg_hi:[1,0,0]
v_pk_fma_f32 v[242:243], v[132:133], v[228:229], v[242:243]
v_cvt_pk_bf16_f32 v162, v240, v241
v_cvt_pk_bf16_f32 v170, v242, v243
v_pk_mul_f32 v[240:241], v[134:135], v[214:215]
v_pk_mul_f32 v[242:243], v[150:151], v[214:215]
v_pk_fma_f32 v[240:241], v[150:151], v[230:231], v[240:241] neg_lo:[1,0,0] neg_hi:[1,0,0]
v_pk_fma_f32 v[242:243], v[134:135], v[230:231], v[242:243]
v_cvt_pk_bf16_f32 v163, v240, v241
v_cvt_pk_bf16_f32 v171, v242, v243
v_pk_mul_f32 v[240:241], v[136:137], v[216:217]
v_pk_mul_f32 v[242:243], v[152:153], v[216:217]
v_pk_fma_f32 v[240:241], v[152:153], v[232:233], v[240:241] neg_lo:[1,0,0] neg_hi:[1,0,0]
v_pk_fma_f32 v[242:243], v[136:137], v[232:233], v[242:243]
v_cvt_pk_bf16_f32 v164, v240, v241
v_cvt_pk_bf16_f32 v172, v242, v243
v_pk_mul_f32 v[240:241], v[138:139], v[218:219]
v_pk_mul_f32 v[242:243], v[154:155], v[218:219]
v_pk_fma_f32 v[240:241], v[154:155], v[234:235], v[240:241] neg_lo:[1,0,0] neg_hi:[1,0,0]
v_pk_fma_f32 v[242:243], v[138:139], v[234:235], v[242:243]
v_cvt_pk_bf16_f32 v165, v240, v241
v_cvt_pk_bf16_f32 v173, v242, v243
v_pk_mul_f32 v[240:241], v[140:141], v[220:221]
v_pk_mul_f32 v[242:243], v[156:157], v[220:221]
v_pk_fma_f32 v[240:241], v[156:157], v[236:237], v[240:241] neg_lo:[1,0,0] neg_hi:[1,0,0]
v_pk_fma_f32 v[242:243], v[140:141], v[236:237], v[242:243]
v_cvt_pk_bf16_f32 v166, v240, v241
v_cvt_pk_bf16_f32 v174, v242, v243
v_pk_mul_f32 v[240:241], v[142:143], v[222:223]
v_pk_mul_f32 v[242:243], v[158:159], v[222:223]
v_pk_fma_f32 v[240:241], v[158:159], v[238:239], v[240:241] neg_lo:[1,0,0] neg_hi:[1,0,0]
v_pk_fma_f32 v[242:243], v[142:143], v[238:239], v[242:243]
v_cvt_pk_bf16_f32 v167, v240, v241
v_cvt_pk_bf16_f32 v175, v242, v243
v_mfma_f32_32x32x16_bf16 v[128:143], v[40:43], v[160:163], 0
wu_14:
s_cbranch_execz wu_ret2
v_mfma_f32_32x32x16_bf16 v[144:159], v[40:43], v[168:171], 0
v_mfma_f32_32x32x16_bf16 v[128:143], v[56:59], v[168:171], v[128:143]
v_mfma_f32_32x32x16_bf16 v[144:159], v[48:51], v[160:163], v[144:159]
v_mfma_f32_32x32x16_bf16 v[128:143], v[44:47], v[164:167], v[128:143]
v_mfma_f32_32x32x16_bf16 v[144:159], v[44:47], v[172:175], v[144:159]
v_mfma_f32_32x32x16_bf16 v[128:143], v[60:63], v[172:175], v[128:143]
v_mfma_f32_32x32x16_bf16 v[144:159], v[52:55], v[164:167], v[144:159]
v_lshlrev_b32 v4, 5, v2
v_lshl_add_u32 v4, v3, 4, v4
v_add_u32 v4, s24, v4
s_waitcnt vmcnt(2)
    s_nop 7
v_cvt_pk_bf16_f32 v8, v128, v144
v_cvt_pk_bf16_f32 v9, v129, v145
v_cvt_pk_bf16_f32 v10, v130, v146
v_cvt_pk_bf16_f32 v11, v131, v147
buffer_store_dwordx4 v[8:11], v4, s[36:39], 0 offen offset:0 sc0 sc1
v_cvt_pk_bf16_f32 v12, v132, v148
v_cvt_pk_bf16_f32 v13, v133, v149
v_cvt_pk_bf16_f32 v14, v134, v150
v_cvt_pk_bf16_f32 v15, v135, v151
buffer_store_dwordx4 v[12:15], v4, s[36:39], 0 offen offset:1024 sc0 sc1
v_cvt_pk_bf16_f32 v16, v136, v152
v_cvt_pk_bf16_f32 v17, v137, v153
v_cvt_pk_bf16_f32 v18, v138, v154
v_cvt_pk_bf16_f32 v19, v139, v155
buffer_store_dwordx4 v[16:19], v4, s[36:39], 0 offen offset:2048 sc0 sc1
v_cvt_pk_bf16_f32 v20, v140, v156
v_cvt_pk_bf16_f32 v21, v141, v157
v_cvt_pk_bf16_f32 v22, v142, v158
v_cvt_pk_bf16_f32 v23, v143, v159
buffer_store_dwordx4 v[20:23], v4, s[36:39], 0 offen offset:3072 sc0 sc1
s_barrier
s_branch b_done_9
b_skip_8:
s_mov_b32 s28, s6
s_mov_b32 s29, s7
s_mov_b32 s30, 0x280000
s_mov_b32 s31, 0x20000
s_mov_b32 s81, 81920
buffer_load_dwordx2 a[0:1], v249, s[28:31], 0 offen offset:0
buffer_load_dwordx2 a[2:3], v249, s[28:31], 0 offen offset:16
buffer_load_dwordx2 a[4:5], v249, s[28:31], 0 offen offset:32
buffer_load_dwordx2 a[6:7], v249, s[28:31], s81 offen offset:0
buffer_load_dwordx2 a[8:9], v249, s[28:31], s81 offen offset:16
buffer_load_dwordx2 a[10:11], v249, s[28:31], s81 offen offset:32
s_waitcnt vmcnt(9)
s_barrier
s_cmp_lg_u32 s3, 0
s_cbranch_scc1 fl_13
s_lshl_b32 s50, s2, 5
s_add_u32 s50, s50, 32768
v_mov_b32 v8, s50
v_mov_b32 v9, s55
s_mov_b64 exec, 1
buffer_store_dword v9, v8, s[12:15], 0 offen sc0 sc1
s_mov_b64 exec, -1
fl_13:
v_lshrrev_b32 v4, 3, v1
v_and_b32 v5, 7, v1
v_bfe_u32 v6, v1, 4, 1
v_lshrrev_b32 v7, 5, v1
v_lshlrev_b32 v6, 1, v6
v_lshl_or_b32 v6, v7, 2, v6
v_xor_b32 v7, 4, v6
v_xor_b32 v6, v5, v6
v_xor_b32 v7, v5, v7
s_mul_i32 s83, s3, 20480
s_sub_u32 s43, s2, 161
s_lshl_b32 s43, s43, 2
s_add_u32 s43, s43, s3
s_cmp_ge_u32 s43, 540
s_cselect_b32 s36, 1, 0
s_cmp_ge_u32 s43, 1080
s_cselect_b32 s36, 2, s36
s_mul_i32 s44, s36, 540
s_sub_u32 s44, s43, s44
s_cmp_eq_u32 s36, 2
s_mov_b32 s37, 3456
s_cselect_b32 s37, 1280, s37
wu_15:
s_cbranch_execz wu_ret2
s_mov_b32 s40, 2048
s_cselect_b32 s40, 1024, s40
s_mov_b32 s41, 8
s_cselect_b32 s41, 4, s41
s_mov_b32 s42, 4
s_cselect_b32 s42, 16, s42
s_mov_b32 s45, 2428
s_cselect_b32 s45, 6554, s45
s_mov_b32 s38, 27
s_cselect_b32 s38, 10, s38
s_mov_b32 s39, 221184
s_cselect_b32 s39, 40960, s39
s_mul_i32 s45, s45, s44
s_lshr_b32 s45, s45, 16
s_mul_i32 s38, s38, s45
s_sub_u32 s44, s44, s38
s_mul_i32 s39, s39, s45
s_mul_i32 s38, s45, s37
s_lshl_b32 s38, s38, 5
s_lshl_b32 s45, s44, 7
s_add_u32 s38, s38, s45
s_cmp_eq_u32 s36, 2
s_mov_b32 s45, 8192
s_cselect_b32 s45, 4096, s45
s_mul_i32 s45, s45, s44
s_add_u32 s39, s39, s45
s_cmp_eq_u32 s36, 1
s_cselect_b32 s45, 1024, 0
s_add_u32 s39, s39, s45
s_cmp_lt_u32 s43, 1620
s_cselect_b32 s38, s38, 0x40000000
s_cselect_b32 s39, s39, 0x40000000
s_cmp_eq_u32 s36, 0
s_cselect_b32 s32, s20, s22
s_cselect_b32 s33, s21, s23
s_cmp_eq_u32 s36, 2
s_cselect_b32 s32, s24, s32
s_cselect_b32 s33, s25, s33
s_mov_b32 s34, 2211840
s_mov_b32 s35, 0x20000
v_mul_lo_u32 v59, v4, s37
v_lshl_add_u32 v232, v6, 4, v59
v_lshl_add_u32 v233, v7, 4, v59
s_lshl_b32 s27, s37, 3
s_add_u32 m0, s83, 45056
    s_nop 0
buffer_load_dwordx4 v232, s[32:35], s38 offen lds
s_add_u32 s38, s38, s27
s_add_u32 m0, s83, 46080
    s_nop 0
buffer_load_dwordx4 v233, s[32:35], s38 offen lds
s_add_u32 s38, s38, s27
s_add_u32 m0, s83, 47104
    s_nop 0
buffer_load_dwordx4 v232, s[32:35], s38 offen lds
s_add_u32 s38, s38, s27
s_add_u32 m0, s83, 48128
    s_nop 0
buffer_load_dwordx4 v233, s[32:35], s38 offen lds
s_mov_b32 s16, s36
s_mov_b32 s29, s39
s_sub_u32 s43, s2, 161
s_lshl_b32 s43, s43, 2
s_add_u32 s43, s43, s3
s_add_u32 s43, s43, 380
s_cmp_ge_u32 s43, 540
s_cselect_b32 s36, 1, 0
s_cmp_ge_u32 s43, 1080
s_cselect_b32 s36, 2, s36
s_mul_i32 s44, s36, 540
s_sub_u32 s44, s43, s44
s_cmp_eq_u32 s36, 2
s_mov_b32 s37, 3456
s_cselect_b32 s37, 1280, s37
s_mov_b32 s40, 2048
s_cselect_b32 s40, 1024, s40
s_mov_b32 s41, 8
s_cselect_b32 s41, 4, s41
s_mov_b32 s42, 4
s_cselect_b32 s42, 16, s42
s_mov_b32 s45, 2428
s_cselect_b32 s45, 6554, s45
s_mov_b32 s38, 27
s_cselect_b32 s38, 10, s38
s_mov_b32 s39, 221184
s_cselect_b32 s39, 40960, s39
s_mul_i32 s45, s45, s44
s_lshr_b32 s45, s45, 16
s_mul_i32 s38, s38, s45
s_sub_u32 s44, s44, s38
s_mul_i32 s39, s39, s45
wu_16:
s_cbranch_execz wu_ret2
s_mul_i32 s38, s45, s37
s_lshl_b32 s38, s38, 5
s_lshl_b32 s45, s44, 7
s_add_u32 s38, s38, s45
s_cmp_eq_u32 s36, 2
s_mov_b32 s45, 8192
s_cselect_b32 s45, 4096, s45
s_mul_i32 s45, s45, s44
s_add_u32 s39, s39, s45
s_cmp_eq_u32 s36, 1
s_cselect_b32 s45, 1024, 0
s_add_u32 s39, s39, s45
s_cmp_lt_u32 s43, 1620
s_cselect_b32 s38, s38, 0x40000000
s_cselect_b32 s39, s39, 0x40000000
s_cmp_eq_u32 s36, 0
s_cselect_b32 s32, s20, s22
s_cselect_b32 s33, s21, s23
s_cmp_eq_u32 s36, 2
s_cselect_b32 s32, s24, s32
s_cselect_b32 s33, s25, s33
s_mov_b32 s34, 2211840
s_mov_b32 s35, 0x20000
v_mul_lo_u32 v59, v4, s37
v_lshl_add_u32 v232, v6, 4, v59
v_lshl_add_u32 v233, v7, 4, v59
s_lshl_b32 s27, s37, 3
s_add_u32 m0, s83, 49152
    s_nop 0
buffer_load_dwordx4 v232, s[32:35], s38 offen lds
s_add_u32 s38, s38, s27
s_add_u32 m0, s83, 50176
    s_nop 0
buffer_load_dwordx4 v233, s[32:35], s38 offen lds
s_add_u32 s38, s38, s27
s_add_u32 m0, s83, 51200
    s_nop 0
buffer_load_dwordx4 v232, s[32:35], s38 offen lds
s_add_u32 s38, s38, s27
s_add_u32 m0, s83, 52224
    s_nop 0
buffer_load_dwordx4 v233, s[32:35], s38 offen lds
s_mov_b32 s17, s36
s_mov_b32 s30, s39
s_sub_u32 s43, s2, 161
s_lshl_b32 s43, s43, 2
s_add_u32 s43, s43, s3
s_add_u32 s43, s43, 760
s_cmp_ge_u32 s43, 540
s_cselect_b32 s36, 1, 0
s_cmp_ge_u32 s43, 1080
s_cselect_b32 s36, 2, s36
s_mul_i32 s44, s36, 540
s_sub_u32 s44, s43, s44
s_cmp_eq_u32 s36, 2
s_mov_b32 s37, 3456
s_cselect_b32 s37, 1280, s37
s_mov_b32 s40, 2048
s_cselect_b32 s40, 1024, s40
s_mov_b32 s41, 8
s_cselect_b32 s41, 4, s41
s_mov_b32 s42, 4
s_cselect_b32 s42, 16, s42
s_mov_b32 s45, 2428
s_cselect_b32 s45, 6554, s45
s_mov_b32 s38, 27
s_cselect_b32 s38, 10, s38
s_mov_b32 s39, 221184
s_cselect_b32 s39, 40960, s39
s_mul_i32 s45, s45, s44
s_lshr_b32 s45, s45, 16
s_mul_i32 s38, s38, s45
s_sub_u32 s44, s44, s38
s_mul_i32 s39, s39, s45
s_mul_i32 s38, s45, s37
s_lshl_b32 s38, s38, 5
s_lshl_b32 s45, s44, 7
s_add_u32 s38, s38, s45
s_cmp_eq_u32 s36, 2
s_mov_b32 s45, 8192
s_cselect_b32 s45, 4096, s45
s_mul_i32 s45, s45, s44
s_add_u32 s39, s39, s45
s_cmp_eq_u32 s36, 1
s_cselect_b32 s45, 1024, 0
s_add_u32 s39, s39, s45
s_cmp_lt_u32 s43, 1620
s_cselect_b32 s38, s38, 0x40000000
s_cselect_b32 s39, s39, 0x40000000
s_cmp_eq_u32 s36, 0
s_cselect_b32 s32, s20, s22
s_cselect_b32 s33, s21, s23
s_cmp_eq_u32 s36, 2
wu_17:
s_cbranch_execz wu_ret2
s_cselect_b32 s32, s24, s32
s_cselect_b32 s33, s25, s33
s_mov_b32 s34, 2211840
s_mov_b32 s35, 0x20000
v_mul_lo_u32 v59, v4, s37
v_lshl_add_u32 v232, v6, 4, v59
v_lshl_add_u32 v233, v7, 4, v59
s_lshl_b32 s27, s37, 3
s_add_u32 m0, s83, 53248
    s_nop 0
buffer_load_dwordx4 v232, s[32:35], s38 offen lds
s_add_u32 s38, s38, s27
s_add_u32 m0, s83, 54272
    s_nop 0
buffer_load_dwordx4 v233, s[32:35], s38 offen lds
s_add_u32 s38, s38, s27
s_add_u32 m0, s83, 55296
    s_nop 0
buffer_load_dwordx4 v232, s[32:35], s38 offen lds
s_add_u32 s38, s38, s27
s_add_u32 m0, s83, 56320
    s_nop 0
buffer_load_dwordx4 v233, s[32:35], s38 offen lds
s_mov_b32 s18, s36
s_mov_b32 s31, s39
s_sub_u32 s43, s2, 161
s_lshl_b32 s43, s43, 2
s_add_u32 s43, s43, s3
s_add_u32 s43, s43, 1140
s_cmp_ge_u32 s43, 540
s_cselect_b32 s36, 1, 0
s_cmp_ge_u32 s43, 1080
s_cselect_b32 s36, 2, s36
s_mul_i32 s44, s36, 540
s_sub_u32 s44, s43, s44
s_cmp_eq_u32 s36, 2
s_mov_b32 s37, 3456
s_cselect_b32 s37, 1280, s37
s_mov_b32 s40, 2048
s_cselect_b32 s40, 1024, s40
s_mov_b32 s41, 8
s_cselect_b32 s41, 4, s41
s_mov_b32 s42, 4
s_cselect_b32 s42, 16, s42
s_mov_b32 s45, 2428
s_cselect_b32 s45, 6554, s45
s_mov_b32 s38, 27
s_cselect_b32 s38, 10, s38
s_mov_b32 s39, 221184
s_cselect_b32 s39, 40960, s39
s_mul_i32 s45, s45, s44
s_lshr_b32 s45, s45, 16
s_mul_i32 s38, s38, s45
s_sub_u32 s44, s44, s38
s_mul_i32 s39, s39, s45
s_mul_i32 s38, s45, s37
s_lshl_b32 s38, s38, 5
s_lshl_b32 s45, s44, 7
s_add_u32 s38, s38, s45
s_cmp_eq_u32 s36, 2
s_mov_b32 s45, 8192
s_cselect_b32 s45, 4096, s45
s_mul_i32 s45, s45, s44
s_add_u32 s39, s39, s45
s_cmp_eq_u32 s36, 1
s_cselect_b32 s45, 1024, 0
s_add_u32 s39, s39, s45
s_cmp_lt_u32 s43, 1620
s_cselect_b32 s38, s38, 0x40000000
s_cselect_b32 s39, s39, 0x40000000
s_cmp_eq_u32 s36, 0
s_cselect_b32 s32, s20, s22
s_cselect_b32 s33, s21, s23
s_cmp_eq_u32 s36, 2
s_cselect_b32 s32, s24, s32
s_cselect_b32 s33, s25, s33
s_mov_b32 s34, 2211840
s_mov_b32 s35, 0x20000
v_mul_lo_u32 v59, v4, s37
v_lshl_add_u32 v232, v6, 4, v59
v_lshl_add_u32 v233, v7, 4, v59
s_lshl_b32 s27, s37, 3
s_add_u32 m0, s83, 57344
    s_nop 0
buffer_load_dwordx4 v232, s[32:35], s38 offen lds
s_add_u32 s38, s38, s27
s_add_u32 m0, s83, 58368
    s_nop 0
buffer_load_dwordx4 v233, s[32:35], s38 offen lds
wu_18:
s_cbranch_execz wu_ret2
s_add_u32 s38, s38, s27
s_add_u32 m0, s83, 59392
    s_nop 0
buffer_load_dwordx4 v232, s[32:35], s38 offen lds
s_add_u32 s38, s38, s27
s_add_u32 m0, s83, 60416
    s_nop 0
buffer_load_dwordx4 v233, s[32:35], s38 offen lds
s_mov_b32 s19, s36
s_mov_b32 s81, s39
s_sub_u32 s43, s2, 161
s_lshl_b32 s43, s43, 2
s_add_u32 s43, s43, s3
s_add_u32 s43, s43, 1520
s_cmp_ge_u32 s43, 540
s_cselect_b32 s36, 1, 0
s_cmp_ge_u32 s43, 1080
s_cselect_b32 s36, 2, s36
s_mul_i32 s44, s36, 540
s_sub_u32 s44, s43, s44
s_cmp_eq_u32 s36, 2
s_mov_b32 s37, 3456
s_cselect_b32 s37, 1280, s37
s_mov_b32 s40, 2048
s_cselect_b32 s40, 1024, s40
s_mov_b32 s41, 8
s_cselect_b32 s41, 4, s41
s_mov_b32 s42, 4
s_cselect_b32 s42, 16, s42
s_mov_b32 s45, 2428
s_cselect_b32 s45, 6554, s45
s_mov_b32 s38, 27
s_cselect_b32 s38, 10, s38
s_mov_b32 s39, 221184
s_cselect_b32 s39, 40960, s39
s_mul_i32 s45, s45, s44
s_lshr_b32 s45, s45, 16
s_mul_i32 s38, s38, s45
s_sub_u32 s44, s44, s38
s_mul_i32 s39, s39, s45
s_mul_i32 s38, s45, s37
s_lshl_b32 s38, s38, 5
s_lshl_b32 s45, s44, 7
s_add_u32 s38, s38, s45
s_cmp_eq_u32 s36, 2
s_mov_b32 s45, 8192
s_cselect_b32 s45, 4096, s45
s_mul_i32 s45, s45, s44
s_add_u32 s39, s39, s45
s_cmp_eq_u32 s36, 1
s_cselect_b32 s45, 1024, 0
s_add_u32 s39, s39, s45
s_cmp_lt_u32 s43, 1620
s_cselect_b32 s38, s38, 0x40000000
s_cselect_b32 s39, s39, 0x40000000
s_cmp_eq_u32 s36, 0
s_cselect_b32 s32, s20, s22
s_cselect_b32 s33, s21, s23
s_cmp_eq_u32 s36, 2
s_cselect_b32 s32, s24, s32
s_cselect_b32 s33, s25, s33
s_mov_b32 s34, 2211840
s_mov_b32 s35, 0x20000
v_mul_lo_u32 v59, v4, s37
v_lshl_add_u32 v232, v6, 4, v59
v_lshl_add_u32 v233, v7, 4, v59
s_lshl_b32 s27, s37, 3
s_add_u32 m0, s83, 61440
    s_nop 0
buffer_load_dwordx4 v232, s[32:35], s38 offen lds
s_add_u32 s38, s38, s27
s_add_u32 m0, s83, 62464
    s_nop 0
buffer_load_dwordx4 v233, s[32:35], s38 offen lds
s_add_u32 s38, s38, s27
s_add_u32 m0, s83, 63488
    s_nop 0
buffer_load_dwordx4 v232, s[32:35], s38 offen lds
s_add_u32 s38, s38, s27
s_add_u32 m0, s83, 64512
    s_nop 0
buffer_load_dwordx4 v233, s[32:35], s38 offen lds
s_mov_b32 s28, s36
s_mov_b32 s82, s39
v_lshrrev_b32 v24, 4, v1
v_bfe_u32 v25, v1, 2, 2
v_mul_u32_u24 v24, 8, v24
v_add_u32 v24, v24, v25
v_add_u32 v25, 4, v24
v_and_b32 v26, 1, v1
v_bfe_u32 v27, v1, 1, 1
wu_19:
s_cbranch_execz wu_ret2
v_bfe_u32 v28, v24, 1, 1
v_lshrrev_b32 v29, 2, v24
v_lshrrev_b32 v30, 3, v24
v_xor_b32 v29, v29, v30
v_and_b32 v29, 1, v29
v_lshl_or_b32 v28, v29, 1, v28
v_lshlrev_b32 v28, 1, v28
v_xor_b32 v28, v28, v27
v_lshlrev_b32 v31, 7, v24
v_lshl_add_u32 v31, v26, 3, v31
v_add_u32 v31, s83, v31
v_xor_b32 v29, 0, v28
v_lshl_add_u32 v8, v29, 4, v31
v_xor_b32 v29, 2, v28
v_lshl_add_u32 v9, v29, 4, v31
v_xor_b32 v29, 4, v28
v_lshl_add_u32 v10, v29, 4, v31
v_xor_b32 v29, 6, v28
v_lshl_add_u32 v11, v29, 4, v31
v_bfe_u32 v28, v25, 1, 1
v_lshrrev_b32 v29, 2, v25
v_lshrrev_b32 v30, 3, v25
v_xor_b32 v29, v29, v30
v_and_b32 v29, 1, v29
v_lshl_or_b32 v28, v29, 1, v28
v_lshlrev_b32 v28, 1, v28
v_xor_b32 v28, v28, v27
v_lshlrev_b32 v31, 7, v25
v_lshl_add_u32 v31, v26, 3, v31
v_add_u32 v31, s83, v31
v_xor_b32 v29, 0, v28
v_lshl_add_u32 v12, v29, 4, v31
v_xor_b32 v29, 2, v28
v_lshl_add_u32 v13, v29, 4, v31
v_xor_b32 v29, 4, v28
v_lshl_add_u32 v14, v29, 4, v31
v_xor_b32 v29, 6, v28
v_lshl_add_u32 v15, v29, 4, v31
v_lshrrev_b32 v24, 4, v1
v_bfe_u32 v25, v1, 2, 2
v_mul_u32_u24 v24, 4, v24
v_add_u32 v24, v24, v25
v_add_u32 v25, 16, v24
v_and_b32 v26, 1, v1
v_bfe_u32 v27, v1, 1, 1
v_bfe_u32 v28, v24, 1, 1
v_lshrrev_b32 v29, 2, v24
v_lshrrev_b32 v30, 3, v24
v_xor_b32 v29, v29, v30
v_and_b32 v29, 1, v29
v_lshl_or_b32 v28, v29, 1, v28
v_lshlrev_b32 v28, 1, v28
v_xor_b32 v28, v28, v27
v_lshlrev_b32 v31, 7, v24
v_lshl_add_u32 v31, v26, 3, v31
v_add_u32 v31, s83, v31
v_xor_b32 v29, 0, v28
v_lshl_add_u32 v16, v29, 4, v31
v_xor_b32 v29, 2, v28
v_lshl_add_u32 v17, v29, 4, v31
v_xor_b32 v29, 4, v28
v_lshl_add_u32 v18, v29, 4, v31
v_xor_b32 v29, 6, v28
v_lshl_add_u32 v19, v29, 4, v31
v_bfe_u32 v28, v25, 1, 1
v_lshrrev_b32 v29, 2, v25
v_lshrrev_b32 v30, 3, v25
v_xor_b32 v29, v29, v30
v_and_b32 v29, 1, v29
v_lshl_or_b32 v28, v29, 1, v28
v_lshlrev_b32 v28, 1, v28
v_xor_b32 v28, v28, v27
v_lshlrev_b32 v31, 7, v25
v_lshl_add_u32 v31, v26, 3, v31
v_add_u32 v31, s83, v31
v_xor_b32 v29, 0, v28
v_lshl_add_u32 v20, v29, 4, v31
v_xor_b32 v29, 2, v28
v_lshl_add_u32 v21, v29, 4, v31
v_xor_b32 v29, 4, v28
v_lshl_add_u32 v22, v29, 4, v31
v_xor_b32 v29, 6, v28
v_lshl_add_u32 v23, v29, 4, v31
v_lshlrev_b32 v24, 4, v1
s_add_u32 s44, s4, 0x400000
s_addc_u32 s45, s5, 0
s_mov_b32 s46, 0x288000
s_mov_b32 s47, 0x20000
v_mul_u32_u24 v25, 10368, v0
rt_14:
buffer_load_dword v26, v25, s[44:47], 0 offen offset:0 sc1
s_add_u32 s53, s53, 1
wu_20:
s_cbranch_execz wu_ret2
s_waitcnt vmcnt(0)
v_cmp_eq_u32 vcc, -1, v26
s_cmp_ge_u32 s53, 4000000
s_cbranch_scc1 rt_14_x
s_cbranch_vccnz rt_14
rt_14_x:
s_cmp_eq_u32 s16, 2
s_mov_b32 s26, 0x1800000
s_cselect_b32 s26, 0x1d00000, s26
s_mov_b32 s34, 0x438000
s_cselect_b32 s34, 0x21c000, s34
s_mov_b32 s27, 2048
s_cselect_b32 s27, 1024, s27
s_add_u32 s32, s4, s26
s_addc_u32 s33, s5, 0
s_cmp_eq_u32 s16, 2
s_cbranch_scc1 rp_15
ds_read_b64_tr_b16 v[40:41], v8 offset:45056
ds_read_b64_tr_b16 v[42:43], v12 offset:45056
ds_read_b64_tr_b16 v[44:45], v9 offset:45056
ds_read_b64_tr_b16 v[46:47], v13 offset:45056
ds_read_b64_tr_b16 v[48:49], v10 offset:45056
ds_read_b64_tr_b16 v[50:51], v14 offset:45056
ds_read_b64_tr_b16 v[52:53], v11 offset:45056
ds_read_b64_tr_b16 v[54:55], v15 offset:45056
s_branch rp_15_e
rp_15:
ds_read_b64_tr_b16 v[40:41], v16 offset:45056
ds_read_b64_tr_b16 v[42:43], v20 offset:45056
ds_read_b64_tr_b16 v[44:45], v17 offset:45056
ds_read_b64_tr_b16 v[46:47], v21 offset:45056
ds_read_b64_tr_b16 v[48:49], v18 offset:45056
ds_read_b64_tr_b16 v[50:51], v22 offset:45056
ds_read_b64_tr_b16 v[52:53], v19 offset:45056
ds_read_b64_tr_b16 v[54:55], v23 offset:45056
rp_15_e:
s_waitcnt lgkmcnt(6)
buffer_store_dwordx4 v[40:43], v24, s[32:35], s29 offen sc0 sc1
s_add_u32 s29, s29, s27
s_waitcnt lgkmcnt(4)
buffer_store_dwordx4 v[44:47], v24, s[32:35], s29 offen sc0 sc1
s_add_u32 s29, s29, s27
s_waitcnt lgkmcnt(2)
buffer_store_dwordx4 v[48:51], v24, s[32:35], s29 offen sc0 sc1
s_add_u32 s29, s29, s27
s_waitcnt lgkmcnt(0)
buffer_store_dwordx4 v[52:55], v24, s[32:35], s29 offen sc0 sc1
s_cmp_eq_u32 s17, 2
s_mov_b32 s26, 0x1800000
s_cselect_b32 s26, 0x1d00000, s26
s_mov_b32 s34, 0x438000
s_cselect_b32 s34, 0x21c000, s34
s_mov_b32 s27, 2048
s_cselect_b32 s27, 1024, s27
s_add_u32 s32, s4, s26
s_addc_u32 s33, s5, 0
s_cmp_eq_u32 s17, 2
s_cbranch_scc1 rp_16
ds_read_b64_tr_b16 v[56:57], v8 offset:49152
ds_read_b64_tr_b16 v[58:59], v12 offset:49152
ds_read_b64_tr_b16 v[60:61], v9 offset:49152
ds_read_b64_tr_b16 v[62:63], v13 offset:49152
ds_read_b64_tr_b16 v[64:65], v10 offset:49152
ds_read_b64_tr_b16 v[66:67], v14 offset:49152
ds_read_b64_tr_b16 v[68:69], v11 offset:49152
ds_read_b64_tr_b16 v[70:71], v15 offset:49152
s_branch rp_16_e
rp_16:
ds_read_b64_tr_b16 v[56:57], v16 offset:49152
ds_read_b64_tr_b16 v[58:59], v20 offset:49152
ds_read_b64_tr_b16 v[60:61], v17 offset:49152
ds_read_b64_tr_b16 v[62:63], v21 offset:49152
ds_read_b64_tr_b16 v[64:65], v18 offset:49152
ds_read_b64_tr_b16 v[66:67], v22 offset:49152
ds_read_b64_tr_b16 v[68:69], v19 offset:49152
ds_read_b64_tr_b16 v[70:71], v23 offset:49152
rp_16_e:
s_waitcnt lgkmcnt(6)
buffer_store_dwordx4 v[56:59], v24, s[32:35], s30 offen sc0 sc1
s_add_u32 s30, s30, s27
s_waitcnt lgkmcnt(4)
buffer_store_dwordx4 v[60:63], v24, s[32:35], s30 offen sc0 sc1
wu_21:
s_cbranch_execz wu_ret2
s_add_u32 s30, s30, s27
s_waitcnt lgkmcnt(2)
buffer_store_dwordx4 v[64:67], v24, s[32:35], s30 offen sc0 sc1
s_add_u32 s30, s30, s27
s_waitcnt lgkmcnt(0)
buffer_store_dwordx4 v[68:71], v24, s[32:35], s30 offen sc0 sc1
s_cmp_eq_u32 s18, 2
s_mov_b32 s26, 0x1800000
s_cselect_b32 s26, 0x1d00000, s26
s_mov_b32 s34, 0x438000
s_cselect_b32 s34, 0x21c000, s34
s_mov_b32 s27, 2048
s_cselect_b32 s27, 1024, s27
s_add_u32 s32, s4, s26
s_addc_u32 s33, s5, 0
s_cmp_eq_u32 s18, 2
s_cbranch_scc1 rp_17
ds_read_b64_tr_b16 v[72:73], v8 offset:53248
ds_read_b64_tr_b16 v[74:75], v12 offset:53248
ds_read_b64_tr_b16 v[76:77], v9 offset:53248
ds_read_b64_tr_b16 v[78:79], v13 offset:53248
ds_read_b64_tr_b16 v[80:81], v10 offset:53248
ds_read_b64_tr_b16 v[82:83], v14 offset:53248
ds_read_b64_tr_b16 v[84:85], v11 offset:53248
ds_read_b64_tr_b16 v[86:87], v15 offset:53248
s_branch rp_17_e
rp_17:
ds_read_b64_tr_b16 v[72:73], v16 offset:53248
ds_read_b64_tr_b16 v[74:75], v20 offset:53248
ds_read_b64_tr_b16 v[76:77], v17 offset:53248
ds_read_b64_tr_b16 v[78:79], v21 offset:53248
ds_read_b64_tr_b16 v[80:81], v18 offset:53248
ds_read_b64_tr_b16 v[82:83], v22 offset:53248
ds_read_b64_tr_b16 v[84:85], v19 offset:53248
ds_read_b64_tr_b16 v[86:87], v23 offset:53248
rp_17_e:
s_waitcnt lgkmcnt(6)
buffer_store_dwordx4 v[72:75], v24, s[32:35], s31 offen sc0 sc1
s_add_u32 s31, s31, s27
s_waitcnt lgkmcnt(4)
buffer_store_dwordx4 v[76:79], v24, s[32:35], s31 offen sc0 sc1
s_add_u32 s31, s31, s27
s_waitcnt lgkmcnt(2)
buffer_store_dwordx4 v[80:83], v24, s[32:35], s31 offen sc0 sc1
s_add_u32 s31, s31, s27
s_waitcnt lgkmcnt(0)
buffer_store_dwordx4 v[84:87], v24, s[32:35], s31 offen sc0 sc1
s_cmp_eq_u32 s19, 2
s_mov_b32 s26, 0x1800000
s_cselect_b32 s26, 0x1d00000, s26
s_mov_b32 s34, 0x438000
s_cselect_b32 s34, 0x21c000, s34
s_mov_b32 s27, 2048
s_cselect_b32 s27, 1024, s27
s_add_u32 s32, s4, s26
s_addc_u32 s33, s5, 0
s_cmp_eq_u32 s19, 2
s_cbranch_scc1 rp_18
ds_read_b64_tr_b16 v[88:89], v8 offset:57344
ds_read_b64_tr_b16 v[90:91], v12 offset:57344
ds_read_b64_tr_b16 v[92:93], v9 offset:57344
ds_read_b64_tr_b16 v[94:95], v13 offset:57344
ds_read_b64_tr_b16 v[96:97], v10 offset:57344
ds_read_b64_tr_b16 v[98:99], v14 offset:57344
ds_read_b64_tr_b16 v[100:101], v11 offset:57344
ds_read_b64_tr_b16 v[102:103], v15 offset:57344
s_branch rp_18_e
rp_18:
ds_read_b64_tr_b16 v[88:89], v16 offset:57344
ds_read_b64_tr_b16 v[90:91], v20 offset:57344
ds_read_b64_tr_b16 v[92:93], v17 offset:57344
ds_read_b64_tr_b16 v[94:95], v21 offset:57344
ds_read_b64_tr_b16 v[96:97], v18 offset:57344
ds_read_b64_tr_b16 v[98:99], v22 offset:57344
ds_read_b64_tr_b16 v[100:101], v19 offset:57344
ds_read_b64_tr_b16 v[102:103], v23 offset:57344
rp_18_e:
s_waitcnt lgkmcnt(6)
buffer_store_dwordx4 v[88:91], v24, s[32:35], s81 offen sc0 sc1
wu_22:
s_cbranch_execz wu_ret2
s_add_u32 s81, s81, s27
s_waitcnt lgkmcnt(4)
buffer_store_dwordx4 v[92:95], v24, s[32:35], s81 offen sc0 sc1
s_add_u32 s81, s81, s27
s_waitcnt lgkmcnt(2)
buffer_store_dwordx4 v[96:99], v24, s[32:35], s81 offen sc0 sc1
s_add_u32 s81, s81, s27
s_waitcnt lgkmcnt(0)
buffer_store_dwordx4 v[100:103], v24, s[32:35], s81 offen sc0 sc1
s_cmp_eq_u32 s28, 2
s_mov_b32 s26, 0x1800000
s_cselect_b32 s26, 0x1d00000, s26
s_mov_b32 s34, 0x438000
s_cselect_b32 s34, 0x21c000, s34
s_mov_b32 s27, 2048
s_cselect_b32 s27, 1024, s27
s_add_u32 s32, s4, s26
s_addc_u32 s33, s5, 0
s_cmp_eq_u32 s28, 2
s_cbranch_scc1 rp_19
ds_read_b64_tr_b16 v[104:105], v8 offset:61440
ds_read_b64_tr_b16 v[106:107], v12 offset:61440
ds_read_b64_tr_b16 v[108:109], v9 offset:61440
ds_read_b64_tr_b16 v[110:111], v13 offset:61440
ds_read_b64_tr_b16 v[112:113], v10 offset:61440
ds_read_b64_tr_b16 v[114:115], v14 offset:61440
ds_read_b64_tr_b16 v[116:117], v11 offset:61440
ds_read_b64_tr_b16 v[118:119], v15 offset:61440
s_branch rp_19_e
rp_19:
ds_read_b64_tr_b16 v[104:105], v16 offset:61440
ds_read_b64_tr_b16 v[106:107], v20 offset:61440
ds_read_b64_tr_b16 v[108:109], v17 offset:61440
ds_read_b64_tr_b16 v[110:111], v21 offset:61440
ds_read_b64_tr_b16 v[112:113], v18 offset:61440
ds_read_b64_tr_b16 v[114:115], v22 offset:61440
ds_read_b64_tr_b16 v[116:117], v19 offset:61440
ds_read_b64_tr_b16 v[118:119], v23 offset:61440
rp_19_e:
s_waitcnt lgkmcnt(6)
buffer_store_dwordx4 v[104:107], v24, s[32:35], s82 offen sc0 sc1
s_add_u32 s82, s82, s27
s_waitcnt lgkmcnt(4)
buffer_store_dwordx4 v[108:111], v24, s[32:35], s82 offen sc0 sc1
s_add_u32 s82, s82, s27
s_waitcnt lgkmcnt(2)
buffer_store_dwordx4 v[112:115], v24, s[32:35], s82 offen sc0 sc1
s_add_u32 s82, s82, s27
s_waitcnt lgkmcnt(0)
buffer_store_dwordx4 v[116:119], v24, s[32:35], s82 offen sc0 sc1
s_mov_b32 s26, 32768
buffer_load_dword v253, v252, s[12:15], s26 offen sc1
s_waitcnt vmcnt(0)
v_cmp_ne_u32 vcc, s55, v253
s_cbranch_vccnz fw_20
fw_20_b:
s_barrier
s_cmp_lg_u32 s3, 0
s_cbranch_scc1 fl_21
s_lshl_b32 s50, s2, 5
s_add_u32 s50, s50, 65536
v_mov_b32 v8, s50
v_mov_b32 v9, s55
s_mov_b64 exec, 1
buffer_store_dword v9, v8, s[12:15], 0 offen sc0 sc1
s_mov_b64 exec, -1
fl_21:
s_mov_b32 s44, s4
s_mov_b32 s45, s5
s_mov_b32 s46, 0x3c00
s_mov_b32 s47, 0x20000
v_lshlrev_b32 v255, 4, v1
s_lshl_b32 s83, s3, 11
s_add_u32 m0, s83, 148864
s_add_u32 s43, s83, 5120
buffer_load_dwordx4 v255, s[44:47], s43 offen sc1 lds
s_add_u32 m0, s83, 149888
s_add_u32 s43, s83, 6144
buffer_load_dwordx4 v255, s[44:47], s43 offen sc1 lds
b_done_9:
s_lshl_b32 s20, s48, 3
s_and_b32 s21, s49, 7
s_add_u32 s20, s20, s21
s_lshr_b32 s21, s49, 3
s_add_u32 s36, s4, 0x1800000
s_addc_u32 s37, s5, 0
s_mov_b32 s38, 0x438000
s_mov_b32 s39, 0x20000
wu_23:
s_cbranch_execz wu_ret2
s_and_b32 s40, s48, 1
s_lshl_b32 s40, s40, 3
s_and_b32 s41, s49, 7
s_add_u32 s40, s40, s41
s_lshr_b32 s41, s48, 1
s_lshl_b32 s41, s41, 2
s_lshr_b32 s42, s49, 3
s_add_u32 s41, s41, s42
s_mul_i32 s41, s41, 7
s_lshr_b32 s42, s3, 1
s_mul_i32 s42, s42, 221184
s_lshl_b32 s43, s41, 11
s_add_u32 s42, s42, s43
s_and_b32 s43, s3, 1
s_mul_i32 s43, s43, 7168
s_add_u32 s42, s42, s43
s_and_b32 s43, s41, 1
s_lshl_b32 s43, s43, 11
s_add_u32 s42, s42, s43
v_lshlrev_b32 v248, 4, v1
v_add_u32 v248, s42, v248
s_and_b32 s43, s41, s3
s_and_b32 s43, s43, 1
s_mul_i32 s43, s43, 14336
v_subrev_u32 v255, s43, v248
s_mul_i32 s42, s3, 7168
s_lshr_b32 s22, s20, 5
s_lshl_b32 s22, s22, 12
s_lshl_b32 s23, s21, 10
s_add_u32 s22, s22, s23
s_and_b32 s23, s20, 31
s_lshl_b32 s23, s23, 5
s_add_u32 s22, s22, s23
v_and_b32 v4, 1, v1
v_bfe_u32 v5, v1, 1, 2
v_lshrrev_b32 v6, 3, v1
s_lshl_b32 s23, s3, 3
v_add_u32 v6, s23, v6
v_lshl_add_u32 v251, v5, 5, v6
v_lshlrev_b32 v251, 13, v251
v_lshl_add_u32 v251, v4, 4, v251
v_add_u32 v251, s22, v251
v_mul_u32_u24 v252, 6208, v4
v_mul_u32_u24 v253, 48, v6
v_add_u32 v252, v252, v253
v_lshl_add_u32 v252, v5, 2, v252
v_add_u32 v252, 114688, v252
s_add_u32 s16, s4, 0x700000
s_addc_u32 s17, s5, 0
s_mov_b32 s18, 0x282000
s_mov_b32 s19, 0x20000
s_mov_b32 s24, 0x100000
s_mov_b32 s25, 0x200000
v_cvt_f32_u32 v249, v2
v_cvt_f32_u32 v250, v3
v_mul_f32 v4, 0x3d4ccccd, v249
v_mul_f32 v5, v4, v250
v_mul_f32 v5, 4.0, v5
v_mov_b32 v6, 0
v_fmamk_f32 v244, v4, 0x0, v5
v_cos_f32 v245, v244
v_sin_f32 v246, v244
    s_nop 0
v_sub_f32 v247, 0, v246
v_cvt_pk_bf16_f32 v92, v245, v247
v_cvt_pk_bf16_f32 v100, v246, v245
v_fmamk_f32 v244, v4, 0x3f800000, v5
v_cos_f32 v245, v244
v_sin_f32 v246, v244
    s_nop 0
v_sub_f32 v247, 0, v246
v_cvt_pk_bf16_f32 v93, v245, v247
v_cvt_pk_bf16_f32 v101, v246, v245
v_fmamk_f32 v244, v4, 0x40000000, v5
v_cos_f32 v245, v244
v_sin_f32 v246, v244
    s_nop 0
v_sub_f32 v247, 0, v246
v_cvt_pk_bf16_f32 v94, v245, v247
v_cvt_pk_bf16_f32 v102, v246, v245
v_fmamk_f32 v244, v4, 0x40400000, v5
v_cos_f32 v245, v244
v_sin_f32 v246, v244
    s_nop 0
v_sub_f32 v247, 0, v246
v_cvt_pk_bf16_f32 v95, v245, v247
v_cvt_pk_bf16_f32 v103, v246, v245
v_fmamk_f32 v244, v4, 0x41000000, v6
v_cos_f32 v245, v244
v_sin_f32 v246, v244
    s_nop 0
v_sub_f32 v247, 0, v246
v_cvt_pk_bf16_f32 v96, v245, v247
v_cvt_pk_bf16_f32 v104, v246, v245
v_fmamk_f32 v244, v4, 0x41100000, v6
wu_24:
s_cbranch_execz wu_ret2
v_cos_f32 v245, v244
v_sin_f32 v246, v244
    s_nop 0
v_sub_f32 v247, 0, v246
v_cvt_pk_bf16_f32 v97, v245, v247
v_cvt_pk_bf16_f32 v105, v246, v245
v_fmamk_f32 v244, v4, 0x41200000, v6
v_cos_f32 v245, v244
v_sin_f32 v246, v244
    s_nop 0
v_sub_f32 v247, 0, v246
v_cvt_pk_bf16_f32 v98, v245, v247
v_cvt_pk_bf16_f32 v106, v246, v245
v_fmamk_f32 v244, v4, 0x41300000, v6
v_cos_f32 v245, v244
v_sin_f32 v246, v244
    s_nop 0
v_sub_f32 v247, 0, v246
v_cvt_pk_bf16_f32 v99, v245, v247
v_cvt_pk_bf16_f32 v107, v246, v245
v_cmp_eq_u32 vcc, 0, v3
    s_nop 1
v_cndmask_b32 v96, 0, v96, vcc
v_cndmask_b32 v104, 0, v104, vcc
v_cndmask_b32 v97, 0, v97, vcc
v_cndmask_b32 v105, 0, v105, vcc
v_cndmask_b32 v98, 0, v98, vcc
v_cndmask_b32 v106, 0, v106, vcc
v_cndmask_b32 v99, 0, v99, vcc
v_cndmask_b32 v107, 0, v107, vcc
v_mul_f32 v4, 0x3acccccd, v249
v_mul_f32 v5, v4, v250
v_mul_f32 v5, 4.0, v5
v_fmamk_f32 v244, v4, 0x0, v5
v_cos_f32 v108, v244
v_sin_f32 v124, v244
v_fmamk_f32 v244, v4, 0x3f800000, v5
v_cos_f32 v109, v244
v_sin_f32 v125, v244
v_fmamk_f32 v244, v4, 0x40000000, v5
v_cos_f32 v110, v244
v_sin_f32 v126, v244
v_fmamk_f32 v244, v4, 0x40400000, v5
v_cos_f32 v111, v244
v_sin_f32 v127, v244
v_fmamk_f32 v244, v4, 0x41000000, v5
v_cos_f32 v112, v244
v_sin_f32 v128, v244
v_fmamk_f32 v244, v4, 0x41100000, v5
v_cos_f32 v113, v244
v_sin_f32 v129, v244
v_fmamk_f32 v244, v4, 0x41200000, v5
v_cos_f32 v114, v244
v_sin_f32 v130, v244
v_fmamk_f32 v244, v4, 0x41300000, v5
v_cos_f32 v115, v244
v_sin_f32 v131, v244
v_fmamk_f32 v244, v4, 0x41800000, v5
v_cos_f32 v116, v244
v_sin_f32 v132, v244
v_fmamk_f32 v244, v4, 0x41880000, v5
v_cos_f32 v117, v244
v_sin_f32 v133, v244
v_fmamk_f32 v244, v4, 0x41900000, v5
v_cos_f32 v118, v244
v_sin_f32 v134, v244
v_fmamk_f32 v244, v4, 0x41980000, v5
v_cos_f32 v119, v244
v_sin_f32 v135, v244
v_fmamk_f32 v244, v4, 0x41c00000, v5
v_cos_f32 v120, v244
v_sin_f32 v136, v244
v_fmamk_f32 v244, v4, 0x41c80000, v5
v_cos_f32 v121, v244
v_sin_f32 v137, v244
v_fmamk_f32 v244, v4, 0x41d00000, v5
v_cos_f32 v122, v244
v_sin_f32 v138, v244
v_fmamk_f32 v244, v4, 0x41d80000, v5
v_cos_f32 v123, v244
v_sin_f32 v139, v244
v_mul_f32 v4, 0x3d000000, v249
v_mul_f32 v5, v4, v250
v_mul_f32 v5, 4.0, v5
v_fmamk_f32 v244, v4, 0x0, v5
v_cos_f32 v245, v244
v_sin_f32 v247, -v244
v_fmamk_f32 v244, v4, 0x3f800000, v5
v_cos_f32 v246, v244
v_sin_f32 v243, -v244
v_cvt_pk_bf16_f32 v140, v245, v246
v_cvt_pk_bf16_f32 v148, v247, v243
v_fmamk_f32 v244, v4, 0x40000000, v5
v_cos_f32 v245, v244
wu_25:
s_cbranch_execz wu_ret2
v_sin_f32 v247, -v244
v_fmamk_f32 v244, v4, 0x40400000, v5
v_cos_f32 v246, v244
v_sin_f32 v243, -v244
v_cvt_pk_bf16_f32 v141, v245, v246
v_cvt_pk_bf16_f32 v149, v247, v243
v_fmamk_f32 v244, v4, 0x41000000, v5
v_cos_f32 v245, v244
v_sin_f32 v247, -v244
v_fmamk_f32 v244, v4, 0x41100000, v5
v_cos_f32 v246, v244
v_sin_f32 v243, -v244
v_cvt_pk_bf16_f32 v142, v245, v246
v_cvt_pk_bf16_f32 v150, v247, v243
v_fmamk_f32 v244, v4, 0x41200000, v5
v_cos_f32 v245, v244
v_sin_f32 v247, -v244
v_fmamk_f32 v244, v4, 0x41300000, v5
v_cos_f32 v246, v244
v_sin_f32 v243, -v244
v_cvt_pk_bf16_f32 v143, v245, v246
v_cvt_pk_bf16_f32 v151, v247, v243
v_fmamk_f32 v244, v4, 0x41800000, v5
v_cos_f32 v245, v244
v_sin_f32 v247, -v244
v_fmamk_f32 v244, v4, 0x41880000, v5
v_cos_f32 v246, v244
v_sin_f32 v243, -v244
v_cvt_pk_bf16_f32 v144, v245, v246
v_cvt_pk_bf16_f32 v152, v247, v243
v_fmamk_f32 v244, v4, 0x41900000, v5
v_cos_f32 v245, v244
v_sin_f32 v247, -v244
v_fmamk_f32 v244, v4, 0x41980000, v5
v_cos_f32 v246, v244
v_sin_f32 v243, -v244
v_cvt_pk_bf16_f32 v145, v245, v246
v_cvt_pk_bf16_f32 v153, v247, v243
v_fmamk_f32 v244, v4, 0x41c00000, v5
v_cos_f32 v245, v244
v_sin_f32 v247, -v244
v_fmamk_f32 v244, v4, 0x41c80000, v5
v_cos_f32 v246, v244
v_sin_f32 v243, -v244
v_cvt_pk_bf16_f32 v146, v245, v246
v_cvt_pk_bf16_f32 v154, v247, v243
v_fmamk_f32 v244, v4, 0x41d00000, v5
v_cos_f32 v245, v244
v_sin_f32 v247, -v244
v_fmamk_f32 v244, v4, 0x41d80000, v5
v_cos_f32 v246, v244
v_sin_f32 v243, -v244
v_cvt_pk_bf16_f32 v147, v245, v246
v_cvt_pk_bf16_f32 v155, v247, v243
v_accvgpr_read_b32 v20, a0
v_accvgpr_read_b32 v21, a1
v_accvgpr_read_b32 v22, a2
v_accvgpr_read_b32 v23, a3
v_accvgpr_read_b32 v24, a4
v_accvgpr_read_b32 v25, a5
v_accvgpr_read_b32 v26, a6
v_accvgpr_read_b32 v27, a7
v_accvgpr_read_b32 v28, a8
v_accvgpr_read_b32 v29, a9
v_accvgpr_read_b32 v30, a10
v_accvgpr_read_b32 v31, a11
v_lshlrev_b32 v68, 16, v20
v_and_b32 v69, 0xffff0000, v20
v_lshlrev_b32 v70, 16, v21
v_and_b32 v71, 0xffff0000, v21
v_lshlrev_b32 v72, 16, v22
v_and_b32 v73, 0xffff0000, v22
wu_26:
s_cbranch_execz wu_ret2
v_lshlrev_b32 v74, 16, v23
v_and_b32 v75, 0xffff0000, v23
v_lshlrev_b32 v76, 16, v24
v_and_b32 v77, 0xffff0000, v24
v_lshlrev_b32 v78, 16, v25
v_and_b32 v79, 0xffff0000, v25
v_lshlrev_b32 v80, 16, v26
v_and_b32 v81, 0xffff0000, v26
v_lshlrev_b32 v82, 16, v27
v_and_b32 v83, 0xffff0000, v27
v_lshlrev_b32 v84, 16, v28
v_and_b32 v85, 0xffff0000, v28
v_lshlrev_b32 v86, 16, v29
v_and_b32 v87, 0xffff0000, v29
v_lshlrev_b32 v88, 16, v30
v_and_b32 v89, 0xffff0000, v30
v_lshlrev_b32 v90, 16, v31
v_and_b32 v91, 0xffff0000, v31
v_cmp_eq_u32 vcc, 0, v3
    s_nop 1
v_cndmask_b32 v76, 0, v76, vcc
v_cndmask_b32 v77, 0, v77, vcc
v_cndmask_b32 v78, 0, v78, vcc
v_cndmask_b32 v79, 0, v79, vcc
v_cndmask_b32 v88, 0, v88, vcc
v_cndmask_b32 v89, 0, v89, vcc
v_cndmask_b32 v90, 0, v90, vcc
v_cndmask_b32 v91, 0, v91, vcc
v_mul_u32_u24 v7, 80, v2
v_lshl_add_u32 v7, v3, 4, v7
v_add_u32 v7, 148864, v7
v_min_u32 v253, 94, v0
v_add_u32 v253, 2209, v253
v_lshlrev_b32 v253, 5, v253
rt_22:
buffer_load_dwordx4 v[8:11], v251, s[16:19], 0 offen sc1
buffer_load_dwordx4 v[12:15], v251, s[16:19], s24 offen sc1
buffer_load_dwordx4 v[16:19], v251, s[16:19], s25 offen sc1
buffer_load_dword v254, v253, s[12:15], 0 offen sc1
s_add_u32 s53, s53, 1
s_waitcnt vmcnt(0)
v_max3_u32 v4, v8, v9, v10
v_max3_u32 v4, v4, v11, v12
v_max3_u32 v4, v4, v13, v14
v_max3_u32 v4, v4, v15, v16
v_max3_u32 v4, v4, v17, v18
v_max_u32 v4, v4, v19
v_cmp_eq_u32 vcc, -1, v4
v_cmp_ne_u32 s[50:51], s55, v254
s_or_b64 vcc, vcc, s[50:51]
s_cmp_ge_u32 s53, 4000000
s_cbranch_scc1 rt_22_x
s_cbranch_vccnz rt_22
rt_22_x:
ds_write_b32 v252, v8 offset:0
ds_write_b32 v252, v9 offset:1552
ds_write_b32 v252, v10 offset:3104
ds_write_b32 v252, v11 offset:4656
ds_write_b32 v252, v12 offset:16
ds_write_b32 v252, v13 offset:1568
ds_write_b32 v252, v14 offset:3120
ds_write_b32 v252, v15 offset:4672
ds_write_b32 v252, v16 offset:32
ds_write_b32 v252, v17 offset:1584
ds_write_b32 v252, v18 offset:3136
ds_write_b32 v252, v19 offset:4688
s_lshr_b32 s44, s48, 1
s_lshl_b32 s44, s44, 3
s_and_b32 s45, s49, 7
s_add_u32 s44, s44, s45
s_and_b32 s45, s48, 1
s_lshl_b32 s45, s45, 2
s_lshr_b32 s46, s49, 3
s_add_u32 s45, s45, s46
s_mul_i32 s46, s3, 14
s_mul_i32 s47, s46, 40960
s_mul_i32 s51, s45, 5120
s_add_u32 s47, s47, s51
v_lshlrev_b32 v246, 4, v1
v_add_u32 v246, s47, v246
v_add_u32 v247, 4096, v246
s_add_u32 s32, s4, 0x1d00000
s_addc_u32 s33, s5, 0
s_mov_b32 s34, 0x21c000
s_mov_b32 s35, 0x20000
wu_27:
s_cbranch_execz wu_ret2
s_mul_i32 s26, s3, 3104
s_add_u32 s26, s26, 114688
v_mul_u32_u24 v4, 48, v2
v_add_u32 v4, s26, v4
v_lshl_add_u32 v5, v3, 4, v4
s_waitcnt lgkmcnt(0)
s_barrier
ds_read_b128 v[156:159], v5 offset:0
ds_read_b128 v[160:163], v4 offset:32
ds_read_b128 v[164:167], v5 offset:1552
ds_read_b128 v[168:171], v4 offset:1584
ds_read_b128 v[32:35], v7 offset:0
ds_read_b128 v[36:39], v7 offset:32
ds_read_b128 v[40:43], v7 offset:64
ds_read_b128 v[44:47], v7 offset:5120
ds_read_b128 v[48:51], v7 offset:5152
ds_read_b128 v[52:55], v7 offset:5184
ds_read_b128 v[56:59], v7 offset:2560
ds_read_b128 v[60:63], v7 offset:2592
ds_read_b128 v[64:67], v7 offset:2624
s_add_u32 m0, s42, 0
s_mov_b32 s43, 0
buffer_load_dwordx4 v248, s[36:39], s43 offen offset:0 lds
buffer_load_dwordx4 v248, s[36:39], s43 offen offset:1024 lds
s_waitcnt lgkmcnt(11)
v_mfma_f32_32x32x16_bf16 v[172:187], v[156:159], v[92:95], 0
buffer_load_dwordx4 v248, s[36:39], s43 offen offset:2048 lds
v_mfma_f32_32x32x16_bf16 v[188:203], v[156:159], v[100:103], 0
s_waitcnt lgkmcnt(9)
v_mfma_f32_32x32x16_bf16 v[204:219], v[164:167], v[92:95], 0
buffer_load_dwordx4 v248, s[36:39], s43 offen offset:3072 lds
v_mfma_f32_32x32x16_bf16 v[220:235], v[164:167], v[100:103], 0
v_mfma_f32_32x32x16_bf16 v[172:187], v[160:163], v[96:99], v[172:187]
s_add_u32 m0, s42, 4096
s_mov_b32 s43, 4096
buffer_load_dwordx4 v248, s[36:39], s43 offen offset:0 lds
v_mfma_f32_32x32x16_bf16 v[188:203], v[160:163], v[104:107], v[188:203]
v_mfma_f32_32x32x16_bf16 v[204:219], v[168:171], v[96:99], v[204:219]
buffer_load_dwordx4 v255, s[36:39], s43 offen offset:1024 lds
v_mfma_f32_32x32x16_bf16 v[220:235], v[168:171], v[104:107], v[220:235]
v_cmp_eq_u32 vcc, 0, v3
    s_nop 3
v_pk_mul_f32 v[20:21], v[172:173], v[108:109]
    s_nop 2
v_pk_mul_f32 v[22:23], v[188:189], v[108:109]
v_pk_fma_f32 v[20:21], v[188:189], v[124:125], v[20:21] neg_lo:[1,0,0] neg_hi:[1,0,0]
v_pk_fma_f32 v[22:23], v[172:173], v[124:125], v[22:23]
v_cvt_pk_bf16_f32 v156, v20, v21
v_cvt_pk_bf16_f32 v164, v22, v23
buffer_load_dwordx4 v255, s[36:39], s43 offen offset:2048 lds
v_pk_mul_f32 v[20:21], v[174:175], v[110:111]
v_pk_mul_f32 v[22:23], v[190:191], v[110:111]
v_pk_fma_f32 v[20:21], v[190:191], v[126:127], v[20:21] neg_lo:[1,0,0] neg_hi:[1,0,0]
v_pk_fma_f32 v[22:23], v[174:175], v[126:127], v[22:23]
v_cvt_pk_bf16_f32 v157, v20, v21
v_cvt_pk_bf16_f32 v165, v22, v23
s_add_u32 m0, s42, 28672
s_mov_b32 s43, 442368
buffer_load_dwordx4 v248, s[36:39], s43 offen offset:0 lds
v_pk_mul_f32 v[20:21], v[176:177], v[112:113]
v_pk_mul_f32 v[22:23], v[192:193], v[112:113]
v_pk_fma_f32 v[20:21], v[192:193], v[128:129], v[20:21] neg_lo:[1,0,0] neg_hi:[1,0,0]
v_pk_fma_f32 v[22:23], v[176:177], v[128:129], v[22:23]
v_cvt_pk_bf16_f32 v158, v20, v21
v_cvt_pk_bf16_f32 v166, v22, v23
buffer_load_dwordx4 v248, s[36:39], s43 offen offset:1024 lds
v_pk_mul_f32 v[20:21], v[178:179], v[114:115]
v_pk_mul_f32 v[22:23], v[194:195], v[114:115]
v_pk_fma_f32 v[20:21], v[194:195], v[130:131], v[20:21] neg_lo:[1,0,0] neg_hi:[1,0,0]
wu_28:
s_cbranch_execz wu_ret2
v_pk_fma_f32 v[22:23], v[178:179], v[130:131], v[22:23]
v_cvt_pk_bf16_f32 v159, v20, v21
v_cvt_pk_bf16_f32 v167, v22, v23
buffer_load_dwordx4 v248, s[36:39], s43 offen offset:2048 lds
v_pk_mul_f32 v[20:21], v[180:181], v[116:117]
v_pk_mul_f32 v[22:23], v[196:197], v[116:117]
v_pk_fma_f32 v[20:21], v[196:197], v[132:133], v[20:21] neg_lo:[1,0,0] neg_hi:[1,0,0]
v_pk_fma_f32 v[22:23], v[180:181], v[132:133], v[22:23]
v_cvt_pk_bf16_f32 v160, v20, v21
v_cvt_pk_bf16_f32 v168, v22, v23
buffer_load_dwordx4 v248, s[36:39], s43 offen offset:3072 lds
v_pk_mul_f32 v[20:21], v[182:183], v[118:119]
v_pk_mul_f32 v[22:23], v[198:199], v[118:119]
v_pk_fma_f32 v[20:21], v[198:199], v[134:135], v[20:21] neg_lo:[1,0,0] neg_hi:[1,0,0]
v_pk_fma_f32 v[22:23], v[182:183], v[134:135], v[22:23]
v_cvt_pk_bf16_f32 v161, v20, v21
v_cvt_pk_bf16_f32 v169, v22, v23
s_add_u32 m0, s42, 32768
s_mov_b32 s43, 446464
buffer_load_dwordx4 v248, s[36:39], s43 offen offset:0 lds
v_pk_mul_f32 v[20:21], v[184:185], v[120:121]
v_pk_mul_f32 v[22:23], v[200:201], v[120:121]
v_pk_fma_f32 v[20:21], v[200:201], v[136:137], v[20:21] neg_lo:[1,0,0] neg_hi:[1,0,0]
v_pk_fma_f32 v[22:23], v[184:185], v[136:137], v[22:23]
v_cvt_pk_bf16_f32 v162, v20, v21
v_cvt_pk_bf16_f32 v170, v22, v23
buffer_load_dwordx4 v255, s[36:39], s43 offen offset:1024 lds
v_pk_mul_f32 v[20:21], v[186:187], v[122:123]
v_pk_mul_f32 v[22:23], v[202:203], v[122:123]
v_pk_fma_f32 v[20:21], v[202:203], v[138:139], v[20:21] neg_lo:[1,0,0] neg_hi:[1,0,0]
v_pk_fma_f32 v[22:23], v[186:187], v[138:139], v[22:23]
v_cvt_pk_bf16_f32 v163, v20, v21
v_cvt_pk_bf16_f32 v171, v22, v23
buffer_load_dwordx4 v255, s[36:39], s43 offen offset:2048 lds
v_pk_mul_f32 v[20:21], v[204:205], v[108:109]
v_pk_mul_f32 v[22:23], v[220:221], v[108:109]
v_pk_fma_f32 v[20:21], v[220:221], v[124:125], v[20:21] neg_lo:[1,0,0] neg_hi:[1,0,0]
v_pk_fma_f32 v[22:23], v[204:205], v[124:125], v[22:23]
v_cvt_pk_bf16_f32 v8, v20, v21
v_cvt_pk_bf16_f32 v236, v22, v23
s_add_u32 m0, s42, 57344
s_mov_b32 s43, 884736
buffer_load_dwordx4 v248, s[36:39], s43 offen offset:0 lds
v_pk_mul_f32 v[20:21], v[206:207], v[110:111]
v_pk_mul_f32 v[22:23], v[222:223], v[110:111]
v_pk_fma_f32 v[20:21], v[222:223], v[126:127], v[20:21] neg_lo:[1,0,0] neg_hi:[1,0,0]
v_pk_fma_f32 v[22:23], v[206:207], v[126:127], v[22:23]
v_cvt_pk_bf16_f32 v9, v20, v21
v_cvt_pk_bf16_f32 v237, v22, v23
buffer_load_dwordx4 v248, s[36:39], s43 offen offset:1024 lds
v_pk_mul_f32 v[20:21], v[208:209], v[112:113]
v_pk_mul_f32 v[22:23], v[224:225], v[112:113]
v_pk_fma_f32 v[20:21], v[224:225], v[128:129], v[20:21] neg_lo:[1,0,0] neg_hi:[1,0,0]
v_pk_fma_f32 v[22:23], v[208:209], v[128:129], v[22:23]
v_cvt_pk_bf16_f32 v10, v20, v21
v_cvt_pk_bf16_f32 v238, v22, v23
buffer_load_dwordx4 v248, s[36:39], s43 offen offset:2048 lds
v_pk_mul_f32 v[20:21], v[210:211], v[114:115]
v_pk_mul_f32 v[22:23], v[226:227], v[114:115]
v_pk_fma_f32 v[20:21], v[226:227], v[130:131], v[20:21] neg_lo:[1,0,0] neg_hi:[1,0,0]
v_pk_fma_f32 v[22:23], v[210:211], v[130:131], v[22:23]
v_cvt_pk_bf16_f32 v11, v20, v21
v_cvt_pk_bf16_f32 v239, v22, v23
buffer_load_dwordx4 v248, s[36:39], s43 offen offset:3072 lds
wu_29:
s_cbranch_execz wu_ret2
v_pk_mul_f32 v[20:21], v[212:213], v[116:117]
v_pk_mul_f32 v[22:23], v[228:229], v[116:117]
v_pk_fma_f32 v[20:21], v[228:229], v[132:133], v[20:21] neg_lo:[1,0,0] neg_hi:[1,0,0]
v_pk_fma_f32 v[22:23], v[212:213], v[132:133], v[22:23]
v_cvt_pk_bf16_f32 v12, v20, v21
v_cvt_pk_bf16_f32 v240, v22, v23
s_add_u32 m0, s42, 61440
s_mov_b32 s43, 888832
buffer_load_dwordx4 v248, s[36:39], s43 offen offset:0 lds
v_pk_mul_f32 v[20:21], v[214:215], v[118:119]
v_pk_mul_f32 v[22:23], v[230:231], v[118:119]
v_pk_fma_f32 v[20:21], v[230:231], v[134:135], v[20:21] neg_lo:[1,0,0] neg_hi:[1,0,0]
v_pk_fma_f32 v[22:23], v[214:215], v[134:135], v[22:23]
v_cvt_pk_bf16_f32 v13, v20, v21
v_cvt_pk_bf16_f32 v241, v22, v23
buffer_load_dwordx4 v255, s[36:39], s43 offen offset:1024 lds
v_pk_mul_f32 v[20:21], v[216:217], v[120:121]
v_pk_mul_f32 v[22:23], v[232:233], v[120:121]
v_pk_fma_f32 v[20:21], v[232:233], v[136:137], v[20:21] neg_lo:[1,0,0] neg_hi:[1,0,0]
v_pk_fma_f32 v[22:23], v[216:217], v[136:137], v[22:23]
v_cvt_pk_bf16_f32 v14, v20, v21
v_cvt_pk_bf16_f32 v242, v22, v23
buffer_load_dwordx4 v255, s[36:39], s43 offen offset:2048 lds
v_pk_mul_f32 v[20:21], v[218:219], v[122:123]
v_pk_mul_f32 v[22:23], v[234:235], v[122:123]
v_pk_fma_f32 v[20:21], v[234:235], v[138:139], v[20:21] neg_lo:[1,0,0] neg_hi:[1,0,0]
v_pk_fma_f32 v[22:23], v[218:219], v[138:139], v[22:23]
v_cvt_pk_bf16_f32 v15, v20, v21
v_cvt_pk_bf16_f32 v243, v22, v23
s_add_u32 m0, s42, 86016
s_mov_b32 s43, 1327104
buffer_load_dwordx4 v248, s[36:39], s43 offen offset:0 lds
v_mfma_f32_32x32x16_bf16 v[172:187], v[156:159], v[140:143], 0
buffer_load_dwordx4 v248, s[36:39], s43 offen offset:1024 lds
v_mfma_f32_32x32x16_bf16 v[204:219], v[8:11], v[140:143], 0
buffer_load_dwordx4 v248, s[36:39], s43 offen offset:2048 lds
v_mfma_f32_32x32x16_bf16 v[172:187], v[164:167], v[148:151], v[172:187]
v_mfma_f32_32x32x16_bf16 v[204:219], v[236:239], v[148:151], v[204:219]
v_mfma_f32_32x32x16_bf16 v[172:187], v[160:163], v[144:147], v[172:187]
buffer_load_dwordx4 v248, s[36:39], s43 offen offset:3072 lds
v_mfma_f32_32x32x16_bf16 v[204:219], v[12:15], v[144:147], v[204:219]
s_add_u32 m0, s42, 90112
s_mov_b32 s43, 1331200
buffer_load_dwordx4 v248, s[36:39], s43 offen offset:0 lds
v_mfma_f32_32x32x16_bf16 v[172:187], v[168:171], v[152:155], v[172:187]
v_mfma_f32_32x32x16_bf16 v[204:219], v[240:243], v[152:155], v[204:219]
s_waitcnt lgkmcnt(0)
v_cndmask_b32 v40, 0, v40, vcc
v_cndmask_b32 v41, 0, v41, vcc
v_cndmask_b32 v42, 0, v42, vcc
v_cndmask_b32 v43, 0, v43, vcc
    s_nop 5
v_pk_fma_f32 v[68:69], v[32:33], v[172:173], v[68:69]
v_pk_fma_f32 v[70:71], v[34:35], v[174:175], v[70:71]
v_pk_fma_f32 v[72:73], v[36:37], v[176:177], v[72:73]
v_pk_fma_f32 v[74:75], v[38:39], v[178:179], v[74:75]
v_pk_fma_f32 v[76:77], v[40:41], v[180:181], v[76:77]
v_pk_fma_f32 v[78:79], v[42:43], v[182:183], v[78:79]
v_pk_fma_f32 v[80:81], v[32:33], v[204:205], v[80:81]
v_pk_fma_f32 v[82:83], v[34:35], v[206:207], v[82:83]
v_pk_fma_f32 v[84:85], v[36:37], v[208:209], v[84:85]
v_pk_fma_f32 v[86:87], v[38:39], v[210:211], v[86:87]
v_pk_fma_f32 v[88:89], v[40:41], v[212:213], v[88:89]
v_pk_fma_f32 v[90:91], v[42:43], v[214:215], v[90:91]
v_cvt_pk_bf16_f32 v20, v68, v69
v_cvt_pk_bf16_f32 v21, v70, v71
wu_30:
s_cbranch_execz wu_ret2
v_cvt_pk_bf16_f32 v22, v72, v73
v_cvt_pk_bf16_f32 v23, v74, v75
v_cvt_pk_bf16_f32 v24, v76, v77
v_cvt_pk_bf16_f32 v25, v78, v79
v_cvt_pk_bf16_f32 v26, v80, v81
v_cvt_pk_bf16_f32 v27, v82, v83
v_cvt_pk_bf16_f32 v28, v84, v85
v_cvt_pk_bf16_f32 v29, v86, v87
v_cvt_pk_bf16_f32 v30, v88, v89
v_cvt_pk_bf16_f32 v31, v90, v91
s_mul_i32 s26, s3, 2592
s_add_u32 s26, s26, 127104
v_mul_u32_u24 v4, 40, v2
v_lshl_add_u32 v4, v3, 3, v4
v_add_u32 v4, s26, v4
v_lshlrev_b32 v7, 3, v1
v_add_u32 v7, 147840, v7
v_add_u32 v6, 32, v4
v_cndmask_b32 v5, v7, v6, vcc
ds_write_b64 v4, v[20:21] offset:0
ds_write_b64 v4, v[22:23] offset:16
ds_write_b64 v4, v[26:27] offset:1296
ds_write_b64 v4, v[28:29] offset:1312
v_add_u32 v6, 1296, v6
v_cndmask_b32 v6, v7, v6, vcc
ds_write_b64 v5, v[24:25]
ds_write_b64 v6, v[30:31]
v_pk_add_f32 v[32:33], v[68:69], v[70:71]
v_pk_add_f32 v[34:35], v[80:81], v[82:83]
v_pk_add_f32 v[32:33], v[32:33], v[72:73]
v_pk_add_f32 v[34:35], v[34:35], v[84:85]
v_pk_add_f32 v[32:33], v[32:33], v[74:75]
v_pk_add_f32 v[34:35], v[34:35], v[86:87]
v_pk_add_f32 v[32:33], v[32:33], v[76:77]
v_pk_add_f32 v[34:35], v[34:35], v[88:89]
v_pk_add_f32 v[32:33], v[32:33], v[78:79]
v_pk_add_f32 v[34:35], v[34:35], v[90:91]
v_add_f32 v32, v32, v33
v_add_f32 v34, v34, v35
buffer_load_dwordx4 v255, s[36:39], s43 offen offset:1024 lds
buffer_load_dwordx4 v255, s[36:39], s43 offen offset:2048 lds
v_add_f32_dpp v32, v32, v32 quad_perm:[1,0,3,2] row_mask:0xf bank_mask:0xf
v_add_f32_dpp v34, v34, v34 quad_perm:[1,0,3,2] row_mask:0xf bank_mask:0xf
    s_nop 0
v_add_f32_dpp v32, v32, v32 quad_perm:[2,3,0,1] row_mask:0xf bank_mask:0xf
v_add_f32_dpp v34, v34, v34 quad_perm:[2,3,0,1] row_mask:0xf bank_mask:0xf
    s_nop 0
v_add_f32_dpp v32, v32, v32 row_ror:4 row_mask:0xf bank_mask:0xf
v_add_f32_dpp v34, v34, v34 row_ror:4 row_mask:0xf bank_mask:0xf
    s_nop 0
v_add_f32_dpp v32, v32, v32 row_ror:8 row_mask:0xf bank_mask:0xf
v_add_f32_dpp v34, v34, v34 row_ror:8 row_mask:0xf bank_mask:0xf
v_mov_b32 v36, v32
v_mov_b32 v38, v34
    s_nop 0
v_permlane16_swap_b32 v32, v36
v_permlane16_swap_b32 v34, v38
v_add_f32 v32, v32, v36
v_add_f32 v34, v34, v38
v_mov_b32 v36, v32
v_mov_b32 v38, v34
    s_nop 0
v_permlane32_swap_b32 v32, v36
v_permlane32_swap_b32 v34, v38
v_add_f32 v32, v32, v36
v_add_f32 v34, v34, v38
s_mov_b32 s51, 0
buffer_load_dwordx4 a[0:3], v246, s[32:35], s51 offen offset:0
buffer_load_dwordx4 a[4:7], v246, s[32:35], s51 offen offset:1024
v_mul_f32 v32, 0x3acccccd, v32
v_cndmask_b32 v33, 0, v32, vcc
v_mul_f32 v34, 0x3acccccd, v34
v_cndmask_b32 v35, 0, v34, vcc
v_pk_add_f32 v[68:69], v[68:69], v[32:33] op_sel_hi:[1,0] neg_lo:[0,1] neg_hi:[0,1]
v_pk_add_f32 v[80:81], v[80:81], v[34:35] op_sel_hi:[1,0] neg_lo:[0,1] neg_hi:[0,1]
v_pk_add_f32 v[70:71], v[70:71], v[32:33] op_sel_hi:[1,0] neg_lo:[0,1] neg_hi:[0,1]
v_pk_add_f32 v[82:83], v[82:83], v[34:35] op_sel_hi:[1,0] neg_lo:[0,1] neg_hi:[0,1]
buffer_load_dwordx4 a[8:11], v246, s[32:35], s51 offen offset:2048
wu_31:
s_cbranch_execz wu_ret2
v_pk_add_f32 v[72:73], v[72:73], v[32:33] op_sel_hi:[1,0] neg_lo:[0,1] neg_hi:[0,1]
v_pk_add_f32 v[84:85], v[84:85], v[34:35] op_sel_hi:[1,0] neg_lo:[0,1] neg_hi:[0,1]
v_pk_add_f32 v[74:75], v[74:75], v[32:33] op_sel_hi:[1,0] neg_lo:[0,1] neg_hi:[0,1]
v_pk_add_f32 v[86:87], v[86:87], v[34:35] op_sel_hi:[1,0] neg_lo:[0,1] neg_hi:[0,1]
buffer_load_dwordx4 a[12:15], v246, s[32:35], s51 offen offset:3072
v_pk_add_f32 v[76:77], v[76:77], v[32:33] op_sel:[0,1] op_sel_hi:[1,1] neg_lo:[0,1] neg_hi:[0,1]
v_pk_add_f32 v[88:89], v[88:89], v[34:35] op_sel:[0,1] op_sel_hi:[1,1] neg_lo:[0,1] neg_hi:[0,1]
v_pk_add_f32 v[78:79], v[78:79], v[32:33] op_sel:[0,1] op_sel_hi:[1,1] neg_lo:[0,1] neg_hi:[0,1]
v_pk_add_f32 v[90:91], v[90:91], v[34:35] op_sel:[0,1] op_sel_hi:[1,1] neg_lo:[0,1] neg_hi:[0,1]
buffer_load_dwordx4 a[16:19], v247, s[32:35], s51 offen
v_pk_mul_f32 v[40:41], v[68:69], v[68:69]
v_pk_mul_f32 v[42:43], v[80:81], v[80:81]
v_pk_fma_f32 v[40:41], v[70:71], v[70:71], v[40:41]
v_pk_fma_f32 v[42:43], v[82:83], v[82:83], v[42:43]
s_mov_b32 s51, 40960
buffer_load_dwordx4 a[20:23], v246, s[32:35], s51 offen offset:0
v_pk_fma_f32 v[40:41], v[72:73], v[72:73], v[40:41]
v_pk_fma_f32 v[42:43], v[84:85], v[84:85], v[42:43]
v_pk_fma_f32 v[40:41], v[74:75], v[74:75], v[40:41]
v_pk_fma_f32 v[42:43], v[86:87], v[86:87], v[42:43]
buffer_load_dwordx4 a[24:27], v246, s[32:35], s51 offen offset:1024
v_pk_fma_f32 v[40:41], v[76:77], v[76:77], v[40:41]
v_pk_fma_f32 v[42:43], v[88:89], v[88:89], v[42:43]
v_pk_fma_f32 v[40:41], v[78:79], v[78:79], v[40:41]
v_pk_fma_f32 v[42:43], v[90:91], v[90:91], v[42:43]
buffer_load_dwordx4 a[28:31], v246, s[32:35], s51 offen offset:2048
v_add_f32 v40, v40, v41
v_add_f32 v42, v42, v43
buffer_load_dwordx4 a[32:35], v246, s[32:35], s51 offen offset:3072
buffer_load_dwordx4 a[36:39], v247, s[32:35], s51 offen
v_add_f32_dpp v40, v40, v40 quad_perm:[1,0,3,2] row_mask:0xf bank_mask:0xf
v_add_f32_dpp v42, v42, v42 quad_perm:[1,0,3,2] row_mask:0xf bank_mask:0xf
    s_nop 0
v_add_f32_dpp v40, v40, v40 quad_perm:[2,3,0,1] row_mask:0xf bank_mask:0xf
v_add_f32_dpp v42, v42, v42 quad_perm:[2,3,0,1] row_mask:0xf bank_mask:0xf
    s_nop 0
v_add_f32_dpp v40, v40, v40 row_ror:4 row_mask:0xf bank_mask:0xf
v_add_f32_dpp v42, v42, v42 row_ror:4 row_mask:0xf bank_mask:0xf
    s_nop 0
v_add_f32_dpp v40, v40, v40 row_ror:8 row_mask:0xf bank_mask:0xf
v_add_f32_dpp v42, v42, v42 row_ror:8 row_mask:0xf bank_mask:0xf
v_mov_b32 v36, v40
v_mov_b32 v38, v42
    s_nop 0
v_permlane16_swap_b32 v40, v36
v_permlane16_swap_b32 v42, v38
v_add_f32 v40, v40, v36
v_add_f32 v42, v42, v38
v_mov_b32 v36, v40
v_mov_b32 v38, v42
    s_nop 0
v_permlane32_swap_b32 v40, v36
v_permlane32_swap_b32 v42, v38
v_add_f32 v40, v40, v36
v_add_f32 v42, v42, v38
s_mov_b32 s51, 81920
buffer_load_dwordx4 a[40:43], v246, s[32:35], s51 offen offset:0
buffer_load_dwordx4 a[44:47], v246, s[32:35], s51 offen offset:1024
v_mov_b32 v32, 0x3727c5ac
v_fmac_f32 v32, 0x3acccccd, v40
v_mov_b32 v34, 0x3727c5ac
v_fmac_f32 v34, 0x3acccccd, v42
v_rsq_f32 v32, v32
v_rsq_f32 v34, v34
v_pk_mul_f32 v[68:69], v[68:69], v[32:33] op_sel_hi:[1,0]
v_pk_mul_f32 v[80:81], v[80:81], v[34:35] op_sel_hi:[1,0]
v_pk_fma_f32 v[68:69], v[68:69], v[44:45], v[56:57]
v_pk_fma_f32 v[80:81], v[80:81], v[44:45], v[56:57]
buffer_load_dwordx4 a[48:51], v246, s[32:35], s51 offen offset:2048
v_pk_mul_f32 v[70:71], v[70:71], v[32:33] op_sel_hi:[1,0]
v_pk_mul_f32 v[82:83], v[82:83], v[34:35] op_sel_hi:[1,0]
v_pk_fma_f32 v[70:71], v[70:71], v[46:47], v[58:59]
v_pk_fma_f32 v[82:83], v[82:83], v[46:47], v[58:59]
buffer_load_dwordx4 a[52:55], v246, s[32:35], s51 offen offset:3072
wu_32:
s_cbranch_execz wu_ret2
v_pk_mul_f32 v[72:73], v[72:73], v[32:33] op_sel_hi:[1,0]
v_pk_mul_f32 v[84:85], v[84:85], v[34:35] op_sel_hi:[1,0]
v_pk_fma_f32 v[72:73], v[72:73], v[48:49], v[60:61]
v_pk_fma_f32 v[84:85], v[84:85], v[48:49], v[60:61]
buffer_load_dwordx4 a[56:59], v247, s[32:35], s51 offen
v_pk_mul_f32 v[74:75], v[74:75], v[32:33] op_sel_hi:[1,0]
v_pk_mul_f32 v[86:87], v[86:87], v[34:35] op_sel_hi:[1,0]
v_pk_fma_f32 v[74:75], v[74:75], v[50:51], v[62:63]
v_pk_fma_f32 v[86:87], v[86:87], v[50:51], v[62:63]
v_pk_mul_f32 v[76:77], v[76:77], v[32:33] op_sel_hi:[1,0]
v_pk_mul_f32 v[88:89], v[88:89], v[34:35] op_sel_hi:[1,0]
v_pk_fma_f32 v[76:77], v[76:77], v[52:53], v[64:65]
v_pk_fma_f32 v[88:89], v[88:89], v[52:53], v[64:65]
v_pk_mul_f32 v[78:79], v[78:79], v[32:33] op_sel_hi:[1,0]
v_pk_mul_f32 v[90:91], v[90:91], v[34:35] op_sel_hi:[1,0]
v_pk_fma_f32 v[78:79], v[78:79], v[54:55], v[66:67]
v_pk_fma_f32 v[90:91], v[90:91], v[54:55], v[66:67]
v_cvt_pk_bf16_f32 v8, v68, v69
v_cvt_pk_bf16_f32 v9, v70, v71
v_cvt_pk_bf16_f32 v10, v72, v73
v_cvt_pk_bf16_f32 v11, v74, v75
v_cvt_pk_bf16_f32 v12, v76, v77
v_cvt_pk_bf16_f32 v13, v78, v79
v_cvt_pk_bf16_f32 v14, v80, v81
v_cvt_pk_bf16_f32 v15, v82, v83
v_cvt_pk_bf16_f32 v16, v84, v85
v_cvt_pk_bf16_f32 v17, v86, v87
v_cvt_pk_bf16_f32 v18, v88, v89
v_cvt_pk_bf16_f32 v19, v90, v91
ds_write_b64 v4, v[8:9] offset:10368
ds_write_b64 v4, v[10:11] offset:10384
ds_write_b64 v4, v[14:15] offset:11664
ds_write_b64 v4, v[16:17] offset:11680
v_subrev_u32 v7, 10368, v7
v_add_u32 v36, 32, v4
v_cndmask_b32 v37, v7, v36, vcc
v_add_u32 v36, 1296, v36
v_cndmask_b32 v36, v7, v36, vcc
ds_write_b64 v37, v[12:13] offset:10368
ds_write_b64 v36, v[18:19] offset:10368
v_and_b32 v4, 7, v0
v_lshrrev_b32 v5, 3, v0
v_mul_u32_u24 v6, 1296, v4
v_lshl_add_u32 v6, v5, 4, v6
v_add_u32 v6, 137472, v6
s_lshl_b32 s26, s48, 4
s_lshr_b32 s27, s49, 1
s_add_u32 s26, s26, s27
s_mul_i32 s26, s26, 20480
s_and_b32 s27, s49, 1
s_lshl_b32 s27, s27, 7
s_add_u32 s26, s26, s27
v_lshlrev_b32 v5, 8, v5
v_lshl_add_u32 v5, v4, 4, v5
v_add_u32 v5, s26, v5
v_lshrrev_b32 v4, 5, v0
v_mul_u32_u24 v7, 1296, v4
v_lshl_add_u32 v7, v2, 4, v7
v_add_u32 v7, 127104, v7
s_lshl_b32 s26, s21, 9
s_add_u32 s26, s26, s20
s_mul_i32 s26, s26, 1280
v_mul_u32_u24 v4, 81920, v4
v_lshl_add_u32 v4, v2, 4, v4
v_add_u32 v252, s26, v4
v_add_u32 v253, 0x40000000, v252
v_cmp_gt_u32 vcc, 16, v2
    s_nop 1
v_cndmask_b32 v253, v253, v252, vcc
v_add_u32 v37, 0x40000000, v5
s_cmp_lt_u32 s3, 2
s_cselect_b64 vcc, -1, 0
v_cndmask_b32 v37, v37, v5, vcc
s_add_u32 s16, s4, 0xd00000
s_addc_u32 s17, s5, 0
s_mov_b32 s18, 0x280000
wu_33:
s_cbranch_execz wu_ret2
s_mov_b32 s19, 0x20000
s_add_u32 s28, s4, 0xa00000
s_addc_u32 s29, s5, 0
s_mov_b32 s30, 0x280000
s_mov_b32 s31, 0x20000
s_waitcnt lgkmcnt(0)
s_barrier
ds_read_b128 v[8:11], v6 offset:0
ds_read_b128 v[12:15], v6 offset:512
ds_read_b128 v[16:19], v6 offset:1024
ds_read_b128 a[240:243], v7 offset:0
ds_read_b128 a[244:247], v7 offset:512
ds_read_b128 a[248:251], v7 offset:1024
s_movk_i32 s26, 8192
s_movk_i32 s27, 16384
s_waitcnt lgkmcnt(5)
buffer_store_dwordx4 v[8:11], v5, s[16:19], 0 offen sc0 sc1
s_waitcnt lgkmcnt(4)
buffer_store_dwordx4 v[12:15], v5, s[16:19], s26 offen sc0 sc1
s_waitcnt lgkmcnt(3)
buffer_store_dwordx4 v[16:19], v37, s[16:19], s27 offen sc0 sc1
s_mov_b32 s51, 122880
buffer_load_dwordx4 a[60:63], v246, s[32:35], s51 offen offset:0
buffer_load_dwordx4 a[64:67], v246, s[32:35], s51 offen offset:1024
buffer_load_dwordx4 a[68:71], v246, s[32:35], s51 offen offset:2048
buffer_load_dwordx4 a[72:75], v246, s[32:35], s51 offen offset:3072
buffer_load_dwordx4 a[76:79], v247, s[32:35], s51 offen
s_mov_b32 s51, 163840
buffer_load_dwordx4 a[80:83], v246, s[32:35], s51 offen offset:0
buffer_load_dwordx4 a[84:87], v246, s[32:35], s51 offen offset:1024
buffer_load_dwordx4 a[88:91], v246, s[32:35], s51 offen offset:2048
buffer_load_dwordx4 a[92:95], v246, s[32:35], s51 offen offset:3072
buffer_load_dwordx4 a[96:99], v247, s[32:35], s51 offen
s_mov_b32 s51, 204800
buffer_load_dwordx4 a[100:103], v246, s[32:35], s51 offen offset:0
buffer_load_dwordx4 a[104:107], v246, s[32:35], s51 offen offset:1024
buffer_load_dwordx4 a[108:111], v246, s[32:35], s51 offen offset:2048
buffer_load_dwordx4 a[112:115], v246, s[32:35], s51 offen offset:3072
buffer_load_dwordx4 a[116:119], v247, s[32:35], s51 offen
s_lshl_b32 s20, s40, 3
s_lshl_b32 s21, s3, 1
s_add_u32 s20, s20, s21
v_lshlrev_b32 v4, 4, v1
s_mul_i32 s21, s20, 20480
v_add_u32 v237, s21, v4
v_add_u32 v238, 20480, v237
v_mov_b32 v232, v4
v_add_u32 v233, 28672, v4
v_add_u32 v234, 57344, v4
v_add_u32 v235, 86016, v4
v_add_u32 v236, 114688, v4
s_lshl_b32 s26, s40, 3
s_lshl_b32 s27, s3, 1
s_add_u32 s26, s26, s27
s_mul_i32 s26, s26, 55296
s_lshl_b32 s27, s41, 9
v_lshl_add_u32 v249, v1, 4, s27
v_mov_b32 v241, 0x40000000
s_mov_b32 s50, 55296
v_add_u32 v254, 3072, v249
v_cmp_gt_u32 vcc, s50, v254
v_add_u32 v254, s26, v254
v_cmp_gt_u32 s[50:51], 32, v1
s_and_b64 vcc, vcc, s[50:51]
v_cndmask_b32 v254, v241, v254, vcc
s_mov_b32 s50, 55296
v_add_u32 v251, 2048, v249
v_cmp_gt_u32 vcc, s50, v251
v_add_u32 v251, s26, v251
    s_nop 0
v_cndmask_b32 v251, v241, v251, vcc
s_mov_b32 s50, 55296
v_add_u32 v250, 1024, v249
v_cmp_gt_u32 vcc, s50, v250
v_add_u32 v250, s26, v250
    s_nop 0
v_cndmask_b32 v250, v241, v250, vcc
s_mov_b32 s50, 55296
v_cmp_gt_u32 vcc, s50, v249
v_add_u32 v249, s26, v249
wu_34:
s_cbranch_execz wu_ret2
    s_nop 0
v_cndmask_b32 v249, v241, v249, vcc
v_accvgpr_write_b32 a252, -1
v_accvgpr_write_b32 a253, -1
v_accvgpr_write_b32 a254, -1
v_accvgpr_write_b32 a255, -1
s_add_u32 s16, s4, 0xd00000
s_addc_u32 s17, s5, 0
s_mov_b32 s18, 0x280000
s_mov_b32 s19, 0x20000
s_add_u32 s24, s4, 0x1000000
s_addc_u32 s25, s5, 0
s_mov_b32 s26, 0x6c0000
s_mov_b32 s27, 0x20000
rt_23:
s_movk_i32 s54, 0
buffer_load_dwordx4 v[152:155], v237, s[16:19], s54 offen sc1
buffer_load_dwordx4 v[156:159], v238, s[16:19], s54 offen sc1
s_movk_i32 s54, 1024
buffer_load_dwordx4 v[160:163], v237, s[16:19], s54 offen sc1
buffer_load_dwordx4 v[164:167], v238, s[16:19], s54 offen sc1
s_movk_i32 s54, 2048
buffer_load_dwordx4 v[168:171], v237, s[16:19], s54 offen sc1
buffer_load_dwordx4 v[172:175], v238, s[16:19], s54 offen sc1
s_movk_i32 s54, 3072
buffer_load_dwordx4 v[176:179], v237, s[16:19], s54 offen sc1
buffer_load_dwordx4 v[180:183], v238, s[16:19], s54 offen sc1
s_movk_i32 s54, 4096
buffer_load_dwordx4 v[184:187], v237, s[16:19], s54 offen sc1
buffer_load_dwordx4 v[188:191], v238, s[16:19], s54 offen sc1
s_movk_i32 s54, 5120
buffer_load_dwordx4 v[192:195], v237, s[16:19], s54 offen sc1
buffer_load_dwordx4 v[196:199], v238, s[16:19], s54 offen sc1
s_movk_i32 s54, 6144
buffer_load_dwordx4 v[200:203], v237, s[16:19], s54 offen sc1
buffer_load_dwordx4 v[204:207], v238, s[16:19], s54 offen sc1
s_movk_i32 s54, 7168
buffer_load_dwordx4 v[208:211], v237, s[16:19], s54 offen sc1
buffer_load_dwordx4 v[212:215], v238, s[16:19], s54 offen sc1
s_add_u32 s53, s53, 1
s_waitcnt vmcnt(10)
v_max3_u32 v239, v152, v153, v154
v_max3_u32 v239, v239, v155, v156
v_max3_u32 v239, v239, v157, v158
v_max3_u32 v239, v239, v159, v160
v_max3_u32 v239, v239, v161, v162
v_max3_u32 v239, v239, v163, v164
v_max3_u32 v239, v239, v165, v166
v_max3_u32 v239, v239, v167, v168
v_max3_u32 v239, v239, v169, v170
v_max3_u32 v239, v239, v171, v172
v_max3_u32 v239, v239, v173, v174
v_max_u32 v239, v239, v175
v_cmp_eq_u32 vcc, -1, v239
s_cmp_ge_u32 s53, 4000000
s_cbranch_scc1 rt_23_x
s_cbranch_vccnz rt_23
rt_23_x:
s_waitcnt lgkmcnt(0)
s_barrier
ds_read_b128 v[120:123], v232 offset:0
ds_read_b128 v[124:127], v232 offset:1024
ds_read_b128 v[128:131], v232 offset:2048
ds_read_b128 v[132:135], v232 offset:3072
ds_read_b128 v[136:139], v232 offset:4096
ds_read_b128 v[140:143], v232 offset:5120
s_waitcnt lgkmcnt(5)
v_mfma_f32_16x16x32_bf16 v[8:11], v[120:123], v[152:155], 0
ds_read_b128 v[144:147], v232 offset:6144
v_mfma_f32_16x16x32_bf16 v[12:15], v[120:123], v[156:159], 0
s_waitcnt lgkmcnt(5)
v_mfma_f32_16x16x32_bf16 v[16:19], v[124:127], v[152:155], 0
ds_read_b128 v[148:151], v232 offset:7168
v_mfma_f32_16x16x32_bf16 v[20:23], v[124:127], v[156:159], 0
s_waitcnt lgkmcnt(5)
s_movk_i32 s22, 8192
buffer_load_dwordx4 v[216:219], v237, s[16:19], s22 offen offset:0 sc1
v_mfma_f32_16x16x32_bf16 v[24:27], v[128:131], v[152:155], 0
wu_35:
s_cbranch_execz wu_ret2
ds_read_b128 v[120:123], v232 offset:8192
v_mfma_f32_16x16x32_bf16 v[28:31], v[128:131], v[156:159], 0
s_waitcnt lgkmcnt(5)
v_mfma_f32_16x16x32_bf16 v[32:35], v[132:135], v[152:155], 0
ds_read_b128 v[124:127], v232 offset:9216
v_mfma_f32_16x16x32_bf16 v[36:39], v[132:135], v[156:159], 0
s_waitcnt lgkmcnt(5)
buffer_load_dwordx4 v[220:223], v238, s[16:19], s22 offen offset:0 sc1
v_mfma_f32_16x16x32_bf16 v[40:43], v[136:139], v[152:155], 0
ds_read_b128 v[128:131], v232 offset:10240
v_mfma_f32_16x16x32_bf16 v[44:47], v[136:139], v[156:159], 0
s_waitcnt lgkmcnt(5)
v_mfma_f32_16x16x32_bf16 v[48:51], v[140:143], v[152:155], 0
ds_read_b128 v[132:135], v232 offset:11264
v_mfma_f32_16x16x32_bf16 v[52:55], v[140:143], v[156:159], 0
s_waitcnt lgkmcnt(5)
buffer_load_dwordx4 v[224:227], v237, s[16:19], s22 offen offset:1024 sc1
v_mfma_f32_16x16x32_bf16 v[56:59], v[144:147], v[152:155], 0
ds_read_b128 v[136:139], v232 offset:12288
v_mfma_f32_16x16x32_bf16 v[60:63], v[144:147], v[156:159], 0
s_waitcnt lgkmcnt(5)
v_mfma_f32_16x16x32_bf16 v[64:67], v[148:151], v[152:155], 0
ds_read_b128 v[140:143], v232 offset:13312
v_mfma_f32_16x16x32_bf16 v[68:71], v[148:151], v[156:159], 0
s_waitcnt lgkmcnt(5)
buffer_load_dwordx4 v[228:231], v238, s[16:19], s22 offen offset:1024 sc1
v_mfma_f32_16x16x32_bf16 v[72:75], v[120:123], v[152:155], 0
ds_read_b128 v[144:147], v232 offset:14336
v_mfma_f32_16x16x32_bf16 v[76:79], v[120:123], v[156:159], 0
s_waitcnt lgkmcnt(5)
v_mfma_f32_16x16x32_bf16 v[80:83], v[124:127], v[152:155], 0
ds_read_b128 v[148:151], v232 offset:15360
v_mfma_f32_16x16x32_bf16 v[84:87], v[124:127], v[156:159], 0
s_waitcnt lgkmcnt(5)
s_mov_b32 s82, 55296
buffer_store_dwordx4 a[252:255], v249, s[24:27], 0 offen sc0 sc1
v_mfma_f32_16x16x32_bf16 v[88:91], v[128:131], v[152:155], 0
ds_read_b128 v[120:123], v232 offset:16384
v_mfma_f32_16x16x32_bf16 v[92:95], v[128:131], v[156:159], 0
s_waitcnt lgkmcnt(5)
v_mfma_f32_16x16x32_bf16 v[96:99], v[132:135], v[152:155], 0
ds_read_b128 v[124:127], v232 offset:17408
v_mfma_f32_16x16x32_bf16 v[100:103], v[132:135], v[156:159], 0
s_waitcnt lgkmcnt(5)
buffer_store_dwordx4 a[252:255], v250, s[24:27], 0 offen sc0 sc1
v_mfma_f32_16x16x32_bf16 v[104:107], v[136:139], v[152:155], 0
ds_read_b128 v[128:131], v232 offset:18432
v_mfma_f32_16x16x32_bf16 v[108:111], v[136:139], v[156:159], 0
s_waitcnt lgkmcnt(5)
v_mfma_f32_16x16x32_bf16 v[112:115], v[140:143], v[152:155], 0
ds_read_b128 v[132:135], v232 offset:19456
v_mfma_f32_16x16x32_bf16 v[116:119], v[140:143], v[156:159], 0
s_waitcnt lgkmcnt(5)
buffer_load_dwordx4 v[152:155], v237, s[16:19], s22 offen offset:2048 sc1
v_mfma_f32_16x16x32_bf16 v[8:11], v[144:147], v[160:163], v[8:11]
ds_read_b128 v[136:139], v232 offset:20480
v_mfma_f32_16x16x32_bf16 v[12:15], v[144:147], v[164:167], v[12:15]
s_waitcnt lgkmcnt(5)
v_mfma_f32_16x16x32_bf16 v[16:19], v[148:151], v[160:163], v[16:19]
ds_read_b128 v[140:143], v232 offset:21504
v_mfma_f32_16x16x32_bf16 v[20:23], v[148:151], v[164:167], v[20:23]
s_waitcnt lgkmcnt(5)
buffer_load_dwordx4 v[156:159], v238, s[16:19], s22 offen offset:2048 sc1
v_mfma_f32_16x16x32_bf16 v[24:27], v[120:123], v[160:163], v[24:27]
ds_read_b128 v[144:147], v232 offset:22528
v_mfma_f32_16x16x32_bf16 v[28:31], v[120:123], v[164:167], v[28:31]
s_waitcnt lgkmcnt(5)
v_mfma_f32_16x16x32_bf16 v[32:35], v[124:127], v[160:163], v[32:35]
ds_read_b128 v[148:151], v232 offset:23552
v_mfma_f32_16x16x32_bf16 v[36:39], v[124:127], v[164:167], v[36:39]
s_waitcnt lgkmcnt(5)
wu_36:
s_cbranch_execz wu_ret2
v_mfma_f32_16x16x32_bf16 v[40:43], v[128:131], v[160:163], v[40:43]
ds_read_b128 v[120:123], v232 offset:24576
v_mfma_f32_16x16x32_bf16 v[44:47], v[128:131], v[164:167], v[44:47]
s_waitcnt lgkmcnt(5)
v_mfma_f32_16x16x32_bf16 v[48:51], v[132:135], v[160:163], v[48:51]
ds_read_b128 v[124:127], v232 offset:25600
v_mfma_f32_16x16x32_bf16 v[52:55], v[132:135], v[164:167], v[52:55]
s_waitcnt lgkmcnt(5)
v_mfma_f32_16x16x32_bf16 v[56:59], v[136:139], v[160:163], v[56:59]
ds_read_b128 v[128:131], v232 offset:26624
v_mfma_f32_16x16x32_bf16 v[60:63], v[136:139], v[164:167], v[60:63]
s_waitcnt lgkmcnt(5)
v_mfma_f32_16x16x32_bf16 v[64:67], v[140:143], v[160:163], v[64:67]
ds_read_b128 v[132:135], v232 offset:27648
v_mfma_f32_16x16x32_bf16 v[68:71], v[140:143], v[164:167], v[68:71]
s_waitcnt lgkmcnt(5)
v_mfma_f32_16x16x32_bf16 v[72:75], v[144:147], v[160:163], v[72:75]
s_barrier
ds_read_b128 v[136:139], v233 offset:0
v_mfma_f32_16x16x32_bf16 v[76:79], v[144:147], v[164:167], v[76:79]
s_waitcnt lgkmcnt(5)
v_mfma_f32_16x16x32_bf16 v[80:83], v[148:151], v[160:163], v[80:83]
ds_read_b128 v[140:143], v233 offset:1024
v_mfma_f32_16x16x32_bf16 v[84:87], v[148:151], v[164:167], v[84:87]
s_waitcnt lgkmcnt(5)
s_add_u32 m0, s42, 114688
s_mov_b32 s43, 3981312
buffer_load_dwordx4 v248, s[36:39], s43 offen offset:0 lds
v_mfma_f32_16x16x32_bf16 v[88:91], v[120:123], v[160:163], v[88:91]
ds_read_b128 v[144:147], v233 offset:2048
v_mfma_f32_16x16x32_bf16 v[92:95], v[120:123], v[164:167], v[92:95]
s_waitcnt lgkmcnt(5)
v_mfma_f32_16x16x32_bf16 v[96:99], v[124:127], v[160:163], v[96:99]
ds_read_b128 v[148:151], v233 offset:3072
v_mfma_f32_16x16x32_bf16 v[100:103], v[124:127], v[164:167], v[100:103]
s_waitcnt lgkmcnt(5)
buffer_load_dwordx4 v248, s[36:39], s43 offen offset:1024 lds
v_mfma_f32_16x16x32_bf16 v[104:107], v[128:131], v[160:163], v[104:107]
ds_read_b128 v[120:123], v233 offset:4096
v_mfma_f32_16x16x32_bf16 v[108:111], v[128:131], v[164:167], v[108:111]
s_waitcnt lgkmcnt(5)
v_mfma_f32_16x16x32_bf16 v[112:115], v[132:135], v[160:163], v[112:115]
ds_read_b128 v[124:127], v233 offset:5120
v_mfma_f32_16x16x32_bf16 v[116:119], v[132:135], v[164:167], v[116:119]
s_waitcnt lgkmcnt(5)
buffer_load_dwordx4 v[160:163], v237, s[16:19], s22 offen offset:3072 sc1
s_waitcnt vmcnt(19)
v_mfma_f32_16x16x32_bf16 v[8:11], v[136:139], v[168:171], v[8:11]
ds_read_b128 v[128:131], v233 offset:6144
v_max3_u32 v239, v176, v177, v178
v_mfma_f32_16x16x32_bf16 v[12:15], v[136:139], v[172:175], v[12:15]
s_waitcnt lgkmcnt(5)
v_max3_u32 v239, v239, v179, v180
v_mfma_f32_16x16x32_bf16 v[16:19], v[140:143], v[168:171], v[16:19]
ds_read_b128 v[132:135], v233 offset:7168
v_max3_u32 v239, v239, v181, v182
v_mfma_f32_16x16x32_bf16 v[20:23], v[140:143], v[172:175], v[20:23]
s_waitcnt lgkmcnt(5)
buffer_load_dwordx4 v[164:167], v238, s[16:19], s22 offen offset:3072 sc1
v_mfma_f32_16x16x32_bf16 v[24:27], v[144:147], v[168:171], v[24:27]
ds_read_b128 v[136:139], v233 offset:8192
v_max_u32 v239, v239, v183
v_mfma_f32_16x16x32_bf16 v[28:31], v[144:147], v[172:175], v[28:31]
s_waitcnt lgkmcnt(5)
v_cmp_eq_u32 vcc, -1, v239
v_mfma_f32_16x16x32_bf16 v[32:35], v[148:151], v[168:171], v[32:35]
ds_read_b128 v[140:143], v233 offset:9216
s_cbranch_vccnz fx_24
fx_24_b:
v_mfma_f32_16x16x32_bf16 v[36:39], v[148:151], v[172:175], v[36:39]
s_waitcnt lgkmcnt(5)
buffer_load_dwordx4 v248, s[36:39], s43 offen offset:2048 lds
v_mfma_f32_16x16x32_bf16 v[40:43], v[120:123], v[168:171], v[40:43]
ds_read_b128 v[144:147], v233 offset:10240
wu_37:
s_cbranch_execz wu_ret2
v_mfma_f32_16x16x32_bf16 v[44:47], v[120:123], v[172:175], v[44:47]
s_waitcnt lgkmcnt(5)
v_mfma_f32_16x16x32_bf16 v[48:51], v[124:127], v[168:171], v[48:51]
ds_read_b128 v[148:151], v233 offset:11264
v_mfma_f32_16x16x32_bf16 v[52:55], v[124:127], v[172:175], v[52:55]
s_waitcnt lgkmcnt(5)
buffer_load_dwordx4 v248, s[36:39], s43 offen offset:3072 lds
v_mfma_f32_16x16x32_bf16 v[56:59], v[128:131], v[168:171], v[56:59]
ds_read_b128 v[120:123], v233 offset:12288
v_mfma_f32_16x16x32_bf16 v[60:63], v[128:131], v[172:175], v[60:63]
s_waitcnt lgkmcnt(5)
v_mfma_f32_16x16x32_bf16 v[64:67], v[132:135], v[168:171], v[64:67]
ds_read_b128 v[124:127], v233 offset:13312
v_mfma_f32_16x16x32_bf16 v[68:71], v[132:135], v[172:175], v[68:71]
s_waitcnt lgkmcnt(5)
s_add_u32 m0, s42, 118784
s_mov_b32 s43, 3985408
buffer_load_dwordx4 v248, s[36:39], s43 offen offset:0 lds
v_mfma_f32_16x16x32_bf16 v[72:75], v[136:139], v[168:171], v[72:75]
ds_read_b128 v[128:131], v233 offset:14336
v_mfma_f32_16x16x32_bf16 v[76:79], v[136:139], v[172:175], v[76:79]
s_waitcnt lgkmcnt(5)
v_mfma_f32_16x16x32_bf16 v[80:83], v[140:143], v[168:171], v[80:83]
ds_read_b128 v[132:135], v233 offset:15360
v_mfma_f32_16x16x32_bf16 v[84:87], v[140:143], v[172:175], v[84:87]
s_waitcnt lgkmcnt(5)
buffer_load_dwordx4 v255, s[36:39], s43 offen offset:1024 lds
v_mfma_f32_16x16x32_bf16 v[88:91], v[144:147], v[168:171], v[88:91]
ds_read_b128 v[136:139], v233 offset:16384
v_mfma_f32_16x16x32_bf16 v[92:95], v[144:147], v[172:175], v[92:95]
s_waitcnt lgkmcnt(5)
v_mfma_f32_16x16x32_bf16 v[96:99], v[148:151], v[168:171], v[96:99]
ds_read_b128 v[140:143], v233 offset:17408
v_mfma_f32_16x16x32_bf16 v[100:103], v[148:151], v[172:175], v[100:103]
s_waitcnt lgkmcnt(5)
buffer_load_dwordx4 v255, s[36:39], s43 offen offset:2048 lds
v_mfma_f32_16x16x32_bf16 v[104:107], v[120:123], v[168:171], v[104:107]
ds_read_b128 v[144:147], v233 offset:18432
v_mfma_f32_16x16x32_bf16 v[108:111], v[120:123], v[172:175], v[108:111]
s_waitcnt lgkmcnt(5)
v_mfma_f32_16x16x32_bf16 v[112:115], v[124:127], v[168:171], v[112:115]
ds_read_b128 v[148:151], v233 offset:19456
v_mfma_f32_16x16x32_bf16 v[116:119], v[124:127], v[172:175], v[116:119]
s_waitcnt lgkmcnt(5)
s_movk_i32 s22, 12288
buffer_load_dwordx4 v[168:171], v237, s[16:19], s22 offen offset:0 sc1
s_waitcnt vmcnt(24)
v_mfma_f32_16x16x32_bf16 v[8:11], v[128:131], v[176:179], v[8:11]
ds_read_b128 v[120:123], v233 offset:20480
v_max3_u32 v239, v184, v185, v186
v_mfma_f32_16x16x32_bf16 v[12:15], v[128:131], v[180:183], v[12:15]
s_waitcnt lgkmcnt(5)
v_max3_u32 v239, v239, v187, v188
v_mfma_f32_16x16x32_bf16 v[16:19], v[132:135], v[176:179], v[16:19]
ds_read_b128 v[124:127], v233 offset:21504
v_max3_u32 v239, v239, v189, v190
v_mfma_f32_16x16x32_bf16 v[20:23], v[132:135], v[180:183], v[20:23]
s_waitcnt lgkmcnt(5)
buffer_load_dwordx4 v[172:175], v238, s[16:19], s22 offen offset:0 sc1
v_mfma_f32_16x16x32_bf16 v[24:27], v[136:139], v[176:179], v[24:27]
ds_read_b128 v[128:131], v233 offset:22528
v_max_u32 v239, v239, v191
v_mfma_f32_16x16x32_bf16 v[28:31], v[136:139], v[180:183], v[28:31]
s_waitcnt lgkmcnt(5)
v_cmp_eq_u32 vcc, -1, v239
v_mfma_f32_16x16x32_bf16 v[32:35], v[140:143], v[176:179], v[32:35]
ds_read_b128 v[132:135], v233 offset:23552
s_cbranch_vccnz fx_25
fx_25_b:
v_mfma_f32_16x16x32_bf16 v[36:39], v[140:143], v[180:183], v[36:39]
s_waitcnt lgkmcnt(5)
buffer_store_dwordx4 a[252:255], v251, s[24:27], 0 offen sc0 sc1
v_mfma_f32_16x16x32_bf16 v[40:43], v[144:147], v[176:179], v[40:43]
ds_read_b128 v[136:139], v233 offset:24576
wu_38:
s_cbranch_execz wu_ret2
v_mfma_f32_16x16x32_bf16 v[44:47], v[144:147], v[180:183], v[44:47]
s_waitcnt lgkmcnt(5)
v_mfma_f32_16x16x32_bf16 v[48:51], v[148:151], v[176:179], v[48:51]
ds_read_b128 v[140:143], v233 offset:25600
v_mfma_f32_16x16x32_bf16 v[52:55], v[148:151], v[180:183], v[52:55]
s_waitcnt lgkmcnt(5)
v_mfma_f32_16x16x32_bf16 v[56:59], v[120:123], v[176:179], v[56:59]
ds_read_b128 v[144:147], v233 offset:26624
v_mfma_f32_16x16x32_bf16 v[60:63], v[120:123], v[180:183], v[60:63]
s_waitcnt lgkmcnt(5)
v_mfma_f32_16x16x32_bf16 v[64:67], v[124:127], v[176:179], v[64:67]
ds_read_b128 v[148:151], v233 offset:27648
v_mfma_f32_16x16x32_bf16 v[68:71], v[124:127], v[180:183], v[68:71]
s_waitcnt lgkmcnt(5)
v_mfma_f32_16x16x32_bf16 v[72:75], v[128:131], v[176:179], v[72:75]
s_barrier
ds_read_b128 v[120:123], v234 offset:0
v_mfma_f32_16x16x32_bf16 v[76:79], v[128:131], v[180:183], v[76:79]
s_waitcnt lgkmcnt(5)
v_mfma_f32_16x16x32_bf16 v[80:83], v[132:135], v[176:179], v[80:83]
ds_read_b128 v[124:127], v234 offset:1024
v_mfma_f32_16x16x32_bf16 v[84:87], v[132:135], v[180:183], v[84:87]
s_waitcnt lgkmcnt(5)
s_add_u32 m0, s42, 0
s_mov_b32 s43, 1769472
buffer_load_dwordx4 v248, s[36:39], s43 offen offset:0 lds
v_mfma_f32_16x16x32_bf16 v[88:91], v[136:139], v[176:179], v[88:91]
ds_read_b128 v[128:131], v234 offset:2048
v_mfma_f32_16x16x32_bf16 v[92:95], v[136:139], v[180:183], v[92:95]
s_waitcnt lgkmcnt(5)
v_mfma_f32_16x16x32_bf16 v[96:99], v[140:143], v[176:179], v[96:99]
ds_read_b128 v[132:135], v234 offset:3072
v_mfma_f32_16x16x32_bf16 v[100:103], v[140:143], v[180:183], v[100:103]
s_waitcnt lgkmcnt(5)
buffer_load_dwordx4 v248, s[36:39], s43 offen offset:1024 lds
v_mfma_f32_16x16x32_bf16 v[104:107], v[144:147], v[176:179], v[104:107]
ds_read_b128 v[136:139], v234 offset:4096
v_mfma_f32_16x16x32_bf16 v[108:111], v[144:147], v[180:183], v[108:111]
s_waitcnt lgkmcnt(5)
v_mfma_f32_16x16x32_bf16 v[112:115], v[148:151], v[176:179], v[112:115]
ds_read_b128 v[140:143], v234 offset:5120
v_mfma_f32_16x16x32_bf16 v[116:119], v[148:151], v[180:183], v[116:119]
s_waitcnt lgkmcnt(5)
buffer_load_dwordx4 v[176:179], v237, s[16:19], s22 offen offset:1024 sc1
s_waitcnt vmcnt(27)
v_mfma_f32_16x16x32_bf16 v[8:11], v[120:123], v[184:187], v[8:11]
ds_read_b128 v[144:147], v234 offset:6144
v_max3_u32 v239, v192, v193, v194
v_mfma_f32_16x16x32_bf16 v[12:15], v[120:123], v[188:191], v[12:15]
s_waitcnt lgkmcnt(5)
v_max3_u32 v239, v239, v195, v196
v_mfma_f32_16x16x32_bf16 v[16:19], v[124:127], v[184:187], v[16:19]
ds_read_b128 v[148:151], v234 offset:7168
v_max3_u32 v239, v239, v197, v198
v_mfma_f32_16x16x32_bf16 v[20:23], v[124:127], v[188:191], v[20:23]
s_waitcnt lgkmcnt(5)
buffer_load_dwordx4 v[180:183], v238, s[16:19], s22 offen offset:1024 sc1
v_mfma_f32_16x16x32_bf16 v[24:27], v[128:131], v[184:187], v[24:27]
ds_read_b128 v[120:123], v234 offset:8192
v_max_u32 v239, v239, v199
v_mfma_f32_16x16x32_bf16 v[28:31], v[128:131], v[188:191], v[28:31]
s_waitcnt lgkmcnt(5)
v_cmp_eq_u32 vcc, -1, v239
v_mfma_f32_16x16x32_bf16 v[32:35], v[132:135], v[184:187], v[32:35]
ds_read_b128 v[124:127], v234 offset:9216
s_cbranch_vccnz fx_26
fx_26_b:
v_mfma_f32_16x16x32_bf16 v[36:39], v[132:135], v[188:191], v[36:39]
s_waitcnt lgkmcnt(5)
buffer_load_dwordx4 v248, s[36:39], s43 offen offset:2048 lds
v_mfma_f32_16x16x32_bf16 v[40:43], v[136:139], v[184:187], v[40:43]
ds_read_b128 v[128:131], v234 offset:10240
v_mfma_f32_16x16x32_bf16 v[44:47], v[136:139], v[188:191], v[44:47]
s_waitcnt lgkmcnt(5)
v_mfma_f32_16x16x32_bf16 v[48:51], v[140:143], v[184:187], v[48:51]
wu_39:
s_cbranch_execz wu_ret2
ds_read_b128 v[132:135], v234 offset:11264
v_mfma_f32_16x16x32_bf16 v[52:55], v[140:143], v[188:191], v[52:55]
s_waitcnt lgkmcnt(5)
buffer_load_dwordx4 v248, s[36:39], s43 offen offset:3072 lds
v_mfma_f32_16x16x32_bf16 v[56:59], v[144:147], v[184:187], v[56:59]
ds_read_b128 v[136:139], v234 offset:12288
v_mfma_f32_16x16x32_bf16 v[60:63], v[144:147], v[188:191], v[60:63]
s_waitcnt lgkmcnt(5)
v_mfma_f32_16x16x32_bf16 v[64:67], v[148:151], v[184:187], v[64:67]
ds_read_b128 v[140:143], v234 offset:13312
v_mfma_f32_16x16x32_bf16 v[68:71], v[148:151], v[188:191], v[68:71]
s_waitcnt lgkmcnt(5)
s_add_u32 m0, s42, 4096
s_mov_b32 s43, 1773568
buffer_load_dwordx4 v248, s[36:39], s43 offen offset:0 lds
v_mfma_f32_16x16x32_bf16 v[72:75], v[120:123], v[184:187], v[72:75]
ds_read_b128 v[144:147], v234 offset:14336
v_mfma_f32_16x16x32_bf16 v[76:79], v[120:123], v[188:191], v[76:79]
s_waitcnt lgkmcnt(5)
v_mfma_f32_16x16x32_bf16 v[80:83], v[124:127], v[184:187], v[80:83]
ds_read_b128 v[148:151], v234 offset:15360
v_mfma_f32_16x16x32_bf16 v[84:87], v[124:127], v[188:191], v[84:87]
s_waitcnt lgkmcnt(5)
buffer_load_dwordx4 v255, s[36:39], s43 offen offset:1024 lds
v_mfma_f32_16x16x32_bf16 v[88:91], v[128:131], v[184:187], v[88:91]
ds_read_b128 v[120:123], v234 offset:16384
v_mfma_f32_16x16x32_bf16 v[92:95], v[128:131], v[188:191], v[92:95]
s_waitcnt lgkmcnt(5)
v_mfma_f32_16x16x32_bf16 v[96:99], v[132:135], v[184:187], v[96:99]
ds_read_b128 v[124:127], v234 offset:17408
v_mfma_f32_16x16x32_bf16 v[100:103], v[132:135], v[188:191], v[100:103]
s_waitcnt lgkmcnt(5)
buffer_load_dwordx4 v255, s[36:39], s43 offen offset:2048 lds
v_mfma_f32_16x16x32_bf16 v[104:107], v[136:139], v[184:187], v[104:107]
ds_read_b128 v[128:131], v234 offset:18432
v_mfma_f32_16x16x32_bf16 v[108:111], v[136:139], v[188:191], v[108:111]
s_waitcnt lgkmcnt(5)
v_mfma_f32_16x16x32_bf16 v[112:115], v[140:143], v[184:187], v[112:115]
ds_read_b128 v[132:135], v234 offset:19456
v_mfma_f32_16x16x32_bf16 v[116:119], v[140:143], v[188:191], v[116:119]
s_waitcnt lgkmcnt(5)
buffer_load_dwordx4 v[184:187], v237, s[16:19], s22 offen offset:2048 sc1
s_waitcnt vmcnt(32)
v_mfma_f32_16x16x32_bf16 v[8:11], v[144:147], v[192:195], v[8:11]
ds_read_b128 v[136:139], v234 offset:20480
v_max3_u32 v239, v200, v201, v202
v_mfma_f32_16x16x32_bf16 v[12:15], v[144:147], v[196:199], v[12:15]
s_waitcnt lgkmcnt(5)
v_max3_u32 v239, v239, v203, v204
v_mfma_f32_16x16x32_bf16 v[16:19], v[148:151], v[192:195], v[16:19]
ds_read_b128 v[140:143], v234 offset:21504
v_max3_u32 v239, v239, v205, v206
v_mfma_f32_16x16x32_bf16 v[20:23], v[148:151], v[196:199], v[20:23]
s_waitcnt lgkmcnt(5)
buffer_load_dwordx4 v[188:191], v238, s[16:19], s22 offen offset:2048 sc1
v_mfma_f32_16x16x32_bf16 v[24:27], v[120:123], v[192:195], v[24:27]
ds_read_b128 v[144:147], v234 offset:22528
v_max_u32 v239, v239, v207
v_mfma_f32_16x16x32_bf16 v[28:31], v[120:123], v[196:199], v[28:31]
s_waitcnt lgkmcnt(5)
v_cmp_eq_u32 vcc, -1, v239
v_mfma_f32_16x16x32_bf16 v[32:35], v[124:127], v[192:195], v[32:35]
ds_read_b128 v[148:151], v234 offset:23552
s_cbranch_vccnz fx_27
fx_27_b:
v_mfma_f32_16x16x32_bf16 v[36:39], v[124:127], v[196:199], v[36:39]
s_waitcnt lgkmcnt(5)
buffer_store_dwordx4 a[252:255], v254, s[24:27], 0 offen sc0 sc1
v_mfma_f32_16x16x32_bf16 v[40:43], v[128:131], v[192:195], v[40:43]
ds_read_b128 v[120:123], v234 offset:24576
v_mfma_f32_16x16x32_bf16 v[44:47], v[128:131], v[196:199], v[44:47]
s_waitcnt lgkmcnt(5)
v_mfma_f32_16x16x32_bf16 v[48:51], v[132:135], v[192:195], v[48:51]
ds_read_b128 v[124:127], v234 offset:25600
wu_40:
s_cbranch_execz wu_ret2
v_mfma_f32_16x16x32_bf16 v[52:55], v[132:135], v[196:199], v[52:55]
s_waitcnt lgkmcnt(5)
v_mfma_f32_16x16x32_bf16 v[56:59], v[136:139], v[192:195], v[56:59]
ds_read_b128 v[128:131], v234 offset:26624
v_mfma_f32_16x16x32_bf16 v[60:63], v[136:139], v[196:199], v[60:63]
s_waitcnt lgkmcnt(5)
v_mfma_f32_16x16x32_bf16 v[64:67], v[140:143], v[192:195], v[64:67]
ds_read_b128 v[132:135], v234 offset:27648
v_mfma_f32_16x16x32_bf16 v[68:71], v[140:143], v[196:199], v[68:71]
s_waitcnt lgkmcnt(5)
v_mfma_f32_16x16x32_bf16 v[72:75], v[144:147], v[192:195], v[72:75]
s_barrier
ds_read_b128 v[136:139], v235 offset:0
v_mfma_f32_16x16x32_bf16 v[76:79], v[144:147], v[196:199], v[76:79]
s_waitcnt lgkmcnt(5)
v_mfma_f32_16x16x32_bf16 v[80:83], v[148:151], v[192:195], v[80:83]
ds_read_b128 v[140:143], v235 offset:1024
v_mfma_f32_16x16x32_bf16 v[84:87], v[148:151], v[196:199], v[84:87]
s_waitcnt lgkmcnt(5)
s_add_u32 m0, s42, 28672
s_mov_b32 s43, 2211840
buffer_load_dwordx4 v248, s[36:39], s43 offen offset:0 lds
v_mfma_f32_16x16x32_bf16 v[88:91], v[120:123], v[192:195], v[88:91]
ds_read_b128 v[144:147], v235 offset:2048
v_mfma_f32_16x16x32_bf16 v[92:95], v[120:123], v[196:199], v[92:95]
s_waitcnt lgkmcnt(5)
v_mfma_f32_16x16x32_bf16 v[96:99], v[124:127], v[192:195], v[96:99]
ds_read_b128 v[148:151], v235 offset:3072
v_mfma_f32_16x16x32_bf16 v[100:103], v[124:127], v[196:199], v[100:103]
s_waitcnt lgkmcnt(5)
buffer_load_dwordx4 v248, s[36:39], s43 offen offset:1024 lds
v_mfma_f32_16x16x32_bf16 v[104:107], v[128:131], v[192:195], v[104:107]
ds_read_b128 v[120:123], v235 offset:4096
v_mfma_f32_16x16x32_bf16 v[108:111], v[128:131], v[196:199], v[108:111]
s_waitcnt lgkmcnt(5)
v_mfma_f32_16x16x32_bf16 v[112:115], v[132:135], v[192:195], v[112:115]
ds_read_b128 v[124:127], v235 offset:5120
v_mfma_f32_16x16x32_bf16 v[116:119], v[132:135], v[196:199], v[116:119]
s_waitcnt lgkmcnt(5)
buffer_load_dwordx4 v[192:195], v237, s[16:19], s22 offen offset:3072 sc1
s_waitcnt vmcnt(35)
v_mfma_f32_16x16x32_bf16 v[8:11], v[136:139], v[200:203], v[8:11]
ds_read_b128 v[128:131], v235 offset:6144
v_max3_u32 v239, v208, v209, v210
v_mfma_f32_16x16x32_bf16 v[12:15], v[136:139], v[204:207], v[12:15]
s_waitcnt lgkmcnt(5)
v_max3_u32 v239, v239, v211, v212
v_mfma_f32_16x16x32_bf16 v[16:19], v[140:143], v[200:203], v[16:19]
ds_read_b128 v[132:135], v235 offset:7168
v_max3_u32 v239, v239, v213, v214
v_mfma_f32_16x16x32_bf16 v[20:23], v[140:143], v[204:207], v[20:23]
s_waitcnt lgkmcnt(5)
buffer_load_dwordx4 v[196:199], v238, s[16:19], s22 offen offset:3072 sc1
v_mfma_f32_16x16x32_bf16 v[24:27], v[144:147], v[200:203], v[24:27]
ds_read_b128 v[136:139], v235 offset:8192
v_max_u32 v239, v239, v215
v_mfma_f32_16x16x32_bf16 v[28:31], v[144:147], v[204:207], v[28:31]
s_waitcnt lgkmcnt(5)
v_cmp_eq_u32 vcc, -1, v239
v_mfma_f32_16x16x32_bf16 v[32:35], v[148:151], v[200:203], v[32:35]
ds_read_b128 v[140:143], v235 offset:9216
s_cbranch_vccnz fx_28
fx_28_b:
v_mfma_f32_16x16x32_bf16 v[36:39], v[148:151], v[204:207], v[36:39]
s_waitcnt lgkmcnt(5)
buffer_load_dwordx4 v248, s[36:39], s43 offen offset:2048 lds
v_mfma_f32_16x16x32_bf16 v[40:43], v[120:123], v[200:203], v[40:43]
ds_read_b128 v[144:147], v235 offset:10240
v_mfma_f32_16x16x32_bf16 v[44:47], v[120:123], v[204:207], v[44:47]
s_waitcnt lgkmcnt(5)
v_mfma_f32_16x16x32_bf16 v[48:51], v[124:127], v[200:203], v[48:51]
ds_read_b128 v[148:151], v235 offset:11264
v_mfma_f32_16x16x32_bf16 v[52:55], v[124:127], v[204:207], v[52:55]
s_waitcnt lgkmcnt(5)
wu_41:
s_cbranch_execz wu_ret2
buffer_load_dwordx4 v248, s[36:39], s43 offen offset:3072 lds
v_mfma_f32_16x16x32_bf16 v[56:59], v[128:131], v[200:203], v[56:59]
ds_read_b128 v[120:123], v235 offset:12288
v_mfma_f32_16x16x32_bf16 v[60:63], v[128:131], v[204:207], v[60:63]
s_waitcnt lgkmcnt(5)
v_mfma_f32_16x16x32_bf16 v[64:67], v[132:135], v[200:203], v[64:67]
ds_read_b128 v[124:127], v235 offset:13312
v_mfma_f32_16x16x32_bf16 v[68:71], v[132:135], v[204:207], v[68:71]
s_waitcnt lgkmcnt(5)
s_add_u32 m0, s42, 32768
s_mov_b32 s43, 2215936
buffer_load_dwordx4 v248, s[36:39], s43 offen offset:0 lds
v_mfma_f32_16x16x32_bf16 v[72:75], v[136:139], v[200:203], v[72:75]
ds_read_b128 v[128:131], v235 offset:14336
v_mfma_f32_16x16x32_bf16 v[76:79], v[136:139], v[204:207], v[76:79]
s_waitcnt lgkmcnt(5)
v_mfma_f32_16x16x32_bf16 v[80:83], v[140:143], v[200:203], v[80:83]
ds_read_b128 v[132:135], v235 offset:15360
v_mfma_f32_16x16x32_bf16 v[84:87], v[140:143], v[204:207], v[84:87]
s_waitcnt lgkmcnt(5)
buffer_load_dwordx4 v255, s[36:39], s43 offen offset:1024 lds
v_mfma_f32_16x16x32_bf16 v[88:91], v[144:147], v[200:203], v[88:91]
ds_read_b128 v[136:139], v235 offset:16384
v_mfma_f32_16x16x32_bf16 v[92:95], v[144:147], v[204:207], v[92:95]
s_waitcnt lgkmcnt(5)
v_mfma_f32_16x16x32_bf16 v[96:99], v[148:151], v[200:203], v[96:99]
ds_read_b128 v[140:143], v235 offset:17408
v_mfma_f32_16x16x32_bf16 v[100:103], v[148:151], v[204:207], v[100:103]
s_waitcnt lgkmcnt(5)
buffer_load_dwordx4 v255, s[36:39], s43 offen offset:2048 lds
v_mfma_f32_16x16x32_bf16 v[104:107], v[120:123], v[200:203], v[104:107]
ds_read_b128 v[144:147], v235 offset:18432
v_mfma_f32_16x16x32_bf16 v[108:111], v[120:123], v[204:207], v[108:111]
s_waitcnt lgkmcnt(5)
v_mfma_f32_16x16x32_bf16 v[112:115], v[124:127], v[200:203], v[112:115]
ds_read_b128 v[148:151], v235 offset:19456
v_mfma_f32_16x16x32_bf16 v[116:119], v[124:127], v[204:207], v[116:119]
s_waitcnt lgkmcnt(5)
s_movk_i32 s22, 16384
buffer_load_dwordx4 v[200:203], v237, s[16:19], s22 offen offset:0 sc1
s_waitcnt vmcnt(40)
v_mfma_f32_16x16x32_bf16 v[8:11], v[128:131], v[208:211], v[8:11]
ds_read_b128 v[120:123], v235 offset:20480
v_max3_u32 v239, v216, v217, v218
v_mfma_f32_16x16x32_bf16 v[12:15], v[128:131], v[212:215], v[12:15]
s_waitcnt lgkmcnt(5)
v_max3_u32 v239, v239, v219, v220
v_mfma_f32_16x16x32_bf16 v[16:19], v[132:135], v[208:211], v[16:19]
ds_read_b128 v[124:127], v235 offset:21504
v_max3_u32 v239, v239, v221, v222
v_mfma_f32_16x16x32_bf16 v[20:23], v[132:135], v[212:215], v[20:23]
s_waitcnt lgkmcnt(5)
buffer_load_dwordx4 v[204:207], v238, s[16:19], s22 offen offset:0 sc1
v_mfma_f32_16x16x32_bf16 v[24:27], v[136:139], v[208:211], v[24:27]
ds_read_b128 v[128:131], v235 offset:22528
v_max_u32 v239, v239, v223
v_mfma_f32_16x16x32_bf16 v[28:31], v[136:139], v[212:215], v[28:31]
s_waitcnt lgkmcnt(5)
v_cmp_eq_u32 vcc, -1, v239
v_mfma_f32_16x16x32_bf16 v[32:35], v[140:143], v[208:211], v[32:35]
ds_read_b128 v[132:135], v235 offset:23552
s_cbranch_vccnz fx_29
fx_29_b:
v_mfma_f32_16x16x32_bf16 v[36:39], v[140:143], v[212:215], v[36:39]
s_waitcnt lgkmcnt(5)
buffer_store_dwordx4 a[252:255], v249, s[24:27], s82 offen sc0 sc1
v_mfma_f32_16x16x32_bf16 v[40:43], v[144:147], v[208:211], v[40:43]
ds_read_b128 v[136:139], v235 offset:24576
v_mfma_f32_16x16x32_bf16 v[44:47], v[144:147], v[212:215], v[44:47]
s_waitcnt lgkmcnt(5)
v_mfma_f32_16x16x32_bf16 v[48:51], v[148:151], v[208:211], v[48:51]
ds_read_b128 v[140:143], v235 offset:25600
v_mfma_f32_16x16x32_bf16 v[52:55], v[148:151], v[212:215], v[52:55]
s_waitcnt lgkmcnt(5)
wu_42:
s_cbranch_execz wu_ret2
buffer_store_dwordx4 a[252:255], v250, s[24:27], s82 offen sc0 sc1
v_mfma_f32_16x16x32_bf16 v[56:59], v[120:123], v[208:211], v[56:59]
ds_read_b128 v[144:147], v235 offset:26624
v_mfma_f32_16x16x32_bf16 v[60:63], v[120:123], v[212:215], v[60:63]
s_waitcnt lgkmcnt(5)
v_mfma_f32_16x16x32_bf16 v[64:67], v[124:127], v[208:211], v[64:67]
ds_read_b128 v[148:151], v235 offset:27648
v_mfma_f32_16x16x32_bf16 v[68:71], v[124:127], v[212:215], v[68:71]
s_waitcnt lgkmcnt(5)
v_mfma_f32_16x16x32_bf16 v[72:75], v[128:131], v[208:211], v[72:75]
s_waitcnt vmcnt(16)
s_barrier
ds_read_b128 v[120:123], v232 offset:0
v_mfma_f32_16x16x32_bf16 v[76:79], v[128:131], v[212:215], v[76:79]
s_waitcnt lgkmcnt(5)
v_mfma_f32_16x16x32_bf16 v[80:83], v[132:135], v[208:211], v[80:83]
ds_read_b128 v[124:127], v232 offset:1024
v_mfma_f32_16x16x32_bf16 v[84:87], v[132:135], v[212:215], v[84:87]
s_waitcnt lgkmcnt(5)
s_add_u32 m0, s42, 57344
s_mov_b32 s43, 2654208
buffer_load_dwordx4 v248, s[36:39], s43 offen offset:0 lds
v_mfma_f32_16x16x32_bf16 v[88:91], v[136:139], v[208:211], v[88:91]
ds_read_b128 v[128:131], v232 offset:2048
v_mfma_f32_16x16x32_bf16 v[92:95], v[136:139], v[212:215], v[92:95]
s_waitcnt lgkmcnt(5)
v_mfma_f32_16x16x32_bf16 v[96:99], v[140:143], v[208:211], v[96:99]
ds_read_b128 v[132:135], v232 offset:3072
v_mfma_f32_16x16x32_bf16 v[100:103], v[140:143], v[212:215], v[100:103]
s_waitcnt lgkmcnt(5)
buffer_load_dwordx4 v248, s[36:39], s43 offen offset:1024 lds
v_mfma_f32_16x16x32_bf16 v[104:107], v[144:147], v[208:211], v[104:107]
ds_read_b128 v[136:139], v232 offset:4096
v_mfma_f32_16x16x32_bf16 v[108:111], v[144:147], v[212:215], v[108:111]
s_waitcnt lgkmcnt(5)
v_mfma_f32_16x16x32_bf16 v[112:115], v[148:151], v[208:211], v[112:115]
ds_read_b128 v[140:143], v232 offset:5120
v_mfma_f32_16x16x32_bf16 v[116:119], v[148:151], v[212:215], v[116:119]
s_waitcnt lgkmcnt(5)
buffer_load_dwordx4 v[208:211], v237, s[16:19], s22 offen offset:1024 sc1
v_mfma_f32_16x16x32_bf16 v[8:11], v[120:123], v[216:219], v[8:11]
ds_read_b128 v[144:147], v232 offset:6144
v_max3_u32 v239, v224, v225, v226
v_mfma_f32_16x16x32_bf16 v[12:15], v[120:123], v[220:223], v[12:15]
s_waitcnt lgkmcnt(5)
v_max3_u32 v239, v239, v227, v228
v_mfma_f32_16x16x32_bf16 v[16:19], v[124:127], v[216:219], v[16:19]
ds_read_b128 v[148:151], v232 offset:7168
v_max3_u32 v239, v239, v229, v230
v_mfma_f32_16x16x32_bf16 v[20:23], v[124:127], v[220:223], v[20:23]
s_waitcnt lgkmcnt(5)
buffer_load_dwordx4 v[212:215], v238, s[16:19], s22 offen offset:1024 sc1
v_mfma_f32_16x16x32_bf16 v[24:27], v[128:131], v[216:219], v[24:27]
ds_read_b128 v[120:123], v232 offset:8192
v_max_u32 v239, v239, v231
v_mfma_f32_16x16x32_bf16 v[28:31], v[128:131], v[220:223], v[28:31]
s_waitcnt lgkmcnt(5)
v_cmp_eq_u32 vcc, -1, v239
v_mfma_f32_16x16x32_bf16 v[32:35], v[132:135], v[216:219], v[32:35]
ds_read_b128 v[124:127], v232 offset:9216
s_cbranch_vccnz fx_30
fx_30_b:
v_mfma_f32_16x16x32_bf16 v[36:39], v[132:135], v[220:223], v[36:39]
s_waitcnt lgkmcnt(5)
buffer_load_dwordx4 v248, s[36:39], s43 offen offset:2048 lds
v_mfma_f32_16x16x32_bf16 v[40:43], v[136:139], v[216:219], v[40:43]
ds_read_b128 v[128:131], v232 offset:10240
v_mfma_f32_16x16x32_bf16 v[44:47], v[136:139], v[220:223], v[44:47]
s_waitcnt lgkmcnt(5)
v_mfma_f32_16x16x32_bf16 v[48:51], v[140:143], v[216:219], v[48:51]
ds_read_b128 v[132:135], v232 offset:11264
v_mfma_f32_16x16x32_bf16 v[52:55], v[140:143], v[220:223], v[52:55]
s_waitcnt lgkmcnt(5)
buffer_load_dwordx4 v248, s[36:39], s43 offen offset:3072 lds
wu_43:
s_cbranch_execz wu_ret2
v_mfma_f32_16x16x32_bf16 v[56:59], v[144:147], v[216:219], v[56:59]
ds_read_b128 v[136:139], v232 offset:12288
v_mfma_f32_16x16x32_bf16 v[60:63], v[144:147], v[220:223], v[60:63]
s_waitcnt lgkmcnt(5)
v_mfma_f32_16x16x32_bf16 v[64:67], v[148:151], v[216:219], v[64:67]
ds_read_b128 v[140:143], v232 offset:13312
v_mfma_f32_16x16x32_bf16 v[68:71], v[148:151], v[220:223], v[68:71]
s_waitcnt lgkmcnt(5)
s_add_u32 m0, s42, 61440
s_mov_b32 s43, 2658304
buffer_load_dwordx4 v248, s[36:39], s43 offen offset:0 lds
v_mfma_f32_16x16x32_bf16 v[72:75], v[120:123], v[216:219], v[72:75]
ds_read_b128 v[144:147], v232 offset:14336
v_mfma_f32_16x16x32_bf16 v[76:79], v[120:123], v[220:223], v[76:79]
s_waitcnt lgkmcnt(5)
v_mfma_f32_16x16x32_bf16 v[80:83], v[124:127], v[216:219], v[80:83]
ds_read_b128 v[148:151], v232 offset:15360
v_mfma_f32_16x16x32_bf16 v[84:87], v[124:127], v[220:223], v[84:87]
s_waitcnt lgkmcnt(5)
buffer_load_dwordx4 v255, s[36:39], s43 offen offset:1024 lds
v_mfma_f32_16x16x32_bf16 v[88:91], v[128:131], v[216:219], v[88:91]
ds_read_b128 v[120:123], v232 offset:16384
v_mfma_f32_16x16x32_bf16 v[92:95], v[128:131], v[220:223], v[92:95]
s_waitcnt lgkmcnt(5)
v_mfma_f32_16x16x32_bf16 v[96:99], v[132:135], v[216:219], v[96:99]
ds_read_b128 v[124:127], v232 offset:17408
v_mfma_f32_16x16x32_bf16 v[100:103], v[132:135], v[220:223], v[100:103]
s_waitcnt lgkmcnt(5)
buffer_load_dwordx4 v255, s[36:39], s43 offen offset:2048 lds
v_mfma_f32_16x16x32_bf16 v[104:107], v[136:139], v[216:219], v[104:107]
ds_read_b128 v[128:131], v232 offset:18432
v_mfma_f32_16x16x32_bf16 v[108:111], v[136:139], v[220:223], v[108:111]
s_waitcnt lgkmcnt(5)
v_mfma_f32_16x16x32_bf16 v[112:115], v[140:143], v[216:219], v[112:115]
ds_read_b128 v[132:135], v232 offset:19456
v_mfma_f32_16x16x32_bf16 v[116:119], v[140:143], v[220:223], v[116:119]
s_waitcnt lgkmcnt(5)
buffer_load_dwordx4 v[216:219], v237, s[16:19], s22 offen offset:2048 sc1
v_mfma_f32_16x16x32_bf16 v[8:11], v[144:147], v[224:227], v[8:11]
ds_read_b128 v[136:139], v232 offset:20480
v_max3_u32 v239, v152, v153, v154
v_mfma_f32_16x16x32_bf16 v[12:15], v[144:147], v[228:231], v[12:15]
s_waitcnt lgkmcnt(5)
v_max3_u32 v239, v239, v155, v156
v_mfma_f32_16x16x32_bf16 v[16:19], v[148:151], v[224:227], v[16:19]
ds_read_b128 v[140:143], v232 offset:21504
v_max3_u32 v239, v239, v157, v158
v_mfma_f32_16x16x32_bf16 v[20:23], v[148:151], v[228:231], v[20:23]
s_waitcnt lgkmcnt(5)
buffer_load_dwordx4 v[220:223], v238, s[16:19], s22 offen offset:2048 sc1
v_mfma_f32_16x16x32_bf16 v[24:27], v[120:123], v[224:227], v[24:27]
ds_read_b128 v[144:147], v232 offset:22528
v_max_u32 v239, v239, v159
v_mfma_f32_16x16x32_bf16 v[28:31], v[120:123], v[228:231], v[28:31]
s_waitcnt lgkmcnt(5)
v_cmp_eq_u32 vcc, -1, v239
v_mfma_f32_16x16x32_bf16 v[32:35], v[124:127], v[224:227], v[32:35]
ds_read_b128 v[148:151], v232 offset:23552
s_cbranch_vccnz fx_31
fx_31_b:
v_mfma_f32_16x16x32_bf16 v[36:39], v[124:127], v[228:231], v[36:39]
s_waitcnt lgkmcnt(5)
buffer_store_dwordx4 a[252:255], v251, s[24:27], s82 offen sc0 sc1
v_mfma_f32_16x16x32_bf16 v[40:43], v[128:131], v[224:227], v[40:43]
ds_read_b128 v[120:123], v232 offset:24576
v_mfma_f32_16x16x32_bf16 v[44:47], v[128:131], v[228:231], v[44:47]
s_waitcnt lgkmcnt(5)
v_mfma_f32_16x16x32_bf16 v[48:51], v[132:135], v[224:227], v[48:51]
ds_read_b128 v[124:127], v232 offset:25600
v_mfma_f32_16x16x32_bf16 v[52:55], v[132:135], v[228:231], v[52:55]
s_waitcnt lgkmcnt(5)
buffer_store_dwordx4 a[252:255], v254, s[24:27], s82 offen sc0 sc1
v_mfma_f32_16x16x32_bf16 v[56:59], v[136:139], v[224:227], v[56:59]
wu_44:
s_cbranch_execz wu_ret2
ds_read_b128 v[128:131], v232 offset:26624
v_mfma_f32_16x16x32_bf16 v[60:63], v[136:139], v[228:231], v[60:63]
s_waitcnt lgkmcnt(5)
v_mfma_f32_16x16x32_bf16 v[64:67], v[140:143], v[224:227], v[64:67]
ds_read_b128 v[132:135], v232 offset:27648
v_mfma_f32_16x16x32_bf16 v[68:71], v[140:143], v[228:231], v[68:71]
s_waitcnt lgkmcnt(5)
v_mfma_f32_16x16x32_bf16 v[72:75], v[144:147], v[224:227], v[72:75]
s_waitcnt vmcnt(17)
s_barrier
ds_read_b128 v[136:139], v233 offset:0
v_mfma_f32_16x16x32_bf16 v[76:79], v[144:147], v[228:231], v[76:79]
s_waitcnt lgkmcnt(5)
v_mfma_f32_16x16x32_bf16 v[80:83], v[148:151], v[224:227], v[80:83]
ds_read_b128 v[140:143], v233 offset:1024
v_mfma_f32_16x16x32_bf16 v[84:87], v[148:151], v[228:231], v[84:87]
s_waitcnt lgkmcnt(5)
s_add_u32 m0, s42, 86016
s_mov_b32 s43, 3096576
buffer_load_dwordx4 v248, s[36:39], s43 offen offset:0 lds
v_mfma_f32_16x16x32_bf16 v[88:91], v[120:123], v[224:227], v[88:91]
ds_read_b128 v[144:147], v233 offset:2048
v_mfma_f32_16x16x32_bf16 v[92:95], v[120:123], v[228:231], v[92:95]
s_waitcnt lgkmcnt(5)
v_mfma_f32_16x16x32_bf16 v[96:99], v[124:127], v[224:227], v[96:99]
ds_read_b128 v[148:151], v233 offset:3072
v_mfma_f32_16x16x32_bf16 v[100:103], v[124:127], v[228:231], v[100:103]
s_waitcnt lgkmcnt(5)
buffer_load_dwordx4 v248, s[36:39], s43 offen offset:1024 lds
v_mfma_f32_16x16x32_bf16 v[104:107], v[128:131], v[224:227], v[104:107]
ds_read_b128 v[120:123], v233 offset:4096
v_mfma_f32_16x16x32_bf16 v[108:111], v[128:131], v[228:231], v[108:111]
s_waitcnt lgkmcnt(5)
v_mfma_f32_16x16x32_bf16 v[112:115], v[132:135], v[224:227], v[112:115]
ds_read_b128 v[124:127], v233 offset:5120
v_mfma_f32_16x16x32_bf16 v[116:119], v[132:135], v[228:231], v[116:119]
s_waitcnt lgkmcnt(5)
buffer_load_dwordx4 v[224:227], v237, s[16:19], s22 offen offset:3072 sc1
v_mfma_f32_16x16x32_bf16 v[8:11], v[136:139], v[152:155], v[8:11]
ds_read_b128 v[128:131], v233 offset:6144
v_max3_u32 v239, v160, v161, v162
v_mfma_f32_16x16x32_bf16 v[12:15], v[136:139], v[156:159], v[12:15]
s_waitcnt lgkmcnt(5)
v_max3_u32 v239, v239, v163, v164
v_mfma_f32_16x16x32_bf16 v[16:19], v[140:143], v[152:155], v[16:19]
ds_read_b128 v[132:135], v233 offset:7168
v_max3_u32 v239, v239, v165, v166
v_mfma_f32_16x16x32_bf16 v[20:23], v[140:143], v[156:159], v[20:23]
s_waitcnt lgkmcnt(5)
buffer_load_dwordx4 v[228:231], v238, s[16:19], s22 offen offset:3072 sc1
v_mfma_f32_16x16x32_bf16 v[24:27], v[144:147], v[152:155], v[24:27]
ds_read_b128 v[136:139], v233 offset:8192
v_max_u32 v239, v239, v167
v_mfma_f32_16x16x32_bf16 v[28:31], v[144:147], v[156:159], v[28:31]
s_waitcnt lgkmcnt(5)
v_cmp_eq_u32 vcc, -1, v239
v_mfma_f32_16x16x32_bf16 v[32:35], v[148:151], v[152:155], v[32:35]
ds_read_b128 v[140:143], v233 offset:9216
s_cbranch_vccnz fx_32
fx_32_b:
v_mfma_f32_16x16x32_bf16 v[36:39], v[148:151], v[156:159], v[36:39]
s_waitcnt lgkmcnt(5)
buffer_load_dwordx4 v248, s[36:39], s43 offen offset:2048 lds
v_mfma_f32_16x16x32_bf16 v[40:43], v[120:123], v[152:155], v[40:43]
ds_read_b128 v[144:147], v233 offset:10240
v_mfma_f32_16x16x32_bf16 v[44:47], v[120:123], v[156:159], v[44:47]
s_waitcnt lgkmcnt(5)
v_mfma_f32_16x16x32_bf16 v[48:51], v[124:127], v[152:155], v[48:51]
ds_read_b128 v[148:151], v233 offset:11264
v_mfma_f32_16x16x32_bf16 v[52:55], v[124:127], v[156:159], v[52:55]
s_waitcnt lgkmcnt(5)
buffer_load_dwordx4 v248, s[36:39], s43 offen offset:3072 lds
v_mfma_f32_16x16x32_bf16 v[56:59], v[128:131], v[152:155], v[56:59]
ds_read_b128 v[120:123], v233 offset:12288
wu_45:
s_cbranch_execz wu_ret2
v_mfma_f32_16x16x32_bf16 v[60:63], v[128:131], v[156:159], v[60:63]
s_waitcnt lgkmcnt(5)
v_mfma_f32_16x16x32_bf16 v[64:67], v[132:135], v[152:155], v[64:67]
ds_read_b128 v[124:127], v233 offset:13312
v_mfma_f32_16x16x32_bf16 v[68:71], v[132:135], v[156:159], v[68:71]
s_waitcnt lgkmcnt(5)
s_add_u32 m0, s42, 90112
s_mov_b32 s43, 3100672
buffer_load_dwordx4 v248, s[36:39], s43 offen offset:0 lds
v_mfma_f32_16x16x32_bf16 v[72:75], v[136:139], v[152:155], v[72:75]
ds_read_b128 v[128:131], v233 offset:14336
v_mfma_f32_16x16x32_bf16 v[76:79], v[136:139], v[156:159], v[76:79]
s_waitcnt lgkmcnt(5)
v_mfma_f32_16x16x32_bf16 v[80:83], v[140:143], v[152:155], v[80:83]
ds_read_b128 v[132:135], v233 offset:15360
v_mfma_f32_16x16x32_bf16 v[84:87], v[140:143], v[156:159], v[84:87]
s_waitcnt lgkmcnt(5)
buffer_load_dwordx4 v255, s[36:39], s43 offen offset:1024 lds
v_mfma_f32_16x16x32_bf16 v[88:91], v[144:147], v[152:155], v[88:91]
ds_read_b128 v[136:139], v233 offset:16384
v_mfma_f32_16x16x32_bf16 v[92:95], v[144:147], v[156:159], v[92:95]
s_waitcnt lgkmcnt(5)
v_mfma_f32_16x16x32_bf16 v[96:99], v[148:151], v[152:155], v[96:99]
ds_read_b128 v[140:143], v233 offset:17408
v_mfma_f32_16x16x32_bf16 v[100:103], v[148:151], v[156:159], v[100:103]
s_waitcnt lgkmcnt(5)
buffer_load_dwordx4 v255, s[36:39], s43 offen offset:2048 lds
v_mfma_f32_16x16x32_bf16 v[104:107], v[120:123], v[152:155], v[104:107]
ds_read_b128 v[144:147], v233 offset:18432
v_mfma_f32_16x16x32_bf16 v[108:111], v[120:123], v[156:159], v[108:111]
s_waitcnt lgkmcnt(5)
v_mfma_f32_16x16x32_bf16 v[112:115], v[124:127], v[152:155], v[112:115]
ds_read_b128 v[148:151], v233 offset:19456
v_mfma_f32_16x16x32_bf16 v[116:119], v[124:127], v[156:159], v[116:119]
s_waitcnt lgkmcnt(5)
buffer_store_dwordx4 a[240:243], v252, s[28:31], 0 offen offset:0 sc0 sc1
v_mfma_f32_16x16x32_bf16 v[8:11], v[128:131], v[160:163], v[8:11]
ds_read_b128 v[120:123], v233 offset:20480
v_max3_u32 v239, v168, v169, v170
v_mfma_f32_16x16x32_bf16 v[12:15], v[128:131], v[164:167], v[12:15]
s_waitcnt lgkmcnt(5)
v_max3_u32 v239, v239, v171, v172
v_mfma_f32_16x16x32_bf16 v[16:19], v[132:135], v[160:163], v[16:19]
ds_read_b128 v[124:127], v233 offset:21504
v_max3_u32 v239, v239, v173, v174
v_mfma_f32_16x16x32_bf16 v[20:23], v[132:135], v[164:167], v[20:23]
s_waitcnt lgkmcnt(5)
buffer_store_dwordx4 a[244:247], v252, s[28:31], 0 offen offset:512 sc0 sc1
v_mfma_f32_16x16x32_bf16 v[24:27], v[136:139], v[160:163], v[24:27]
ds_read_b128 v[128:131], v233 offset:22528
v_max_u32 v239, v239, v175
v_mfma_f32_16x16x32_bf16 v[28:31], v[136:139], v[164:167], v[28:31]
s_waitcnt lgkmcnt(5)
v_cmp_eq_u32 vcc, -1, v239
v_mfma_f32_16x16x32_bf16 v[32:35], v[140:143], v[160:163], v[32:35]
ds_read_b128 v[132:135], v233 offset:23552
s_cbranch_vccnz fx_33
fx_33_b:
v_mfma_f32_16x16x32_bf16 v[36:39], v[140:143], v[164:167], v[36:39]
s_waitcnt lgkmcnt(5)
buffer_store_dwordx4 a[248:251], v253, s[28:31], 0 offen offset:1024 sc0 sc1
v_mfma_f32_16x16x32_bf16 v[40:43], v[144:147], v[160:163], v[40:43]
ds_read_b128 v[136:139], v233 offset:24576
v_mfma_f32_16x16x32_bf16 v[44:47], v[144:147], v[164:167], v[44:47]
s_waitcnt lgkmcnt(5)
v_mfma_f32_16x16x32_bf16 v[48:51], v[148:151], v[160:163], v[48:51]
ds_read_b128 v[140:143], v233 offset:25600
v_mfma_f32_16x16x32_bf16 v[52:55], v[148:151], v[164:167], v[52:55]
s_waitcnt lgkmcnt(5)
v_mfma_f32_16x16x32_bf16 v[56:59], v[120:123], v[160:163], v[56:59]
ds_read_b128 v[144:147], v233 offset:26624
v_mfma_f32_16x16x32_bf16 v[60:63], v[120:123], v[164:167], v[60:63]
s_waitcnt lgkmcnt(5)
v_mfma_f32_16x16x32_bf16 v[64:67], v[124:127], v[160:163], v[64:67]
wu_46:
s_cbranch_execz wu_ret2
ds_read_b128 v[148:151], v233 offset:27648
v_mfma_f32_16x16x32_bf16 v[68:71], v[124:127], v[164:167], v[68:71]
s_waitcnt lgkmcnt(5)
v_mfma_f32_16x16x32_bf16 v[72:75], v[128:131], v[160:163], v[72:75]
s_waitcnt vmcnt(16)
s_barrier
ds_read_b128 v[120:123], v234 offset:0
v_mfma_f32_16x16x32_bf16 v[76:79], v[128:131], v[164:167], v[76:79]
s_waitcnt lgkmcnt(5)
v_mfma_f32_16x16x32_bf16 v[80:83], v[132:135], v[160:163], v[80:83]
ds_read_b128 v[124:127], v234 offset:1024
v_mfma_f32_16x16x32_bf16 v[84:87], v[132:135], v[164:167], v[84:87]
s_waitcnt lgkmcnt(5)
s_add_u32 m0, s42, 0
s_mov_b32 s43, 3538944
buffer_load_dwordx4 v248, s[36:39], s43 offen offset:0 lds
v_mfma_f32_16x16x32_bf16 v[88:91], v[136:139], v[160:163], v[88:91]
ds_read_b128 v[128:131], v234 offset:2048
v_mfma_f32_16x16x32_bf16 v[92:95], v[136:139], v[164:167], v[92:95]
s_waitcnt lgkmcnt(5)
v_mfma_f32_16x16x32_bf16 v[96:99], v[140:143], v[160:163], v[96:99]
ds_read_b128 v[132:135], v234 offset:3072
v_mfma_f32_16x16x32_bf16 v[100:103], v[140:143], v[164:167], v[100:103]
s_waitcnt lgkmcnt(5)
buffer_load_dwordx4 v248, s[36:39], s43 offen offset:1024 lds
v_mfma_f32_16x16x32_bf16 v[104:107], v[144:147], v[160:163], v[104:107]
ds_read_b128 v[136:139], v234 offset:4096
v_mfma_f32_16x16x32_bf16 v[108:111], v[144:147], v[164:167], v[108:111]
s_waitcnt lgkmcnt(5)
v_mfma_f32_16x16x32_bf16 v[112:115], v[148:151], v[160:163], v[112:115]
ds_read_b128 v[140:143], v234 offset:5120
v_mfma_f32_16x16x32_bf16 v[116:119], v[148:151], v[164:167], v[116:119]
s_waitcnt lgkmcnt(5)
buffer_load_dwordx4 v248, s[36:39], s43 offen offset:2048 lds
v_mfma_f32_16x16x32_bf16 v[8:11], v[120:123], v[168:171], v[8:11]
ds_read_b128 v[144:147], v234 offset:6144
v_max3_u32 v239, v176, v177, v178
v_mfma_f32_16x16x32_bf16 v[12:15], v[120:123], v[172:175], v[12:15]
s_waitcnt lgkmcnt(5)
v_max3_u32 v239, v239, v179, v180
v_mfma_f32_16x16x32_bf16 v[16:19], v[124:127], v[168:171], v[16:19]
ds_read_b128 v[148:151], v234 offset:7168
v_max3_u32 v239, v239, v181, v182
v_mfma_f32_16x16x32_bf16 v[20:23], v[124:127], v[172:175], v[20:23]
s_waitcnt lgkmcnt(5)
buffer_load_dwordx4 v248, s[36:39], s43 offen offset:3072 lds
v_mfma_f32_16x16x32_bf16 v[24:27], v[128:131], v[168:171], v[24:27]
ds_read_b128 v[120:123], v234 offset:8192
v_max_u32 v239, v239, v183
v_mfma_f32_16x16x32_bf16 v[28:31], v[128:131], v[172:175], v[28:31]
s_waitcnt lgkmcnt(5)
v_cmp_eq_u32 vcc, -1, v239
v_mfma_f32_16x16x32_bf16 v[32:35], v[132:135], v[168:171], v[32:35]
ds_read_b128 v[124:127], v234 offset:9216
s_cbranch_vccnz fx_34
fx_34_b:
v_mfma_f32_16x16x32_bf16 v[36:39], v[132:135], v[172:175], v[36:39]
s_waitcnt lgkmcnt(5)
s_add_u32 m0, s42, 4096
s_mov_b32 s43, 3543040
buffer_load_dwordx4 v248, s[36:39], s43 offen offset:0 lds
v_mfma_f32_16x16x32_bf16 v[40:43], v[136:139], v[168:171], v[40:43]
ds_read_b128 v[128:131], v234 offset:10240
v_mfma_f32_16x16x32_bf16 v[44:47], v[136:139], v[172:175], v[44:47]
s_waitcnt lgkmcnt(5)
v_mfma_f32_16x16x32_bf16 v[48:51], v[140:143], v[168:171], v[48:51]
ds_read_b128 v[132:135], v234 offset:11264
v_mfma_f32_16x16x32_bf16 v[52:55], v[140:143], v[172:175], v[52:55]
s_waitcnt lgkmcnt(5)
buffer_load_dwordx4 v255, s[36:39], s43 offen offset:1024 lds
v_mfma_f32_16x16x32_bf16 v[56:59], v[144:147], v[168:171], v[56:59]
ds_read_b128 v[136:139], v234 offset:12288
v_mfma_f32_16x16x32_bf16 v[60:63], v[144:147], v[172:175], v[60:63]
s_waitcnt lgkmcnt(5)
wu_47:
s_cbranch_execz wu_ret2
v_mfma_f32_16x16x32_bf16 v[64:67], v[148:151], v[168:171], v[64:67]
ds_read_b128 v[140:143], v234 offset:13312
v_mfma_f32_16x16x32_bf16 v[68:71], v[148:151], v[172:175], v[68:71]
s_waitcnt lgkmcnt(5)
buffer_load_dwordx4 v255, s[36:39], s43 offen offset:2048 lds
v_mfma_f32_16x16x32_bf16 v[72:75], v[120:123], v[168:171], v[72:75]
ds_read_b128 v[144:147], v234 offset:14336
v_mfma_f32_16x16x32_bf16 v[76:79], v[120:123], v[172:175], v[76:79]
s_waitcnt lgkmcnt(5)
v_mfma_f32_16x16x32_bf16 v[80:83], v[124:127], v[168:171], v[80:83]
ds_read_b128 v[148:151], v234 offset:15360
v_mfma_f32_16x16x32_bf16 v[84:87], v[124:127], v[172:175], v[84:87]
s_waitcnt lgkmcnt(5)
s_mov_b32 s51, 245760
buffer_load_dwordx4 a[120:123], v246, s[32:35], s51 offen offset:0
v_mfma_f32_16x16x32_bf16 v[88:91], v[128:131], v[168:171], v[88:91]
ds_read_b128 v[120:123], v234 offset:16384
v_mfma_f32_16x16x32_bf16 v[92:95], v[128:131], v[172:175], v[92:95]
s_waitcnt lgkmcnt(5)
v_mfma_f32_16x16x32_bf16 v[96:99], v[132:135], v[168:171], v[96:99]
ds_read_b128 v[124:127], v234 offset:17408
v_mfma_f32_16x16x32_bf16 v[100:103], v[132:135], v[172:175], v[100:103]
s_waitcnt lgkmcnt(5)
buffer_load_dwordx4 a[124:127], v246, s[32:35], s51 offen offset:1024
v_mfma_f32_16x16x32_bf16 v[104:107], v[136:139], v[168:171], v[104:107]
ds_read_b128 v[128:131], v234 offset:18432
v_mfma_f32_16x16x32_bf16 v[108:111], v[136:139], v[172:175], v[108:111]
s_waitcnt lgkmcnt(5)
v_mfma_f32_16x16x32_bf16 v[112:115], v[140:143], v[168:171], v[112:115]
ds_read_b128 v[132:135], v234 offset:19456
v_mfma_f32_16x16x32_bf16 v[116:119], v[140:143], v[172:175], v[116:119]
s_waitcnt lgkmcnt(5)
buffer_load_dwordx4 a[128:131], v246, s[32:35], s51 offen offset:2048
v_mfma_f32_16x16x32_bf16 v[8:11], v[144:147], v[176:179], v[8:11]
ds_read_b128 v[136:139], v234 offset:20480
v_max3_u32 v239, v208, v209, v210
v_mfma_f32_16x16x32_bf16 v[12:15], v[144:147], v[180:183], v[12:15]
s_waitcnt lgkmcnt(5)
v_max3_u32 v239, v239, v211, v212
v_mfma_f32_16x16x32_bf16 v[16:19], v[148:151], v[176:179], v[16:19]
ds_read_b128 v[140:143], v234 offset:21504
v_max3_u32 v239, v239, v213, v214
v_mfma_f32_16x16x32_bf16 v[20:23], v[148:151], v[180:183], v[20:23]
s_waitcnt lgkmcnt(5)
buffer_load_dwordx4 a[132:135], v246, s[32:35], s51 offen offset:3072
v_mfma_f32_16x16x32_bf16 v[24:27], v[120:123], v[176:179], v[24:27]
ds_read_b128 v[144:147], v234 offset:22528
v_max_u32 v239, v239, v215
v_mfma_f32_16x16x32_bf16 v[28:31], v[120:123], v[180:183], v[28:31]
s_waitcnt lgkmcnt(5)
v_cmp_eq_u32 vcc, -1, v239
v_mfma_f32_16x16x32_bf16 v[32:35], v[124:127], v[176:179], v[32:35]
ds_read_b128 v[148:151], v234 offset:23552
s_cbranch_vccnz fx_36
fx_36_b:
v_mfma_f32_16x16x32_bf16 v[36:39], v[124:127], v[180:183], v[36:39]
s_waitcnt lgkmcnt(5)
buffer_load_dwordx4 a[136:139], v247, s[32:35], s51 offen
v_mfma_f32_16x16x32_bf16 v[40:43], v[128:131], v[176:179], v[40:43]
ds_read_b128 v[120:123], v234 offset:24576
v_max3_u32 v239, v184, v185, v186
v_mfma_f32_16x16x32_bf16 v[44:47], v[128:131], v[180:183], v[44:47]
s_waitcnt lgkmcnt(5)
v_max3_u32 v239, v239, v187, v188
v_mfma_f32_16x16x32_bf16 v[48:51], v[132:135], v[176:179], v[48:51]
ds_read_b128 v[124:127], v234 offset:25600
v_max3_u32 v239, v239, v189, v190
v_mfma_f32_16x16x32_bf16 v[52:55], v[132:135], v[180:183], v[52:55]
s_waitcnt lgkmcnt(5)
s_mov_b32 s51, 286720
buffer_load_dwordx4 a[140:143], v246, s[32:35], s51 offen offset:0
v_mfma_f32_16x16x32_bf16 v[56:59], v[136:139], v[176:179], v[56:59]
ds_read_b128 v[128:131], v234 offset:26624
wu_48:
s_cbranch_execz wu_ret2
v_max_u32 v239, v239, v191
v_mfma_f32_16x16x32_bf16 v[60:63], v[136:139], v[180:183], v[60:63]
s_waitcnt lgkmcnt(5)
v_cmp_eq_u32 vcc, -1, v239
v_mfma_f32_16x16x32_bf16 v[64:67], v[140:143], v[176:179], v[64:67]
ds_read_b128 v[132:135], v234 offset:27648
s_cbranch_vccnz fx_35
fx_35_b:
v_mfma_f32_16x16x32_bf16 v[68:71], v[140:143], v[180:183], v[68:71]
s_waitcnt lgkmcnt(5)
buffer_load_dwordx4 a[144:147], v246, s[32:35], s51 offen offset:1024
v_mfma_f32_16x16x32_bf16 v[72:75], v[144:147], v[176:179], v[72:75]
s_waitcnt vmcnt(17)
s_barrier
ds_read_b128 v[136:139], v235 offset:0
v_mfma_f32_16x16x32_bf16 v[76:79], v[144:147], v[180:183], v[76:79]
s_waitcnt lgkmcnt(5)
v_mfma_f32_16x16x32_bf16 v[80:83], v[148:151], v[176:179], v[80:83]
ds_read_b128 v[140:143], v235 offset:1024
v_mfma_f32_16x16x32_bf16 v[84:87], v[148:151], v[180:183], v[84:87]
s_waitcnt lgkmcnt(5)
buffer_load_dwordx4 a[148:151], v246, s[32:35], s51 offen offset:2048
v_mfma_f32_16x16x32_bf16 v[88:91], v[120:123], v[176:179], v[88:91]
ds_read_b128 v[144:147], v235 offset:2048
v_mfma_f32_16x16x32_bf16 v[92:95], v[120:123], v[180:183], v[92:95]
s_waitcnt lgkmcnt(5)
v_mfma_f32_16x16x32_bf16 v[96:99], v[124:127], v[176:179], v[96:99]
ds_read_b128 v[148:151], v235 offset:3072
v_mfma_f32_16x16x32_bf16 v[100:103], v[124:127], v[180:183], v[100:103]
s_waitcnt lgkmcnt(5)
buffer_load_dwordx4 a[152:155], v246, s[32:35], s51 offen offset:3072
v_mfma_f32_16x16x32_bf16 v[104:107], v[128:131], v[176:179], v[104:107]
ds_read_b128 v[120:123], v235 offset:4096
v_mfma_f32_16x16x32_bf16 v[108:111], v[128:131], v[180:183], v[108:111]
s_waitcnt lgkmcnt(5)
v_mfma_f32_16x16x32_bf16 v[112:115], v[132:135], v[176:179], v[112:115]
ds_read_b128 v[124:127], v235 offset:5120
v_mfma_f32_16x16x32_bf16 v[116:119], v[132:135], v[180:183], v[116:119]
s_waitcnt lgkmcnt(5)
buffer_load_dwordx4 a[156:159], v247, s[32:35], s51 offen
v_mfma_f32_16x16x32_bf16 v[8:11], v[136:139], v[184:187], v[8:11]
ds_read_b128 v[128:131], v235 offset:6144
v_max3_u32 v239, v216, v217, v218
v_mfma_f32_16x16x32_bf16 v[12:15], v[136:139], v[188:191], v[12:15]
s_waitcnt lgkmcnt(5)
v_max3_u32 v239, v239, v219, v220
v_mfma_f32_16x16x32_bf16 v[16:19], v[140:143], v[184:187], v[16:19]
ds_read_b128 v[132:135], v235 offset:7168
v_max3_u32 v239, v239, v221, v222
v_mfma_f32_16x16x32_bf16 v[20:23], v[140:143], v[188:191], v[20:23]
s_waitcnt lgkmcnt(5)
s_mov_b32 s51, 327680
buffer_load_dwordx4 a[160:163], v246, s[32:35], s51 offen offset:0
v_mfma_f32_16x16x32_bf16 v[24:27], v[144:147], v[184:187], v[24:27]
ds_read_b128 v[136:139], v235 offset:8192
v_max_u32 v239, v239, v223
v_mfma_f32_16x16x32_bf16 v[28:31], v[144:147], v[188:191], v[28:31]
s_waitcnt lgkmcnt(5)
v_cmp_eq_u32 vcc, -1, v239
v_mfma_f32_16x16x32_bf16 v[32:35], v[148:151], v[184:187], v[32:35]
ds_read_b128 v[140:143], v235 offset:9216
s_cbranch_vccnz fx_38
fx_38_b:
v_mfma_f32_16x16x32_bf16 v[36:39], v[148:151], v[188:191], v[36:39]
s_waitcnt lgkmcnt(5)
buffer_load_dwordx4 a[164:167], v246, s[32:35], s51 offen offset:1024
v_mfma_f32_16x16x32_bf16 v[40:43], v[120:123], v[184:187], v[40:43]
ds_read_b128 v[144:147], v235 offset:10240
v_max3_u32 v239, v192, v193, v194
v_mfma_f32_16x16x32_bf16 v[44:47], v[120:123], v[188:191], v[44:47]
s_waitcnt lgkmcnt(5)
v_max3_u32 v239, v239, v195, v196
v_mfma_f32_16x16x32_bf16 v[48:51], v[124:127], v[184:187], v[48:51]
ds_read_b128 v[148:151], v235 offset:11264
v_max3_u32 v239, v239, v197, v198
v_mfma_f32_16x16x32_bf16 v[52:55], v[124:127], v[188:191], v[52:55]
wu_49:
s_cbranch_execz wu_ret2
s_waitcnt lgkmcnt(5)
buffer_load_dwordx4 a[168:171], v246, s[32:35], s51 offen offset:2048
v_mfma_f32_16x16x32_bf16 v[56:59], v[128:131], v[184:187], v[56:59]
ds_read_b128 v[120:123], v235 offset:12288
v_max_u32 v239, v239, v199
v_mfma_f32_16x16x32_bf16 v[60:63], v[128:131], v[188:191], v[60:63]
s_waitcnt lgkmcnt(5)
v_cmp_eq_u32 vcc, -1, v239
v_mfma_f32_16x16x32_bf16 v[64:67], v[132:135], v[184:187], v[64:67]
ds_read_b128 v[124:127], v235 offset:13312
s_cbranch_vccnz fx_37
fx_37_b:
v_mfma_f32_16x16x32_bf16 v[68:71], v[132:135], v[188:191], v[68:71]
s_waitcnt lgkmcnt(5)
buffer_load_dwordx4 a[172:175], v246, s[32:35], s51 offen offset:3072
v_mfma_f32_16x16x32_bf16 v[72:75], v[136:139], v[184:187], v[72:75]
ds_read_b128 v[128:131], v235 offset:14336
v_mfma_f32_16x16x32_bf16 v[76:79], v[136:139], v[188:191], v[76:79]
s_waitcnt lgkmcnt(5)
v_mfma_f32_16x16x32_bf16 v[80:83], v[140:143], v[184:187], v[80:83]
ds_read_b128 v[132:135], v235 offset:15360
v_mfma_f32_16x16x32_bf16 v[84:87], v[140:143], v[188:191], v[84:87]
s_waitcnt lgkmcnt(5)
buffer_load_dwordx4 a[176:179], v247, s[32:35], s51 offen
v_mfma_f32_16x16x32_bf16 v[88:91], v[144:147], v[184:187], v[88:91]
ds_read_b128 v[136:139], v235 offset:16384
v_mfma_f32_16x16x32_bf16 v[92:95], v[144:147], v[188:191], v[92:95]
s_waitcnt lgkmcnt(5)
v_mfma_f32_16x16x32_bf16 v[96:99], v[148:151], v[184:187], v[96:99]
ds_read_b128 v[140:143], v235 offset:17408
v_mfma_f32_16x16x32_bf16 v[100:103], v[148:151], v[188:191], v[100:103]
s_waitcnt lgkmcnt(5)
s_mov_b32 s51, 368640
buffer_load_dwordx4 a[180:183], v246, s[32:35], s51 offen offset:0
v_mfma_f32_16x16x32_bf16 v[104:107], v[120:123], v[184:187], v[104:107]
ds_read_b128 v[144:147], v235 offset:18432
v_mfma_f32_16x16x32_bf16 v[108:111], v[120:123], v[188:191], v[108:111]
s_waitcnt lgkmcnt(5)
v_mfma_f32_16x16x32_bf16 v[112:115], v[124:127], v[184:187], v[112:115]
ds_read_b128 v[148:151], v235 offset:19456
v_mfma_f32_16x16x32_bf16 v[116:119], v[124:127], v[188:191], v[116:119]
s_waitcnt lgkmcnt(5)
buffer_load_dwordx4 a[184:187], v246, s[32:35], s51 offen offset:1024
v_mfma_f32_16x16x32_bf16 v[8:11], v[128:131], v[192:195], v[8:11]
ds_read_b128 v[120:123], v235 offset:20480
v_max3_u32 v239, v224, v225, v226
v_mfma_f32_16x16x32_bf16 v[12:15], v[128:131], v[196:199], v[12:15]
s_waitcnt lgkmcnt(5)
v_max3_u32 v239, v239, v227, v228
v_mfma_f32_16x16x32_bf16 v[16:19], v[132:135], v[192:195], v[16:19]
ds_read_b128 v[124:127], v235 offset:21504
v_max3_u32 v239, v239, v229, v230
v_mfma_f32_16x16x32_bf16 v[20:23], v[132:135], v[196:199], v[20:23]
s_waitcnt lgkmcnt(5)
buffer_load_dwordx4 a[188:191], v246, s[32:35], s51 offen offset:2048
v_mfma_f32_16x16x32_bf16 v[24:27], v[136:139], v[192:195], v[24:27]
ds_read_b128 v[128:131], v235 offset:22528
v_max_u32 v239, v239, v231
v_mfma_f32_16x16x32_bf16 v[28:31], v[136:139], v[196:199], v[28:31]
s_waitcnt lgkmcnt(5)
v_cmp_eq_u32 vcc, -1, v239
v_mfma_f32_16x16x32_bf16 v[32:35], v[140:143], v[192:195], v[32:35]
ds_read_b128 v[132:135], v235 offset:23552
s_cbranch_vccnz fx_40
fx_40_b:
v_mfma_f32_16x16x32_bf16 v[36:39], v[140:143], v[196:199], v[36:39]
s_waitcnt lgkmcnt(5)
buffer_load_dwordx4 a[192:195], v246, s[32:35], s51 offen offset:3072
v_mfma_f32_16x16x32_bf16 v[40:43], v[144:147], v[192:195], v[40:43]
ds_read_b128 v[136:139], v235 offset:24576
v_max3_u32 v239, v200, v201, v202
v_mfma_f32_16x16x32_bf16 v[44:47], v[144:147], v[196:199], v[44:47]
s_waitcnt lgkmcnt(5)
v_max3_u32 v239, v239, v203, v204
v_mfma_f32_16x16x32_bf16 v[48:51], v[148:151], v[192:195], v[48:51]
wu_50:
s_cbranch_execz wu_ret2
ds_read_b128 v[140:143], v235 offset:25600
v_max3_u32 v239, v239, v205, v206
v_mfma_f32_16x16x32_bf16 v[52:55], v[148:151], v[196:199], v[52:55]
s_waitcnt lgkmcnt(5)
buffer_load_dwordx4 a[196:199], v247, s[32:35], s51 offen
v_mfma_f32_16x16x32_bf16 v[56:59], v[120:123], v[192:195], v[56:59]
ds_read_b128 v[144:147], v235 offset:26624
v_max_u32 v239, v239, v207
v_mfma_f32_16x16x32_bf16 v[60:63], v[120:123], v[196:199], v[60:63]
s_waitcnt lgkmcnt(5)
v_cmp_eq_u32 vcc, -1, v239
v_mfma_f32_16x16x32_bf16 v[64:67], v[124:127], v[192:195], v[64:67]
ds_read_b128 v[148:151], v235 offset:27648
s_cbranch_vccnz fx_39
fx_39_b:
v_mfma_f32_16x16x32_bf16 v[68:71], v[124:127], v[196:199], v[68:71]
s_waitcnt lgkmcnt(5)
s_mov_b32 s51, 409600
buffer_load_dwordx4 a[200:203], v246, s[32:35], s51 offen offset:0
v_mfma_f32_16x16x32_bf16 v[72:75], v[128:131], v[192:195], v[72:75]
s_waitcnt vmcnt(21)
s_barrier
s_cmp_lg_u32 s3, 0
s_cbranch_scc1 fl_41
s_lshl_b32 s50, s2, 5
s_add_u32 s50, s50, 163840
v_mov_b32 v4, s50
v_mov_b32 v5, s55
s_mov_b64 exec, 1
buffer_store_dword v5, v4, s[12:15], 0 offen sc0 sc1
s_mov_b64 exec, -1
fl_41:
ds_read_b128 v[120:123], v232 offset:0
v_mfma_f32_16x16x32_bf16 v[76:79], v[128:131], v[196:199], v[76:79]
s_waitcnt lgkmcnt(5)
v_mfma_f32_16x16x32_bf16 v[80:83], v[132:135], v[192:195], v[80:83]
ds_read_b128 v[124:127], v232 offset:1024
v_mfma_f32_16x16x32_bf16 v[84:87], v[132:135], v[196:199], v[84:87]
s_waitcnt lgkmcnt(5)
buffer_load_dwordx4 a[204:207], v246, s[32:35], s51 offen offset:1024
v_mfma_f32_16x16x32_bf16 v[88:91], v[136:139], v[192:195], v[88:91]
ds_read_b128 v[128:131], v232 offset:14336
v_mfma_f32_16x16x32_bf16 v[92:95], v[136:139], v[196:199], v[92:95]
s_waitcnt lgkmcnt(5)
v_mfma_f32_16x16x32_bf16 v[96:99], v[140:143], v[192:195], v[96:99]
ds_read_b128 v[132:135], v232 offset:15360
v_mfma_f32_16x16x32_bf16 v[100:103], v[140:143], v[196:199], v[100:103]
s_waitcnt lgkmcnt(5)
buffer_load_dwordx4 a[208:211], v246, s[32:35], s51 offen offset:2048
v_mfma_f32_16x16x32_bf16 v[104:107], v[144:147], v[192:195], v[104:107]
ds_read_b128 v[136:139], v236 offset:0
v_mfma_f32_16x16x32_bf16 v[108:111], v[144:147], v[196:199], v[108:111]
s_waitcnt lgkmcnt(5)
v_mfma_f32_16x16x32_bf16 v[112:115], v[148:151], v[192:195], v[112:115]
ds_read_b128 v[140:143], v236 offset:1024
v_mfma_f32_16x16x32_bf16 v[116:119], v[148:151], v[196:199], v[116:119]
s_waitcnt lgkmcnt(5)
buffer_load_dwordx4 a[212:215], v246, s[32:35], s51 offen offset:3072
v_mfma_f32_16x16x32_bf16 v[8:11], v[120:123], v[200:203], v[8:11]
ds_read_b128 v[144:147], v236 offset:14336
s_mul_i32 s21, s20, 55296
v_lshlrev_b32 v4, 4, v1
v_add_u32 v237, s21, v4
v_mfma_f32_16x16x32_bf16 v[12:15], v[120:123], v[204:207], v[12:15]
s_waitcnt lgkmcnt(5)
v_add_u32 v238, 55296, v237
s_lshr_b32 s21, s44, 1
s_lshr_b32 s50, s21, 3
v_mfma_f32_16x16x32_bf16 v[16:19], v[124:127], v[200:203], v[16:19]
ds_read_b128 v[148:151], v236 offset:15360
s_and_b32 s21, s21, 7
s_lshl_b32 s21, s21, 3
s_add_u32 s21, s21, s50
v_mfma_f32_16x16x32_bf16 v[20:23], v[124:127], v[204:207], v[20:23]
s_waitcnt lgkmcnt(5)
buffer_load_dwordx4 a[216:219], v247, s[32:35], s51 offen
v_mfma_f32_16x16x32_bf16 v[8:11], v[128:131], v[208:211], v[8:11]
ds_read_b128 v[120:123], v232 offset:2048
v_and_b32 v252, 3, v1
v_lshlrev_b32 v252, 6, v252
v_bfe_u32 v253, v1, 2, 2
v_mfma_f32_16x16x32_bf16 v[12:15], v[128:131], v[212:215], v[12:15]
wu_51:
s_cbranch_execz wu_ret2
s_waitcnt lgkmcnt(5)
v_lshl_add_u32 v252, v253, 1, v252
v_add_u32 v252, s21, v252
s_and_b32 s21, s44, 3
v_mfma_f32_16x16x32_bf16 v[16:19], v[132:135], v[208:211], v[16:19]
ds_read_b128 v[124:127], v232 offset:3072
s_lshl_b32 s21, s21, 6
s_lshr_b32 s50, s44, 2
s_add_u32 s21, s21, s50
v_mfma_f32_16x16x32_bf16 v[20:23], v[132:135], v[212:215], v[20:23]
s_waitcnt lgkmcnt(5)
s_mov_b32 s51, 450560
buffer_load_dwordx4 a[220:223], v246, s[32:35], s51 offen offset:0
v_mfma_f32_16x16x32_bf16 v[8:11], v[136:139], v[216:219], v[8:11]
ds_read_b128 v[128:131], v232 offset:16384
v_and_b32 v253, 7, v1
v_lshl_add_u32 v253, v253, 3, s21
v_cmp_gt_u32 vcc, 16, v1
v_mfma_f32_16x16x32_bf16 v[12:15], v[136:139], v[220:223], v[12:15]
s_waitcnt lgkmcnt(5)
v_cndmask_b32 v252, v253, v252, vcc
v_add_u32 v252, 5120, v252
v_lshlrev_b32 v252, 5, v252
v_mfma_f32_16x16x32_bf16 v[16:19], v[140:143], v[216:219], v[16:19]
ds_read_b128 v[132:135], v232 offset:17408
v_mov_b32 v6, 0xbfb8aa3b
v_lshlrev_b32 v4, 3, v1
v_sub_u32 v4, v237, v4
v_mfma_f32_16x16x32_bf16 v[20:23], v[140:143], v[220:223], v[20:23]
s_waitcnt lgkmcnt(5)
buffer_load_dwordx4 a[224:227], v246, s[32:35], s51 offen offset:1024
v_mfma_f32_16x16x32_bf16 v[8:11], v[144:147], v[224:227], v[8:11]
ds_read_b128 v[136:139], v236 offset:2048
v_add_u32 v5, 55296, v4
s_lshr_b32 s22, s41, 1
s_lshl_b32 s22, s22, 10
v_mfma_f32_16x16x32_bf16 v[12:15], v[144:147], v[228:231], v[12:15]
s_waitcnt lgkmcnt(5)
s_bitcmp1_b32 s41, 0
s_cselect_b32 s21, 1, 6
s_cselect_b32 s23, 1024, 0
v_mfma_f32_16x16x32_bf16 v[16:19], v[148:151], v[224:227], v[16:19]
ds_read_b128 v[140:143], v236 offset:3072
s_lshl_b32 s21, s21, 9
s_add_u32 s21, s21, s22
s_add_u32 s22, s22, s23
v_mfma_f32_16x16x32_bf16 v[20:23], v[148:151], v[228:231], v[20:23]
s_waitcnt lgkmcnt(5)
buffer_load_dwordx4 a[228:231], v246, s[32:35], s51 offen offset:2048
v_mfma_f32_16x16x32_bf16 v[24:27], v[120:123], v[200:203], v[24:27]
ds_read_b128 v[144:147], v236 offset:16384
s_cmp_eq_u32 s41, 105
s_cselect_b32 s23, 0x40000000, s22
v_mul_f32 v176, v6, v8
v_mfma_f32_16x16x32_bf16 v[28:31], v[120:123], v[204:207], v[28:31]
s_waitcnt lgkmcnt(5)
v_mul_f32 v177, v6, v9
v_mul_f32 v178, v6, v10
v_mul_f32 v179, v6, v11
v_mfma_f32_16x16x32_bf16 v[32:35], v[124:127], v[200:203], v[32:35]
ds_read_b128 v[148:151], v236 offset:17408
v_exp_f32 v176, v176
v_exp_f32 v177, v177
v_exp_f32 v178, v178
v_mfma_f32_16x16x32_bf16 v[36:39], v[124:127], v[204:207], v[36:39]
s_waitcnt lgkmcnt(5)
buffer_load_dwordx4 a[232:235], v246, s[32:35], s51 offen offset:3072
v_mfma_f32_16x16x32_bf16 v[24:27], v[128:131], v[208:211], v[24:27]
ds_read_b128 v[120:123], v232 offset:4096
v_exp_f32 v179, v179
v_mul_f32 v8, v8, v16
v_mul_f32 v9, v9, v17
v_mfma_f32_16x16x32_bf16 v[28:31], v[128:131], v[212:215], v[28:31]
s_waitcnt lgkmcnt(5)
v_mul_f32 v10, v10, v18
v_mul_f32 v11, v11, v19
v_add_f32 v176, 1.0, v176
v_mfma_f32_16x16x32_bf16 v[32:35], v[132:135], v[208:211], v[32:35]
ds_read_b128 v[124:127], v232 offset:5120
v_add_f32 v177, 1.0, v177
v_add_f32 v178, 1.0, v178
v_add_f32 v179, 1.0, v179
v_mfma_f32_16x16x32_bf16 v[36:39], v[132:135], v[212:215], v[36:39]
s_waitcnt lgkmcnt(5)
buffer_load_dwordx4 a[236:239], v247, s[32:35], s51 offen
v_mfma_f32_16x16x32_bf16 v[24:27], v[136:139], v[216:219], v[24:27]
wu_52:
s_cbranch_execz wu_ret2
ds_read_b128 v[128:131], v232 offset:18432
v_rcp_f32 v176, v176
v_rcp_f32 v177, v177
v_rcp_f32 v178, v178
v_mfma_f32_16x16x32_bf16 v[28:31], v[136:139], v[220:223], v[28:31]
s_waitcnt lgkmcnt(5)
v_rcp_f32 v179, v179
v_mul_f32 v8, v8, v176
v_mul_f32 v9, v9, v177
v_mfma_f32_16x16x32_bf16 v[32:35], v[140:143], v[216:219], v[32:35]
ds_read_b128 v[132:135], v232 offset:19456
v_mul_f32 v10, v10, v178
v_mul_f32 v11, v11, v179
v_cvt_pk_bf16_f32 v184, v8, v9
v_mfma_f32_16x16x32_bf16 v[36:39], v[140:143], v[220:223], v[36:39]
s_waitcnt lgkmcnt(5)
s_mov_b32 s51, 491520
buffer_load_dwordx4 a[240:243], v246, s[32:35], s51 offen offset:0
v_mfma_f32_16x16x32_bf16 v[24:27], v[144:147], v[224:227], v[24:27]
ds_read_b128 v[136:139], v236 offset:4096
v_cvt_pk_bf16_f32 v185, v10, v11
v_mul_f32 v180, v6, v12
v_mul_f32 v181, v6, v13
v_mfma_f32_16x16x32_bf16 v[28:31], v[144:147], v[228:231], v[28:31]
s_waitcnt lgkmcnt(5)
v_mul_f32 v182, v6, v14
v_mul_f32 v183, v6, v15
v_exp_f32 v180, v180
v_mfma_f32_16x16x32_bf16 v[32:35], v[148:151], v[224:227], v[32:35]
ds_read_b128 v[140:143], v236 offset:5120
v_exp_f32 v181, v181
v_exp_f32 v182, v182
v_exp_f32 v183, v183
v_mfma_f32_16x16x32_bf16 v[36:39], v[148:151], v[228:231], v[36:39]
s_waitcnt lgkmcnt(5)
buffer_load_dwordx4 a[244:247], v246, s[32:35], s51 offen offset:1024
v_mfma_f32_16x16x32_bf16 v[40:43], v[120:123], v[200:203], v[40:43]
ds_read_b128 v[144:147], v236 offset:18432
v_mul_f32 v12, v12, v20
v_mul_f32 v13, v13, v21
v_mul_f32 v14, v14, v22
v_mfma_f32_16x16x32_bf16 v[44:47], v[120:123], v[204:207], v[44:47]
s_waitcnt lgkmcnt(5)
v_mul_f32 v15, v15, v23
v_add_f32 v180, 1.0, v180
v_add_f32 v181, 1.0, v181
v_mfma_f32_16x16x32_bf16 v[48:51], v[124:127], v[200:203], v[48:51]
ds_read_b128 v[148:151], v236 offset:19456
v_add_f32 v182, 1.0, v182
v_add_f32 v183, 1.0, v183
v_rcp_f32 v180, v180
v_mfma_f32_16x16x32_bf16 v[52:55], v[124:127], v[204:207], v[52:55]
s_waitcnt lgkmcnt(5)
buffer_load_dwordx4 a[248:251], v246, s[32:35], s51 offen offset:2048
v_mfma_f32_16x16x32_bf16 v[40:43], v[128:131], v[208:211], v[40:43]
ds_read_b128 v[120:123], v232 offset:6144
v_rcp_f32 v181, v181
v_rcp_f32 v182, v182
v_rcp_f32 v183, v183
v_mfma_f32_16x16x32_bf16 v[44:47], v[128:131], v[212:215], v[44:47]
s_waitcnt lgkmcnt(5)
v_mul_f32 v12, v12, v180
v_mul_f32 v13, v13, v181
v_mul_f32 v14, v14, v182
v_mfma_f32_16x16x32_bf16 v[48:51], v[132:135], v[208:211], v[48:51]
ds_read_b128 v[124:127], v232 offset:7168
v_mul_f32 v15, v15, v183
v_cvt_pk_bf16_f32 v188, v12, v13
v_cvt_pk_bf16_f32 v189, v14, v15
v_mfma_f32_16x16x32_bf16 v[52:55], v[132:135], v[212:215], v[52:55]
s_waitcnt lgkmcnt(5)
buffer_load_dwordx4 a[252:255], v246, s[32:35], s51 offen offset:3072
v_mfma_f32_16x16x32_bf16 v[40:43], v[136:139], v[216:219], v[40:43]
ds_read_b128 v[128:131], v232 offset:20480
v_mul_f32 v176, v6, v24
v_mul_f32 v177, v6, v25
v_mul_f32 v178, v6, v26
v_mfma_f32_16x16x32_bf16 v[44:47], v[136:139], v[220:223], v[44:47]
s_waitcnt lgkmcnt(5)
v_mul_f32 v179, v6, v27
v_exp_f32 v176, v176
v_exp_f32 v177, v177
v_mfma_f32_16x16x32_bf16 v[48:51], v[140:143], v[216:219], v[48:51]
ds_read_b128 v[132:135], v232 offset:21504
v_exp_f32 v178, v178
v_exp_f32 v179, v179
v_mul_f32 v24, v24, v32
v_mfma_f32_16x16x32_bf16 v[52:55], v[140:143], v[220:223], v[52:55]
wu_53:
s_cbranch_execz wu_ret2
s_waitcnt lgkmcnt(5)
buffer_load_dwordx4 v[152:155], v247, s[32:35], s51 offen
v_mfma_f32_16x16x32_bf16 v[40:43], v[144:147], v[224:227], v[40:43]
ds_read_b128 v[136:139], v236 offset:6144
v_mul_f32 v25, v25, v33
v_mul_f32 v26, v26, v34
v_mul_f32 v27, v27, v35
v_mfma_f32_16x16x32_bf16 v[44:47], v[144:147], v[228:231], v[44:47]
s_waitcnt lgkmcnt(5)
v_add_f32 v176, 1.0, v176
v_add_f32 v177, 1.0, v177
v_add_f32 v178, 1.0, v178
v_mfma_f32_16x16x32_bf16 v[48:51], v[148:151], v[224:227], v[48:51]
ds_read_b128 v[140:143], v236 offset:7168
v_add_f32 v179, 1.0, v179
v_rcp_f32 v176, v176
v_rcp_f32 v177, v177
v_mfma_f32_16x16x32_bf16 v[52:55], v[148:151], v[228:231], v[52:55]
s_waitcnt lgkmcnt(5)
v_rcp_f32 v178, v178
v_rcp_f32 v179, v179
v_mul_f32 v24, v24, v176
v_mfma_f32_16x16x32_bf16 v[56:59], v[120:123], v[200:203], v[56:59]
ds_read_b128 v[144:147], v236 offset:20480
v_mul_f32 v25, v25, v177
v_mul_f32 v26, v26, v178
v_mul_f32 v27, v27, v179
v_mfma_f32_16x16x32_bf16 v[60:63], v[120:123], v[204:207], v[60:63]
s_waitcnt lgkmcnt(5)
v_cvt_pk_bf16_f32 v186, v24, v25
v_cvt_pk_bf16_f32 v187, v26, v27
buffer_store_dwordx4 v[184:187], v237, s[24:27], s22 offen offset:0 sc0 sc1
v_mfma_f32_16x16x32_bf16 v[64:67], v[124:127], v[200:203], v[64:67]
ds_read_b128 v[148:151], v236 offset:21504
v_mul_f32 v180, v6, v28
v_mul_f32 v181, v6, v29
v_mul_f32 v182, v6, v30
v_mfma_f32_16x16x32_bf16 v[68:71], v[124:127], v[204:207], v[68:71]
s_waitcnt lgkmcnt(5)
v_mul_f32 v183, v6, v31
v_exp_f32 v180, v180
v_exp_f32 v181, v181
v_mfma_f32_16x16x32_bf16 v[56:59], v[128:131], v[208:211], v[56:59]
ds_read_b128 v[120:123], v232 offset:8192
v_exp_f32 v182, v182
v_exp_f32 v183, v183
v_mul_f32 v28, v28, v36
v_mfma_f32_16x16x32_bf16 v[60:63], v[128:131], v[212:215], v[60:63]
s_waitcnt lgkmcnt(5)
v_mul_f32 v29, v29, v37
v_mul_f32 v30, v30, v38
v_mul_f32 v31, v31, v39
v_mfma_f32_16x16x32_bf16 v[64:67], v[132:135], v[208:211], v[64:67]
ds_read_b128 v[124:127], v232 offset:9216
v_add_f32 v180, 1.0, v180
v_add_f32 v181, 1.0, v181
v_add_f32 v182, 1.0, v182
v_mfma_f32_16x16x32_bf16 v[68:71], v[132:135], v[212:215], v[68:71]
s_waitcnt lgkmcnt(5)
v_add_f32 v183, 1.0, v183
v_rcp_f32 v180, v180
v_rcp_f32 v181, v181
v_mfma_f32_16x16x32_bf16 v[56:59], v[136:139], v[216:219], v[56:59]
ds_read_b128 v[128:131], v232 offset:22528
v_rcp_f32 v182, v182
v_rcp_f32 v183, v183
v_mul_f32 v28, v28, v180
v_mfma_f32_16x16x32_bf16 v[60:63], v[136:139], v[220:223], v[60:63]
s_waitcnt lgkmcnt(5)
v_mul_f32 v29, v29, v181
v_mul_f32 v30, v30, v182
v_mul_f32 v31, v31, v183
v_mfma_f32_16x16x32_bf16 v[64:67], v[140:143], v[216:219], v[64:67]
ds_read_b128 v[132:135], v232 offset:23552
v_cvt_pk_bf16_f32 v190, v28, v29
v_cvt_pk_bf16_f32 v191, v30, v31
buffer_store_dwordx4 v[188:191], v238, s[24:27], s22 offen offset:0 sc0 sc1
v_mfma_f32_16x16x32_bf16 v[68:71], v[140:143], v[220:223], v[68:71]
s_waitcnt lgkmcnt(5)
v_mul_f32 v176, v6, v40
v_mul_f32 v177, v6, v41
v_mul_f32 v178, v6, v42
v_mfma_f32_16x16x32_bf16 v[56:59], v[144:147], v[224:227], v[56:59]
ds_read_b128 v[136:139], v236 offset:8192
v_mul_f32 v179, v6, v43
v_exp_f32 v176, v176
v_exp_f32 v177, v177
v_mfma_f32_16x16x32_bf16 v[60:63], v[144:147], v[228:231], v[60:63]
s_waitcnt lgkmcnt(5)
v_exp_f32 v178, v178
v_exp_f32 v179, v179
v_mul_f32 v40, v40, v48
v_mfma_f32_16x16x32_bf16 v[64:67], v[148:151], v[224:227], v[64:67]
wu_54:
s_cbranch_execz wu_ret2
ds_read_b128 v[140:143], v236 offset:9216
v_mul_f32 v41, v41, v49
v_mul_f32 v42, v42, v50
v_mul_f32 v43, v43, v51
v_mfma_f32_16x16x32_bf16 v[68:71], v[148:151], v[228:231], v[68:71]
s_waitcnt lgkmcnt(5)
v_add_f32 v176, 1.0, v176
v_add_f32 v177, 1.0, v177
v_add_f32 v178, 1.0, v178
v_mfma_f32_16x16x32_bf16 v[72:75], v[120:123], v[200:203], v[72:75]
ds_read_b128 v[144:147], v236 offset:22528
v_add_f32 v179, 1.0, v179
v_rcp_f32 v176, v176
v_rcp_f32 v177, v177
v_mfma_f32_16x16x32_bf16 v[76:79], v[120:123], v[204:207], v[76:79]
s_waitcnt lgkmcnt(5)
v_rcp_f32 v178, v178
v_rcp_f32 v179, v179
v_mul_f32 v40, v40, v176
v_mfma_f32_16x16x32_bf16 v[80:83], v[124:127], v[200:203], v[80:83]
ds_read_b128 v[148:151], v236 offset:23552
v_mul_f32 v41, v41, v177
v_mul_f32 v42, v42, v178
v_mul_f32 v43, v43, v179
v_mfma_f32_16x16x32_bf16 v[84:87], v[124:127], v[204:207], v[84:87]
s_waitcnt lgkmcnt(5)
v_cvt_pk_bf16_f32 v192, v40, v41
v_cvt_pk_bf16_f32 v193, v42, v43
v_mul_f32 v180, v6, v44
v_mfma_f32_16x16x32_bf16 v[72:75], v[128:131], v[208:211], v[72:75]
ds_read_b128 v[120:123], v232 offset:10240
v_mul_f32 v181, v6, v45
v_mul_f32 v182, v6, v46
v_mul_f32 v183, v6, v47
v_mfma_f32_16x16x32_bf16 v[76:79], v[128:131], v[212:215], v[76:79]
s_waitcnt lgkmcnt(5)
v_exp_f32 v180, v180
v_exp_f32 v181, v181
v_exp_f32 v182, v182
v_mfma_f32_16x16x32_bf16 v[80:83], v[132:135], v[208:211], v[80:83]
ds_read_b128 v[124:127], v232 offset:11264
v_exp_f32 v183, v183
v_mul_f32 v44, v44, v52
v_mul_f32 v45, v45, v53
v_mfma_f32_16x16x32_bf16 v[84:87], v[132:135], v[212:215], v[84:87]
s_waitcnt lgkmcnt(5)
v_mul_f32 v46, v46, v54
v_mul_f32 v47, v47, v55
v_add_f32 v180, 1.0, v180
v_mfma_f32_16x16x32_bf16 v[72:75], v[136:139], v[216:219], v[72:75]
ds_read_b128 v[128:131], v232 offset:24576
v_add_f32 v181, 1.0, v181
v_add_f32 v182, 1.0, v182
v_add_f32 v183, 1.0, v183
v_mfma_f32_16x16x32_bf16 v[76:79], v[136:139], v[220:223], v[76:79]
s_waitcnt lgkmcnt(5)
v_rcp_f32 v180, v180
v_rcp_f32 v181, v181
v_rcp_f32 v182, v182
v_mfma_f32_16x16x32_bf16 v[80:83], v[140:143], v[216:219], v[80:83]
ds_read_b128 v[132:135], v232 offset:25600
v_rcp_f32 v183, v183
v_mul_f32 v44, v44, v180
v_mul_f32 v45, v45, v181
v_mfma_f32_16x16x32_bf16 v[84:87], v[140:143], v[220:223], v[84:87]
s_waitcnt lgkmcnt(5)
v_mul_f32 v46, v46, v182
v_mul_f32 v47, v47, v183
v_cvt_pk_bf16_f32 v196, v44, v45
v_mfma_f32_16x16x32_bf16 v[72:75], v[144:147], v[224:227], v[72:75]
ds_read_b128 v[136:139], v236 offset:10240
v_cvt_pk_bf16_f32 v197, v46, v47
buffer_load_dword v253, v252, s[12:15], 0 offen sc1
v_mul_f32 v176, v6, v56
v_mfma_f32_16x16x32_bf16 v[76:79], v[144:147], v[228:231], v[76:79]
s_waitcnt lgkmcnt(5)
v_mul_f32 v177, v6, v57
v_mul_f32 v178, v6, v58
v_mul_f32 v179, v6, v59
v_mfma_f32_16x16x32_bf16 v[80:83], v[148:151], v[224:227], v[80:83]
ds_read_b128 v[140:143], v236 offset:11264
v_exp_f32 v176, v176
v_exp_f32 v177, v177
v_exp_f32 v178, v178
v_mfma_f32_16x16x32_bf16 v[84:87], v[148:151], v[228:231], v[84:87]
s_waitcnt lgkmcnt(5)
v_exp_f32 v179, v179
v_mul_f32 v56, v56, v64
v_mul_f32 v57, v57, v65
v_mfma_f32_16x16x32_bf16 v[88:91], v[120:123], v[200:203], v[88:91]
ds_read_b128 v[144:147], v236 offset:24576
v_mul_f32 v58, v58, v66
v_mul_f32 v59, v59, v67
wu_55:
s_cbranch_execz wu_ret2
v_add_f32 v176, 1.0, v176
v_mfma_f32_16x16x32_bf16 v[92:95], v[120:123], v[204:207], v[92:95]
s_waitcnt lgkmcnt(5)
v_add_f32 v177, 1.0, v177
v_add_f32 v178, 1.0, v178
v_add_f32 v179, 1.0, v179
v_mfma_f32_16x16x32_bf16 v[96:99], v[124:127], v[200:203], v[96:99]
ds_read_b128 v[148:151], v236 offset:25600
v_rcp_f32 v176, v176
v_rcp_f32 v177, v177
v_rcp_f32 v178, v178
v_mfma_f32_16x16x32_bf16 v[100:103], v[124:127], v[204:207], v[100:103]
s_waitcnt lgkmcnt(5)
v_rcp_f32 v179, v179
v_mul_f32 v56, v56, v176
v_mul_f32 v57, v57, v177
v_mfma_f32_16x16x32_bf16 v[88:91], v[128:131], v[208:211], v[88:91]
ds_read_b128 v[120:123], v232 offset:12288
v_mul_f32 v58, v58, v178
v_mul_f32 v59, v59, v179
v_cvt_pk_bf16_f32 v194, v56, v57
v_mfma_f32_16x16x32_bf16 v[92:95], v[128:131], v[212:215], v[92:95]
s_waitcnt lgkmcnt(5)
v_cvt_pk_bf16_f32 v195, v58, v59
buffer_store_dwordx4 v[192:195], v237, s[24:27], s23 offen offset:1024 sc0 sc1
v_mul_f32 v180, v6, v60
v_mfma_f32_16x16x32_bf16 v[96:99], v[132:135], v[208:211], v[96:99]
ds_read_b128 v[124:127], v232 offset:13312
v_mul_f32 v181, v6, v61
v_mul_f32 v182, v6, v62
v_mul_f32 v183, v6, v63
v_mfma_f32_16x16x32_bf16 v[100:103], v[132:135], v[212:215], v[100:103]
s_waitcnt lgkmcnt(5)
v_exp_f32 v180, v180
v_exp_f32 v181, v181
v_exp_f32 v182, v182
v_mfma_f32_16x16x32_bf16 v[88:91], v[136:139], v[216:219], v[88:91]
ds_read_b128 v[128:131], v232 offset:26624
v_exp_f32 v183, v183
v_mul_f32 v60, v60, v68
v_mul_f32 v61, v61, v69
v_mfma_f32_16x16x32_bf16 v[92:95], v[136:139], v[220:223], v[92:95]
s_waitcnt lgkmcnt(5)
v_mul_f32 v62, v62, v70
v_mul_f32 v63, v63, v71
v_add_f32 v180, 1.0, v180
v_mfma_f32_16x16x32_bf16 v[96:99], v[140:143], v[216:219], v[96:99]
ds_read_b128 v[132:135], v232 offset:27648
v_add_f32 v181, 1.0, v181
v_add_f32 v182, 1.0, v182
v_add_f32 v183, 1.0, v183
v_mfma_f32_16x16x32_bf16 v[100:103], v[140:143], v[220:223], v[100:103]
s_waitcnt lgkmcnt(5)
v_rcp_f32 v180, v180
v_rcp_f32 v181, v181
v_rcp_f32 v182, v182
v_mfma_f32_16x16x32_bf16 v[88:91], v[144:147], v[224:227], v[88:91]
ds_read_b128 v[136:139], v236 offset:12288
v_rcp_f32 v183, v183
v_mul_f32 v60, v60, v180
v_mul_f32 v61, v61, v181
v_mfma_f32_16x16x32_bf16 v[92:95], v[144:147], v[228:231], v[92:95]
s_waitcnt lgkmcnt(5)
v_mul_f32 v62, v62, v182
v_mul_f32 v63, v63, v183
v_cvt_pk_bf16_f32 v198, v60, v61
v_mfma_f32_16x16x32_bf16 v[96:99], v[148:151], v[224:227], v[96:99]
ds_read_b128 v[140:143], v236 offset:13312
v_cvt_pk_bf16_f32 v199, v62, v63
buffer_store_dwordx4 v[196:199], v238, s[24:27], s23 offen offset:1024 sc0 sc1
v_mul_f32 v176, v6, v72
v_mfma_f32_16x16x32_bf16 v[100:103], v[148:151], v[228:231], v[100:103]
s_waitcnt lgkmcnt(5)
v_mul_f32 v177, v6, v73
v_mul_f32 v178, v6, v74
v_mul_f32 v179, v6, v75
v_mfma_f32_16x16x32_bf16 v[104:107], v[120:123], v[200:203], v[104:107]
ds_read_b128 v[144:147], v236 offset:26624
v_exp_f32 v176, v176
v_exp_f32 v177, v177
v_exp_f32 v178, v178
v_mfma_f32_16x16x32_bf16 v[108:111], v[120:123], v[204:207], v[108:111]
s_waitcnt lgkmcnt(5)
v_exp_f32 v179, v179
v_mul_f32 v72, v72, v80
v_mul_f32 v73, v73, v81
v_mfma_f32_16x16x32_bf16 v[112:115], v[124:127], v[200:203], v[112:115]
ds_read_b128 v[148:151], v236 offset:27648
v_mul_f32 v74, v74, v82
v_mul_f32 v75, v75, v83
v_add_f32 v176, 1.0, v176
v_mfma_f32_16x16x32_bf16 v[116:119], v[124:127], v[204:207], v[116:119]
s_waitcnt lgkmcnt(5)
wu_56:
s_cbranch_execz wu_ret2
v_add_f32 v177, 1.0, v177
v_add_f32 v178, 1.0, v178
v_add_f32 v179, 1.0, v179
v_mfma_f32_16x16x32_bf16 v[104:107], v[128:131], v[208:211], v[104:107]
v_rcp_f32 v176, v176
v_rcp_f32 v177, v177
v_rcp_f32 v178, v178
v_mfma_f32_16x16x32_bf16 v[108:111], v[128:131], v[212:215], v[108:111]
s_waitcnt lgkmcnt(4)
v_rcp_f32 v179, v179
v_mul_f32 v72, v72, v176
v_mul_f32 v73, v73, v177
v_mfma_f32_16x16x32_bf16 v[112:115], v[132:135], v[208:211], v[112:115]
v_mul_f32 v74, v74, v178
v_mul_f32 v75, v75, v179
v_cvt_pk_bf16_f32 v184, v72, v73
v_mfma_f32_16x16x32_bf16 v[116:119], v[132:135], v[212:215], v[116:119]
s_waitcnt lgkmcnt(3)
v_cvt_pk_bf16_f32 v185, v74, v75
v_mul_f32 v180, v6, v76
v_mul_f32 v181, v6, v77
v_mfma_f32_16x16x32_bf16 v[104:107], v[136:139], v[216:219], v[104:107]
v_mul_f32 v182, v6, v78
v_mul_f32 v183, v6, v79
v_exp_f32 v180, v180
v_mfma_f32_16x16x32_bf16 v[108:111], v[136:139], v[220:223], v[108:111]
s_waitcnt lgkmcnt(2)
v_exp_f32 v181, v181
v_exp_f32 v182, v182
v_exp_f32 v183, v183
v_mfma_f32_16x16x32_bf16 v[112:115], v[140:143], v[216:219], v[112:115]
v_mul_f32 v76, v76, v84
v_mul_f32 v77, v77, v85
v_mul_f32 v78, v78, v86
v_mfma_f32_16x16x32_bf16 v[116:119], v[140:143], v[220:223], v[116:119]
s_waitcnt lgkmcnt(1)
v_mul_f32 v79, v79, v87
v_add_f32 v180, 1.0, v180
v_add_f32 v181, 1.0, v181
v_mfma_f32_16x16x32_bf16 v[104:107], v[144:147], v[224:227], v[104:107]
v_add_f32 v182, 1.0, v182
v_add_f32 v183, 1.0, v183
v_rcp_f32 v180, v180
v_mfma_f32_16x16x32_bf16 v[108:111], v[144:147], v[228:231], v[108:111]
s_waitcnt lgkmcnt(0)
v_rcp_f32 v181, v181
v_rcp_f32 v182, v182
v_rcp_f32 v183, v183
v_mfma_f32_16x16x32_bf16 v[112:115], v[148:151], v[224:227], v[112:115]
v_mul_f32 v76, v76, v180
v_mul_f32 v77, v77, v181
v_mul_f32 v78, v78, v182
v_mfma_f32_16x16x32_bf16 v[116:119], v[148:151], v[228:231], v[116:119]
v_mul_f32 v79, v79, v183
v_cvt_pk_bf16_f32 v188, v76, v77
v_cvt_pk_bf16_f32 v189, v78, v79
s_mov_b32 s51, 532480
buffer_load_dwordx4 v[156:159], v246, s[32:35], s51 offen offset:0
buffer_load_dwordx4 v[160:163], v246, s[32:35], s51 offen offset:1024
buffer_load_dwordx4 v[164:167], v246, s[32:35], s51 offen offset:2048
buffer_load_dwordx4 v[168:171], v246, s[32:35], s51 offen offset:3072
buffer_load_dwordx4 v[172:175], v247, s[32:35], s51 offen
v_mul_f32 v176, v6, v88
v_mul_f32 v177, v6, v89
v_mul_f32 v178, v6, v90
v_mul_f32 v179, v6, v91
v_exp_f32 v176, v176
v_exp_f32 v177, v177
v_exp_f32 v178, v178
v_exp_f32 v179, v179
v_mul_f32 v88, v88, v96
v_mul_f32 v89, v89, v97
v_mul_f32 v90, v90, v98
v_mul_f32 v91, v91, v99
v_add_f32 v176, 1.0, v176
v_add_f32 v177, 1.0, v177
v_add_f32 v178, 1.0, v178
v_add_f32 v179, 1.0, v179
v_rcp_f32 v176, v176
v_rcp_f32 v177, v177
v_rcp_f32 v178, v178
v_rcp_f32 v179, v179
v_mul_f32 v88, v88, v176
v_mul_f32 v89, v89, v177
v_mul_f32 v90, v90, v178
v_mul_f32 v91, v91, v179
v_cvt_pk_bf16_f32 v186, v88, v89
v_cvt_pk_bf16_f32 v187, v90, v91
buffer_store_dwordx4 v[184:187], v237, s[24:27], s23 offen offset:2048 sc0 sc1
v_mul_f32 v180, v6, v92
v_mul_f32 v181, v6, v93
v_mul_f32 v182, v6, v94
v_mul_f32 v183, v6, v95
v_exp_f32 v180, v180
v_exp_f32 v181, v181
v_exp_f32 v182, v182
v_exp_f32 v183, v183
v_mul_f32 v92, v92, v100
v_mul_f32 v93, v93, v101
v_mul_f32 v94, v94, v102
v_mul_f32 v95, v95, v103
v_add_f32 v180, 1.0, v180
wu_57:
s_cbranch_execz wu_ret2
v_add_f32 v181, 1.0, v181
v_add_f32 v182, 1.0, v182
v_add_f32 v183, 1.0, v183
v_rcp_f32 v180, v180
v_rcp_f32 v181, v181
v_rcp_f32 v182, v182
v_rcp_f32 v183, v183
v_mul_f32 v92, v92, v180
v_mul_f32 v93, v93, v181
v_mul_f32 v94, v94, v182
v_mul_f32 v95, v95, v183
v_cvt_pk_bf16_f32 v190, v92, v93
v_cvt_pk_bf16_f32 v191, v94, v95
buffer_store_dwordx4 v[188:191], v238, s[24:27], s23 offen offset:2048 sc0 sc1
v_pk_mul_f32 v[176:177], v[104:105], v[6:7] op_sel_hi:[1,0]
v_pk_mul_f32 v[178:179], v[106:107], v[6:7] op_sel_hi:[1,0]
v_exp_f32 v176, v176
v_exp_f32 v177, v177
v_exp_f32 v178, v178
v_exp_f32 v179, v179
v_pk_mul_f32 v[104:105], v[104:105], v[112:113]
v_pk_mul_f32 v[106:107], v[106:107], v[114:115]
v_pk_add_f32 v[176:177], v[176:177], 1.0 op_sel_hi:[1,0]
v_pk_add_f32 v[178:179], v[178:179], 1.0 op_sel_hi:[1,0]
v_rcp_f32 v176, v176
v_rcp_f32 v177, v177
v_rcp_f32 v178, v178
v_rcp_f32 v179, v179
v_pk_mul_f32 v[104:105], v[104:105], v[176:177]
v_pk_mul_f32 v[106:107], v[106:107], v[178:179]
v_cvt_pk_bf16_f32 v192, v104, v105
v_cvt_pk_bf16_f32 v193, v106, v107
buffer_store_dwordx2 v[192:193], v4, s[24:27], s21 offen sc0 sc1
v_pk_mul_f32 v[180:181], v[108:109], v[6:7] op_sel_hi:[1,0]
v_pk_mul_f32 v[182:183], v[110:111], v[6:7] op_sel_hi:[1,0]
v_exp_f32 v180, v180
v_exp_f32 v181, v181
v_exp_f32 v182, v182
v_exp_f32 v183, v183
v_pk_mul_f32 v[108:109], v[108:109], v[116:117]
v_pk_mul_f32 v[110:111], v[110:111], v[118:119]
v_pk_add_f32 v[180:181], v[180:181], 1.0 op_sel_hi:[1,0]
v_pk_add_f32 v[182:183], v[182:183], 1.0 op_sel_hi:[1,0]
v_rcp_f32 v180, v180
v_rcp_f32 v181, v181
v_rcp_f32 v182, v182
v_rcp_f32 v183, v183
v_pk_mul_f32 v[108:109], v[108:109], v[180:181]
v_pk_mul_f32 v[110:111], v[110:111], v[182:183]
v_cvt_pk_bf16_f32 v196, v108, v109
v_cvt_pk_bf16_f32 v197, v110, v111
buffer_store_dwordx2 v[196:197], v5, s[24:27], s21 offen sc0 sc1
s_waitcnt vmcnt(11)
v_cmp_ne_u32 vcc, s55, v253
s_cbranch_vccnz fx_42
fx_42_b:
v_lshlrev_b32 v2, 4, v1
s_lshl_b32 s20, s44, 2
s_lshl_b32 s21, s46, 10
s_mov_b32 s23, s3
s_add_u32 s22, s23, 0
s_and_b32 s22, s22, 3
s_add_u32 s22, s22, s20
s_mul_i32 s22, s22, 55296
s_add_u32 s22, s22, s21
v_add_u32 v240, s22, v2
v_lshl_add_u32 v248, v1, 3, s22
s_add_u32 s22, s23, 1
s_and_b32 s22, s22, 3
s_add_u32 s22, s22, s20
s_mul_i32 s22, s22, 55296
s_add_u32 s22, s22, s21
v_add_u32 v241, s22, v2
v_lshl_add_u32 v249, v1, 3, s22
s_add_u32 s22, s23, 2
s_and_b32 s22, s22, 3
s_add_u32 s22, s22, s20
s_mul_i32 s22, s22, 55296
s_add_u32 s22, s22, s21
v_add_u32 v242, s22, v2
v_lshl_add_u32 v250, v1, 3, s22
s_add_u32 s22, s23, 3
s_and_b32 s22, s22, 3
s_add_u32 s22, s22, s20
s_mul_i32 s22, s22, 55296
s_add_u32 s22, s22, s21
v_add_u32 v243, s22, v2
v_lshl_add_u32 v251, v1, 3, s22
s_cmp_eq_u32 s3, 3
s_mov_b32 s47, 12288
s_cselect_b32 s47, 0x40000000, s47
s_add_u32 s16, s4, 0x1000000
s_addc_u32 s17, s5, 0
wu_58:
s_cbranch_execz wu_ret2
s_mov_b32 s18, 0x6c0000
s_mov_b32 s19, 0x20000
s_add_u32 s24, s4, 0xa00000
s_addc_u32 s25, s5, 0
s_mov_b32 s26, 0x280000
s_mov_b32 s27, 0x20000
s_mov_b32 s28, s4
s_mov_b32 s29, s5
s_mov_b32 s30, 0x3c00
s_mov_b32 s31, 0x20000
s_mov_b32 s36, s8
s_mov_b32 s37, s9
s_mov_b32 s38, 0x280000
s_mov_b32 s39, 0x20000
v_and_b32 v3, 15, v1
s_lshl_b32 s21, s44, 6
s_lshl_b32 s22, s23, 4
s_add_u32 s21, s21, s22
v_add_u32 v3, s21, v3
v_lshrrev_b32 v4, 8, v3
v_bfe_u32 v5, v3, 3, 3
v_lshl_add_u32 v4, v4, 3, v5
v_bfe_u32 v5, v3, 6, 2
v_and_b32 v6, 7, v3
v_lshl_add_u32 v5, v5, 3, v6
v_lshl_add_u32 v4, v5, 6, v4
v_mul_u32_u24 v244, 1280, v4
v_lshrrev_b32 v5, 4, v1
s_mul_i32 s21, s45, 160
v_lshl_add_u32 v244, v5, 3, v244
v_add_u32 v244, s21, v244
s_mul_i32 s21, s45, 320
s_add_u32 s21, s21, 12800
v_lshlrev_b32 v245, 4, v5
v_add_u32 v245, s21, v245
s_movk_i32 s20, 4096
s_movk_i32 s21, 8192
s_waitcnt vmcnt(0)
rt_43:
buffer_load_dwordx4 v[88:91], v241, s[16:19], 0 offen offset:0 sc1
buffer_load_dwordx4 v[92:95], v241, s[16:19], 0 offen offset:1024 sc1
buffer_load_dwordx4 v[96:99], v241, s[16:19], 0 offen offset:2048 sc1
buffer_load_dwordx2 v[100:101], v249, s[16:19], 0 offen offset:3072 sc1
buffer_load_dwordx2 v[102:103], v249, s[16:19], 0 offen offset:3584 sc1
s_add_u32 s53, s53, 1
s_waitcnt vmcnt(0)
v_max3_u32 v252, v88, v89, v90
v_max3_u32 v252, v252, v91, v92
v_max3_u32 v252, v252, v93, v94
v_max3_u32 v252, v252, v95, v96
v_max3_u32 v252, v252, v97, v98
v_max3_u32 v252, v252, v99, v100
v_max3_u32 v252, v252, v101, v102
v_max_u32 v252, v252, v103
v_cmp_eq_u32 vcc, -1, v252
s_cmp_ge_u32 s53, 4000000
s_cbranch_scc1 rt_43_x
s_cbranch_vccnz rt_43
rt_43_x:
buffer_load_dwordx4 v[104:107], v241, s[16:19], s20 offen offset:0 sc1
buffer_load_dwordx4 v[108:111], v241, s[16:19], s20 offen offset:1024 sc1
buffer_load_dwordx4 v[112:115], v241, s[16:19], s20 offen offset:2048 sc1
buffer_load_dwordx4 v[116:119], v241, s[16:19], s20 offen offset:3072 sc1
buffer_load_dwordx4 v[120:123], v241, s[16:19], s21 offen offset:0 sc1
buffer_load_dwordx4 v[124:127], v241, s[16:19], s21 offen offset:1024 sc1
buffer_load_dwordx2 v[128:129], v249, s[16:19], s21 offen offset:2048 sc1
buffer_load_dwordx2 v[130:131], v249, s[16:19], s21 offen offset:2560 sc1
buffer_load_dwordx4 v[132:135], v241, s[16:19], s21 offen offset:3072 sc1
buffer_load_dwordx4 v[136:139], v241, s[16:19], s47 offen offset:0 sc1
buffer_load_dwordx4 v[140:143], v241, s[16:19], s47 offen offset:1024 sc1
buffer_load_dwordx4 v[144:147], v242, s[16:19], 0 offen offset:0 sc1
buffer_load_dwordx4 v[148:151], v242, s[16:19], 0 offen offset:1024 sc1
buffer_load_dwordx4 v[176:179], v242, s[16:19], 0 offen offset:2048 sc1
buffer_load_dwordx2 v[180:181], v250, s[16:19], 0 offen offset:3072 sc1
buffer_load_dwordx2 v[182:183], v250, s[16:19], 0 offen offset:3584 sc1
buffer_load_dwordx4 v[184:187], v242, s[16:19], s20 offen offset:0 sc1
buffer_load_dwordx4 v[188:191], v242, s[16:19], s20 offen offset:1024 sc1
buffer_load_dwordx4 v[192:195], v242, s[16:19], s20 offen offset:2048 sc1
wu_59:
s_cbranch_execz wu_ret2
buffer_load_dwordx4 v[196:199], v242, s[16:19], s20 offen offset:3072 sc1
buffer_load_dwordx4 v[200:203], v242, s[16:19], s21 offen offset:0 sc1
buffer_load_dwordx4 v[204:207], v242, s[16:19], s21 offen offset:1024 sc1
buffer_load_dwordx2 v[208:209], v250, s[16:19], s21 offen offset:2048 sc1
buffer_load_dwordx2 v[210:211], v250, s[16:19], s21 offen offset:2560 sc1
buffer_load_dwordx4 v[212:215], v242, s[16:19], s21 offen offset:3072 sc1
buffer_load_dwordx4 v[216:219], v242, s[16:19], s47 offen offset:0 sc1
buffer_load_dwordx4 v[220:223], v242, s[16:19], s47 offen offset:1024 sc1
buffer_load_dwordx4 v[224:227], v243, s[16:19], 0 offen offset:0 sc1
buffer_load_dwordx4 v[228:231], v243, s[16:19], 0 offen offset:1024 sc1
buffer_load_dwordx4 v[232:235], v243, s[16:19], 0 offen offset:2048 sc1
buffer_load_dwordx2 v[236:237], v251, s[16:19], 0 offen offset:3072 sc1
buffer_load_dwordx2 v[238:239], v251, s[16:19], 0 offen offset:3584 sc1
v_lshlrev_b32 v2, 4, v1
s_add_u32 s22, s3, 1
s_and_b32 s22, s22, 3
s_mul_i32 s22, s22, 15360
s_add_u32 s22, s22, 28672
v_add_u32 v253, s22, v2
s_add_u32 s22, s3, 2
s_and_b32 s22, s22, 3
s_mul_i32 s22, s22, 15360
s_add_u32 s22, s22, 33792
v_add_u32 v254, s22, v2
s_add_u32 s22, s3, 3
s_and_b32 s22, s22, 3
s_mul_i32 s22, s22, 15360
s_add_u32 s22, s22, 38912
v_add_u32 v255, s22, v2
s_mul_i32 s22, s3, 15360
s_add_u32 s22, s22, 28672
v_add_u32 v6, s22, v2
v_mfma_f32_16x16x32_bf16 v[28:31], a[0:3], v[88:91], 0
v_mfma_f32_16x16x32_bf16 v[32:35], a[4:7], v[88:91], 0
v_mfma_f32_16x16x32_bf16 v[36:39], a[8:11], v[88:91], 0
v_mfma_f32_16x16x32_bf16 v[40:43], a[12:15], v[88:91], 0
v_mfma_f32_16x16x32_bf16 v[44:47], a[16:19], v[88:91], 0
v_mfma_f32_16x16x32_bf16 v[28:31], a[20:23], v[92:95], v[28:31]
buffer_load_dwordx4 v[88:91], v243, s[16:19], s20 offen offset:0 sc1
v_mfma_f32_16x16x32_bf16 v[32:35], a[24:27], v[92:95], v[32:35]
v_mfma_f32_16x16x32_bf16 v[36:39], a[28:31], v[92:95], v[36:39]
v_mfma_f32_16x16x32_bf16 v[40:43], a[32:35], v[92:95], v[40:43]
v_mfma_f32_16x16x32_bf16 v[44:47], a[36:39], v[92:95], v[44:47]
s_waitcnt vmcnt(31)
v_mfma_f32_16x16x32_bf16 v[28:31], a[40:43], v[96:99], v[28:31]
buffer_load_dwordx4 v[92:95], v243, s[16:19], s20 offen offset:1024 sc1
v_mfma_f32_16x16x32_bf16 v[32:35], a[44:47], v[96:99], v[32:35]
v_max3_u32 v252, v104, v105, v106
v_mfma_f32_16x16x32_bf16 v[36:39], a[48:51], v[96:99], v[36:39]
v_max3_u32 v252, v252, v107, v108
v_mfma_f32_16x16x32_bf16 v[40:43], a[52:55], v[96:99], v[40:43]
v_max3_u32 v252, v252, v109, v110
v_mfma_f32_16x16x32_bf16 v[44:47], a[56:59], v[96:99], v[44:47]
v_max_u32 v252, v252, v111
v_mfma_f32_16x16x32_bf16 v[28:31], a[60:63], v[100:103], v[28:31]
buffer_load_dwordx4 v[96:99], v243, s[16:19], s20 offen offset:2048 sc1
v_mfma_f32_16x16x32_bf16 v[32:35], a[64:67], v[100:103], v[32:35]
v_cmp_eq_u32 vcc, -1, v252
v_mfma_f32_16x16x32_bf16 v[36:39], a[68:71], v[100:103], v[36:39]
s_cbranch_vccnz ex_44
ex_44_b:
v_mfma_f32_16x16x32_bf16 v[40:43], a[72:75], v[100:103], v[40:43]
v_mfma_f32_16x16x32_bf16 v[44:47], a[76:79], v[100:103], v[44:47]
s_waitcnt vmcnt(31)
v_mfma_f32_16x16x32_bf16 v[28:31], a[80:83], v[104:107], v[28:31]
buffer_load_dwordx4 v[100:103], v243, s[16:19], s20 offen offset:3072 sc1
v_mfma_f32_16x16x32_bf16 v[32:35], a[84:87], v[104:107], v[32:35]
v_max3_u32 v252, v112, v113, v114
v_mfma_f32_16x16x32_bf16 v[36:39], a[88:91], v[104:107], v[36:39]
v_max3_u32 v252, v252, v115, v116
v_mfma_f32_16x16x32_bf16 v[40:43], a[92:95], v[104:107], v[40:43]
v_max3_u32 v252, v252, v117, v118
v_mfma_f32_16x16x32_bf16 v[44:47], a[96:99], v[104:107], v[44:47]
wu_60:
s_cbranch_execz wu_ret2
v_max_u32 v252, v252, v119
v_mfma_f32_16x16x32_bf16 v[28:31], a[100:103], v[108:111], v[28:31]
buffer_load_dwordx4 v[104:107], v243, s[16:19], s21 offen offset:0 sc1
v_mfma_f32_16x16x32_bf16 v[32:35], a[104:107], v[108:111], v[32:35]
v_cmp_eq_u32 vcc, -1, v252
v_mfma_f32_16x16x32_bf16 v[36:39], a[108:111], v[108:111], v[36:39]
s_cbranch_vccnz ex_45
ex_45_b:
v_mfma_f32_16x16x32_bf16 v[40:43], a[112:115], v[108:111], v[40:43]
v_mfma_f32_16x16x32_bf16 v[44:47], a[116:119], v[108:111], v[44:47]
s_waitcnt vmcnt(31)
v_mfma_f32_16x16x32_bf16 v[28:31], a[120:123], v[112:115], v[28:31]
buffer_load_dwordx4 v[108:111], v243, s[16:19], s21 offen offset:1024 sc1
v_mfma_f32_16x16x32_bf16 v[32:35], a[124:127], v[112:115], v[32:35]
v_max3_u32 v252, v120, v121, v122
v_mfma_f32_16x16x32_bf16 v[36:39], a[128:131], v[112:115], v[36:39]
v_max3_u32 v252, v252, v123, v124
v_mfma_f32_16x16x32_bf16 v[40:43], a[132:135], v[112:115], v[40:43]
v_max3_u32 v252, v252, v125, v126
v_mfma_f32_16x16x32_bf16 v[44:47], a[136:139], v[112:115], v[44:47]
v_max_u32 v252, v252, v127
v_mfma_f32_16x16x32_bf16 v[28:31], a[140:143], v[116:119], v[28:31]
buffer_load_dwordx2 v[112:113], v251, s[16:19], s21 offen offset:2048 sc1
buffer_load_dwordx2 v[114:115], v251, s[16:19], s21 offen offset:2560 sc1
v_mfma_f32_16x16x32_bf16 v[32:35], a[144:147], v[116:119], v[32:35]
v_cmp_eq_u32 vcc, -1, v252
v_mfma_f32_16x16x32_bf16 v[36:39], a[148:151], v[116:119], v[36:39]
s_cbranch_vccnz ex_46
ex_46_b:
v_mfma_f32_16x16x32_bf16 v[40:43], a[152:155], v[116:119], v[40:43]
v_mfma_f32_16x16x32_bf16 v[44:47], a[156:159], v[116:119], v[44:47]
s_waitcnt vmcnt(31)
v_mfma_f32_16x16x32_bf16 v[28:31], a[160:163], v[120:123], v[28:31]
buffer_load_dwordx4 v[116:119], v243, s[16:19], s21 offen offset:3072 sc1
v_mfma_f32_16x16x32_bf16 v[32:35], a[164:167], v[120:123], v[32:35]
v_max3_u32 v252, v128, v129, v130
v_mfma_f32_16x16x32_bf16 v[36:39], a[168:171], v[120:123], v[36:39]
v_max3_u32 v252, v252, v131, v132
v_mfma_f32_16x16x32_bf16 v[40:43], a[172:175], v[120:123], v[40:43]
v_max3_u32 v252, v252, v133, v134
v_mfma_f32_16x16x32_bf16 v[44:47], a[176:179], v[120:123], v[44:47]
v_max_u32 v252, v252, v135
v_mfma_f32_16x16x32_bf16 v[28:31], a[180:183], v[124:127], v[28:31]
buffer_load_dwordx4 v[120:123], v243, s[16:19], s47 offen offset:0 sc1
v_mfma_f32_16x16x32_bf16 v[32:35], a[184:187], v[124:127], v[32:35]
v_cmp_eq_u32 vcc, -1, v252
v_mfma_f32_16x16x32_bf16 v[36:39], a[188:191], v[124:127], v[36:39]
s_cbranch_vccnz ex_47
ex_47_b:
v_mfma_f32_16x16x32_bf16 v[40:43], a[192:195], v[124:127], v[40:43]
v_mfma_f32_16x16x32_bf16 v[44:47], a[196:199], v[124:127], v[44:47]
s_waitcnt vmcnt(31)
v_mfma_f32_16x16x32_bf16 v[28:31], a[200:203], v[128:131], v[28:31]
buffer_load_dwordx4 v[124:127], v243, s[16:19], s47 offen offset:1024 sc1
v_mfma_f32_16x16x32_bf16 v[32:35], a[204:207], v[128:131], v[32:35]
v_max3_u32 v252, v136, v137, v138
v_mfma_f32_16x16x32_bf16 v[36:39], a[208:211], v[128:131], v[36:39]
v_max3_u32 v252, v252, v139, v140
v_mfma_f32_16x16x32_bf16 v[40:43], a[212:215], v[128:131], v[40:43]
v_max3_u32 v252, v252, v141, v142
v_mfma_f32_16x16x32_bf16 v[44:47], a[216:219], v[128:131], v[44:47]
v_max_u32 v252, v252, v143
v_mfma_f32_16x16x32_bf16 v[28:31], a[220:223], v[132:135], v[28:31]
buffer_load_dwordx4 v[128:131], v240, s[16:19], 0 offen offset:0 sc1
v_mfma_f32_16x16x32_bf16 v[32:35], a[224:227], v[132:135], v[32:35]
v_cmp_eq_u32 vcc, -1, v252
v_mfma_f32_16x16x32_bf16 v[36:39], a[228:231], v[132:135], v[36:39]
s_cbranch_vccnz ex_48
ex_48_b:
v_mfma_f32_16x16x32_bf16 v[40:43], a[232:235], v[132:135], v[40:43]
v_mfma_f32_16x16x32_bf16 v[44:47], a[236:239], v[132:135], v[44:47]
s_waitcnt vmcnt(31)
v_mfma_f32_16x16x32_bf16 v[28:31], a[240:243], v[136:139], v[28:31]
buffer_load_dwordx4 v[132:135], v240, s[16:19], 0 offen offset:1024 sc1
v_mfma_f32_16x16x32_bf16 v[32:35], a[244:247], v[136:139], v[32:35]
wu_61:
s_cbranch_execz wu_ret2
v_max3_u32 v252, v144, v145, v146
v_mfma_f32_16x16x32_bf16 v[36:39], a[248:251], v[136:139], v[36:39]
v_max3_u32 v252, v252, v147, v148
v_mfma_f32_16x16x32_bf16 v[40:43], a[252:255], v[136:139], v[40:43]
v_max3_u32 v252, v252, v149, v150
v_mfma_f32_16x16x32_bf16 v[44:47], v[152:155], v[136:139], v[44:47]
v_max_u32 v252, v252, v151
v_mfma_f32_16x16x32_bf16 v[28:31], v[156:159], v[140:143], v[28:31]
buffer_load_dwordx4 v[136:139], v240, s[16:19], 0 offen offset:2048 sc1
v_mfma_f32_16x16x32_bf16 v[32:35], v[160:163], v[140:143], v[32:35]
v_cmp_eq_u32 vcc, -1, v252
v_mfma_f32_16x16x32_bf16 v[36:39], v[164:167], v[140:143], v[36:39]
s_cbranch_vccnz ex_49
ex_49_b:
v_mfma_f32_16x16x32_bf16 v[40:43], v[168:171], v[140:143], v[40:43]
v_mfma_f32_16x16x32_bf16 v[44:47], v[172:175], v[140:143], v[44:47]
s_waitcnt vmcnt(30)
v_mfma_f32_16x16x32_bf16 v[48:51], a[0:3], v[144:147], 0
buffer_load_dwordx2 v[140:141], v248, s[16:19], 0 offen offset:3072 sc1
buffer_load_dwordx2 v[142:143], v248, s[16:19], 0 offen offset:3584 sc1
v_mfma_f32_16x16x32_bf16 v[52:55], a[4:7], v[144:147], 0
v_max3_u32 v252, v176, v177, v178
v_mfma_f32_16x16x32_bf16 v[56:59], a[8:11], v[144:147], 0
v_max3_u32 v252, v252, v179, v180
v_mfma_f32_16x16x32_bf16 v[60:63], a[12:15], v[144:147], 0
v_max3_u32 v252, v252, v181, v182
v_mfma_f32_16x16x32_bf16 v[64:67], a[16:19], v[144:147], 0
v_max_u32 v252, v252, v183
v_mfma_f32_16x16x32_bf16 v[48:51], a[20:23], v[148:151], v[48:51]
buffer_load_dwordx4 v[144:147], v240, s[16:19], s20 offen offset:0 sc1
v_mfma_f32_16x16x32_bf16 v[52:55], a[24:27], v[148:151], v[52:55]
v_cmp_eq_u32 vcc, -1, v252
v_mfma_f32_16x16x32_bf16 v[56:59], a[28:31], v[148:151], v[56:59]
s_cbranch_vccnz ex_50
ex_50_b:
v_mfma_f32_16x16x32_bf16 v[60:63], a[32:35], v[148:151], v[60:63]
ds_write_b128 v253, v[28:31] offset:0
v_mfma_f32_16x16x32_bf16 v[64:67], a[36:39], v[148:151], v[64:67]
ds_write_b128 v253, v[32:35] offset:1024
s_waitcnt vmcnt(31)
v_mfma_f32_16x16x32_bf16 v[48:51], a[40:43], v[176:179], v[48:51]
buffer_load_dwordx4 v[148:151], v240, s[16:19], s20 offen offset:1024 sc1
v_mfma_f32_16x16x32_bf16 v[52:55], a[44:47], v[176:179], v[52:55]
v_max3_u32 v252, v184, v185, v186
v_mfma_f32_16x16x32_bf16 v[56:59], a[48:51], v[176:179], v[56:59]
v_max3_u32 v252, v252, v187, v188
v_mfma_f32_16x16x32_bf16 v[60:63], a[52:55], v[176:179], v[60:63]
v_max3_u32 v252, v252, v189, v190
v_mfma_f32_16x16x32_bf16 v[64:67], a[56:59], v[176:179], v[64:67]
v_max_u32 v252, v252, v191
v_mfma_f32_16x16x32_bf16 v[48:51], a[60:63], v[180:183], v[48:51]
buffer_load_dwordx4 v[176:179], v240, s[16:19], s20 offen offset:2048 sc1
v_mfma_f32_16x16x32_bf16 v[52:55], a[64:67], v[180:183], v[52:55]
v_cmp_eq_u32 vcc, -1, v252
v_mfma_f32_16x16x32_bf16 v[56:59], a[68:71], v[180:183], v[56:59]
s_cbranch_vccnz ex_51
ex_51_b:
v_mfma_f32_16x16x32_bf16 v[60:63], a[72:75], v[180:183], v[60:63]
ds_write_b128 v253, v[36:39] offset:2048
v_mfma_f32_16x16x32_bf16 v[64:67], a[76:79], v[180:183], v[64:67]
ds_write_b128 v253, v[40:43] offset:3072
s_waitcnt vmcnt(31)
v_mfma_f32_16x16x32_bf16 v[48:51], a[80:83], v[184:187], v[48:51]
buffer_load_dwordx4 v[180:183], v240, s[16:19], s20 offen offset:3072 sc1
v_mfma_f32_16x16x32_bf16 v[52:55], a[84:87], v[184:187], v[52:55]
v_max3_u32 v252, v192, v193, v194
v_mfma_f32_16x16x32_bf16 v[56:59], a[88:91], v[184:187], v[56:59]
v_max3_u32 v252, v252, v195, v196
v_mfma_f32_16x16x32_bf16 v[60:63], a[92:95], v[184:187], v[60:63]
v_max3_u32 v252, v252, v197, v198
v_mfma_f32_16x16x32_bf16 v[64:67], a[96:99], v[184:187], v[64:67]
v_max_u32 v252, v252, v199
v_mfma_f32_16x16x32_bf16 v[48:51], a[100:103], v[188:191], v[48:51]
wu_62:
s_cbranch_execz wu_ret2
buffer_load_dwordx4 v[184:187], v240, s[16:19], s21 offen offset:0 sc1
v_mfma_f32_16x16x32_bf16 v[52:55], a[104:107], v[188:191], v[52:55]
v_cmp_eq_u32 vcc, -1, v252
v_mfma_f32_16x16x32_bf16 v[56:59], a[108:111], v[188:191], v[56:59]
s_cbranch_vccnz ex_52
ex_52_b:
v_mfma_f32_16x16x32_bf16 v[60:63], a[112:115], v[188:191], v[60:63]
ds_write_b128 v253, v[44:47] offset:4096
v_mfma_f32_16x16x32_bf16 v[64:67], a[116:119], v[188:191], v[64:67]
s_waitcnt vmcnt(31)
v_mfma_f32_16x16x32_bf16 v[48:51], a[120:123], v[192:195], v[48:51]
buffer_load_dwordx4 v[188:191], v240, s[16:19], s21 offen offset:1024 sc1
v_mfma_f32_16x16x32_bf16 v[52:55], a[124:127], v[192:195], v[52:55]
v_max3_u32 v252, v200, v201, v202
v_mfma_f32_16x16x32_bf16 v[56:59], a[128:131], v[192:195], v[56:59]
v_max3_u32 v252, v252, v203, v204
v_mfma_f32_16x16x32_bf16 v[60:63], a[132:135], v[192:195], v[60:63]
v_max3_u32 v252, v252, v205, v206
v_mfma_f32_16x16x32_bf16 v[64:67], a[136:139], v[192:195], v[64:67]
v_max_u32 v252, v252, v207
v_mfma_f32_16x16x32_bf16 v[48:51], a[140:143], v[196:199], v[48:51]
buffer_load_dwordx2 v[192:193], v248, s[16:19], s21 offen offset:2048 sc1
buffer_load_dwordx2 v[194:195], v248, s[16:19], s21 offen offset:2560 sc1
v_mfma_f32_16x16x32_bf16 v[52:55], a[144:147], v[196:199], v[52:55]
v_cmp_eq_u32 vcc, -1, v252
v_mfma_f32_16x16x32_bf16 v[56:59], a[148:151], v[196:199], v[56:59]
s_cbranch_vccnz ex_53
ex_53_b:
v_mfma_f32_16x16x32_bf16 v[60:63], a[152:155], v[196:199], v[60:63]
v_mfma_f32_16x16x32_bf16 v[64:67], a[156:159], v[196:199], v[64:67]
s_waitcnt vmcnt(31)
v_mfma_f32_16x16x32_bf16 v[48:51], a[160:163], v[200:203], v[48:51]
buffer_load_dwordx4 v[196:199], v240, s[16:19], s21 offen offset:3072 sc1
v_mfma_f32_16x16x32_bf16 v[52:55], a[164:167], v[200:203], v[52:55]
v_max3_u32 v252, v208, v209, v210
v_mfma_f32_16x16x32_bf16 v[56:59], a[168:171], v[200:203], v[56:59]
v_max3_u32 v252, v252, v211, v212
v_mfma_f32_16x16x32_bf16 v[60:63], a[172:175], v[200:203], v[60:63]
v_max3_u32 v252, v252, v213, v214
v_mfma_f32_16x16x32_bf16 v[64:67], a[176:179], v[200:203], v[64:67]
v_max_u32 v252, v252, v215
v_mfma_f32_16x16x32_bf16 v[48:51], a[180:183], v[204:207], v[48:51]
buffer_load_dwordx4 v[200:203], v240, s[16:19], s47 offen offset:0 sc1
v_mfma_f32_16x16x32_bf16 v[52:55], a[184:187], v[204:207], v[52:55]
v_cmp_eq_u32 vcc, -1, v252
v_mfma_f32_16x16x32_bf16 v[56:59], a[188:191], v[204:207], v[56:59]
s_cbranch_vccnz ex_54
ex_54_b:
v_mfma_f32_16x16x32_bf16 v[60:63], a[192:195], v[204:207], v[60:63]
v_mfma_f32_16x16x32_bf16 v[64:67], a[196:199], v[204:207], v[64:67]
s_waitcnt vmcnt(31)
v_mfma_f32_16x16x32_bf16 v[48:51], a[200:203], v[208:211], v[48:51]
buffer_load_dwordx4 v[204:207], v240, s[16:19], s47 offen offset:1024 sc1
v_mfma_f32_16x16x32_bf16 v[52:55], a[204:207], v[208:211], v[52:55]
v_max3_u32 v252, v216, v217, v218
v_mfma_f32_16x16x32_bf16 v[56:59], a[208:211], v[208:211], v[56:59]
v_max3_u32 v252, v252, v219, v220
v_mfma_f32_16x16x32_bf16 v[60:63], a[212:215], v[208:211], v[60:63]
v_max3_u32 v252, v252, v221, v222
v_mfma_f32_16x16x32_bf16 v[64:67], a[216:219], v[208:211], v[64:67]
v_max_u32 v252, v252, v223
v_mfma_f32_16x16x32_bf16 v[48:51], a[220:223], v[212:215], v[48:51]
v_cmp_eq_u32 vcc, -1, v252
v_mfma_f32_16x16x32_bf16 v[52:55], a[224:227], v[212:215], v[52:55]
s_cbranch_vccnz ex_55
ex_55_b:
v_mfma_f32_16x16x32_bf16 v[56:59], a[228:231], v[212:215], v[56:59]
v_mfma_f32_16x16x32_bf16 v[60:63], a[232:235], v[212:215], v[60:63]
v_mfma_f32_16x16x32_bf16 v[64:67], a[236:239], v[212:215], v[64:67]
s_waitcnt vmcnt(30)
v_mfma_f32_16x16x32_bf16 v[48:51], a[240:243], v[216:219], v[48:51]
v_max3_u32 v252, v224, v225, v226
v_mfma_f32_16x16x32_bf16 v[52:55], a[244:247], v[216:219], v[52:55]
v_max3_u32 v252, v252, v227, v228
v_mfma_f32_16x16x32_bf16 v[56:59], a[248:251], v[216:219], v[56:59]
wu_63:
s_cbranch_execz wu_ret2
v_max3_u32 v252, v252, v229, v230
v_mfma_f32_16x16x32_bf16 v[60:63], a[252:255], v[216:219], v[60:63]
v_max_u32 v252, v252, v231
v_mfma_f32_16x16x32_bf16 v[64:67], v[152:155], v[216:219], v[64:67]
v_cmp_eq_u32 vcc, -1, v252
v_mfma_f32_16x16x32_bf16 v[48:51], v[156:159], v[220:223], v[48:51]
s_cbranch_vccnz ex_56
ex_56_b:
v_mfma_f32_16x16x32_bf16 v[52:55], v[160:163], v[220:223], v[52:55]
v_mfma_f32_16x16x32_bf16 v[56:59], v[164:167], v[220:223], v[56:59]
v_mfma_f32_16x16x32_bf16 v[60:63], v[168:171], v[220:223], v[60:63]
v_mfma_f32_16x16x32_bf16 v[64:67], v[172:175], v[220:223], v[64:67]
s_waitcnt vmcnt(27)
v_mfma_f32_16x16x32_bf16 v[68:71], a[0:3], v[224:227], 0
v_max3_u32 v252, v232, v233, v234
v_mfma_f32_16x16x32_bf16 v[72:75], a[4:7], v[224:227], 0
v_max3_u32 v252, v252, v235, v236
v_mfma_f32_16x16x32_bf16 v[76:79], a[8:11], v[224:227], 0
v_max3_u32 v252, v252, v237, v238
v_mfma_f32_16x16x32_bf16 v[80:83], a[12:15], v[224:227], 0
v_max_u32 v252, v252, v239
v_mfma_f32_16x16x32_bf16 v[84:87], a[16:19], v[224:227], 0
v_cmp_eq_u32 vcc, -1, v252
v_mfma_f32_16x16x32_bf16 v[68:71], a[20:23], v[228:231], v[68:71]
s_cbranch_vccnz ex_57
ex_57_b:
v_mfma_f32_16x16x32_bf16 v[72:75], a[24:27], v[228:231], v[72:75]
ds_write_b128 v254, v[48:51] offset:0
v_mfma_f32_16x16x32_bf16 v[76:79], a[28:31], v[228:231], v[76:79]
ds_write_b128 v254, v[52:55] offset:1024
v_mfma_f32_16x16x32_bf16 v[80:83], a[32:35], v[228:231], v[80:83]
ds_write_b128 v254, v[56:59] offset:2048
v_mfma_f32_16x16x32_bf16 v[84:87], a[36:39], v[228:231], v[84:87]
ds_write_b128 v254, v[60:63] offset:3072
s_waitcnt vmcnt(25)
v_mfma_f32_16x16x32_bf16 v[68:71], a[40:43], v[232:235], v[68:71]
v_max3_u32 v252, v88, v89, v90
v_mfma_f32_16x16x32_bf16 v[72:75], a[44:47], v[232:235], v[72:75]
v_max3_u32 v252, v252, v91, v92
v_mfma_f32_16x16x32_bf16 v[76:79], a[48:51], v[232:235], v[76:79]
v_max3_u32 v252, v252, v93, v94
v_mfma_f32_16x16x32_bf16 v[80:83], a[52:55], v[232:235], v[80:83]
v_max_u32 v252, v252, v95
v_mfma_f32_16x16x32_bf16 v[84:87], a[56:59], v[232:235], v[84:87]
v_cmp_eq_u32 vcc, -1, v252
v_mfma_f32_16x16x32_bf16 v[68:71], a[60:63], v[236:239], v[68:71]
s_cbranch_vccnz ex_58
ex_58_b:
v_mfma_f32_16x16x32_bf16 v[72:75], a[64:67], v[236:239], v[72:75]
ds_write_b128 v254, v[64:67] offset:4096
v_mfma_f32_16x16x32_bf16 v[76:79], a[68:71], v[236:239], v[76:79]
v_mfma_f32_16x16x32_bf16 v[80:83], a[72:75], v[236:239], v[80:83]
v_mfma_f32_16x16x32_bf16 v[84:87], a[76:79], v[236:239], v[84:87]
s_waitcnt vmcnt(23)
v_mfma_f32_16x16x32_bf16 v[68:71], a[80:83], v[88:91], v[68:71]
buffer_load_dwordx2 v[208:209], v244, s[24:27], 0 offen offset:0 sc1
v_mfma_f32_16x16x32_bf16 v[72:75], a[84:87], v[88:91], v[72:75]
v_max3_u32 v252, v96, v97, v98
v_mfma_f32_16x16x32_bf16 v[76:79], a[88:91], v[88:91], v[76:79]
buffer_load_dwordx4 v[220:223], v245, s[28:31], 0 offen offset:0 sc1
v_mfma_f32_16x16x32_bf16 v[80:83], a[92:95], v[88:91], v[80:83]
v_max3_u32 v252, v252, v99, v100
v_mfma_f32_16x16x32_bf16 v[84:87], a[96:99], v[88:91], v[84:87]
v_max3_u32 v252, v252, v101, v102
v_mfma_f32_16x16x32_bf16 v[68:71], a[100:103], v[92:95], v[68:71]
buffer_load_dwordx2 v[210:211], v244, s[24:27], 0 offen offset:32 sc1
v_mfma_f32_16x16x32_bf16 v[72:75], a[104:107], v[92:95], v[72:75]
v_max_u32 v252, v252, v103
v_mfma_f32_16x16x32_bf16 v[76:79], a[108:111], v[92:95], v[76:79]
buffer_load_dwordx4 v[224:227], v245, s[28:31], 0 offen offset:64 sc1
v_mfma_f32_16x16x32_bf16 v[80:83], a[112:115], v[92:95], v[80:83]
v_cmp_eq_u32 vcc, -1, v252
v_mfma_f32_16x16x32_bf16 v[84:87], a[116:119], v[92:95], v[84:87]
s_cbranch_vccnz ex_59
ex_59_b:
wu_64:
s_cbranch_execz wu_ret2
s_waitcnt vmcnt(25)
v_mfma_f32_16x16x32_bf16 v[68:71], a[120:123], v[96:99], v[68:71]
buffer_load_dwordx2 v[212:213], v244, s[24:27], 0 offen offset:64 sc1
v_mfma_f32_16x16x32_bf16 v[72:75], a[124:127], v[96:99], v[72:75]
v_max3_u32 v252, v104, v105, v106
v_mfma_f32_16x16x32_bf16 v[76:79], a[128:131], v[96:99], v[76:79]
buffer_load_dwordx4 v[228:231], v245, s[28:31], 0 offen offset:128 sc1
v_mfma_f32_16x16x32_bf16 v[80:83], a[132:135], v[96:99], v[80:83]
v_max3_u32 v252, v252, v107, v108
v_mfma_f32_16x16x32_bf16 v[84:87], a[136:139], v[96:99], v[84:87]
v_max3_u32 v252, v252, v109, v110
v_mfma_f32_16x16x32_bf16 v[68:71], a[140:143], v[100:103], v[68:71]
buffer_load_dwordx2 v[214:215], v244, s[24:27], 0 offen offset:96 sc1
v_mfma_f32_16x16x32_bf16 v[72:75], a[144:147], v[100:103], v[72:75]
v_max_u32 v252, v252, v111
v_mfma_f32_16x16x32_bf16 v[76:79], a[148:151], v[100:103], v[76:79]
buffer_load_dwordx4 v[232:235], v245, s[28:31], 0 offen offset:192 sc1
v_mfma_f32_16x16x32_bf16 v[80:83], a[152:155], v[100:103], v[80:83]
v_cmp_eq_u32 vcc, -1, v252
v_mfma_f32_16x16x32_bf16 v[84:87], a[156:159], v[100:103], v[84:87]
s_cbranch_vccnz ex_60
ex_60_b:
s_waitcnt vmcnt(26)
v_mfma_f32_16x16x32_bf16 v[68:71], a[160:163], v[104:107], v[68:71]
buffer_load_dwordx2 v[216:217], v244, s[24:27], 0 offen offset:128 sc1
v_mfma_f32_16x16x32_bf16 v[72:75], a[164:167], v[104:107], v[72:75]
v_max3_u32 v252, v112, v113, v114
v_mfma_f32_16x16x32_bf16 v[76:79], a[168:171], v[104:107], v[76:79]
buffer_load_dwordx4 v[236:239], v245, s[28:31], 0 offen offset:256 sc1
v_mfma_f32_16x16x32_bf16 v[80:83], a[172:175], v[104:107], v[80:83]
v_max3_u32 v252, v252, v115, v116
v_mfma_f32_16x16x32_bf16 v[84:87], a[176:179], v[104:107], v[84:87]
v_max3_u32 v252, v252, v117, v118
v_mfma_f32_16x16x32_bf16 v[68:71], a[180:183], v[108:111], v[68:71]
v_max_u32 v252, v252, v119
v_mfma_f32_16x16x32_bf16 v[72:75], a[184:187], v[108:111], v[72:75]
v_cmp_eq_u32 vcc, -1, v252
v_mfma_f32_16x16x32_bf16 v[76:79], a[188:191], v[108:111], v[76:79]
s_cbranch_vccnz ex_61
ex_61_b:
v_mfma_f32_16x16x32_bf16 v[80:83], a[192:195], v[108:111], v[80:83]
v_mfma_f32_16x16x32_bf16 v[84:87], a[196:199], v[108:111], v[84:87]
s_waitcnt vmcnt(26)
v_mfma_f32_16x16x32_bf16 v[68:71], a[200:203], v[112:115], v[68:71]
v_max3_u32 v252, v120, v121, v122
v_mfma_f32_16x16x32_bf16 v[72:75], a[204:207], v[112:115], v[72:75]
v_max3_u32 v252, v252, v123, v124
v_mfma_f32_16x16x32_bf16 v[76:79], a[208:211], v[112:115], v[76:79]
v_max3_u32 v252, v252, v125, v126
v_mfma_f32_16x16x32_bf16 v[80:83], a[212:215], v[112:115], v[80:83]
v_max_u32 v252, v252, v127
v_mfma_f32_16x16x32_bf16 v[84:87], a[216:219], v[112:115], v[84:87]
v_cmp_eq_u32 vcc, -1, v252
v_mfma_f32_16x16x32_bf16 v[68:71], a[220:223], v[116:119], v[68:71]
s_cbranch_vccnz ex_62
ex_62_b:
v_mfma_f32_16x16x32_bf16 v[72:75], a[224:227], v[116:119], v[72:75]
v_mfma_f32_16x16x32_bf16 v[76:79], a[228:231], v[116:119], v[76:79]
v_mfma_f32_16x16x32_bf16 v[80:83], a[232:235], v[116:119], v[80:83]
v_mfma_f32_16x16x32_bf16 v[84:87], a[236:239], v[116:119], v[84:87]
s_waitcnt vmcnt(24)
v_mfma_f32_16x16x32_bf16 v[68:71], a[240:243], v[120:123], v[68:71]
v_max3_u32 v252, v128, v129, v130
v_mfma_f32_16x16x32_bf16 v[72:75], a[244:247], v[120:123], v[72:75]
v_max3_u32 v252, v252, v131, v132
v_mfma_f32_16x16x32_bf16 v[76:79], a[248:251], v[120:123], v[76:79]
v_max3_u32 v252, v252, v133, v134
v_mfma_f32_16x16x32_bf16 v[80:83], a[252:255], v[120:123], v[80:83]
v_max_u32 v252, v252, v135
v_mfma_f32_16x16x32_bf16 v[84:87], v[152:155], v[120:123], v[84:87]
v_cmp_eq_u32 vcc, -1, v252
v_mfma_f32_16x16x32_bf16 v[68:71], v[156:159], v[124:127], v[68:71]
s_cbranch_vccnz ex_63
ex_63_b:
v_mfma_f32_16x16x32_bf16 v[72:75], v[160:163], v[124:127], v[72:75]
v_mfma_f32_16x16x32_bf16 v[76:79], v[164:167], v[124:127], v[76:79]
wu_65:
s_cbranch_execz wu_ret2
v_mfma_f32_16x16x32_bf16 v[80:83], v[168:171], v[124:127], v[80:83]
v_mfma_f32_16x16x32_bf16 v[84:87], v[172:175], v[124:127], v[84:87]
s_waitcnt vmcnt(21)
v_mfma_f32_16x16x32_bf16 v[8:11], a[0:3], v[128:131], 0
v_max3_u32 v252, v136, v137, v138
v_mfma_f32_16x16x32_bf16 v[12:15], a[4:7], v[128:131], 0
v_max3_u32 v252, v252, v139, v140
v_mfma_f32_16x16x32_bf16 v[16:19], a[8:11], v[128:131], 0
v_max3_u32 v252, v252, v141, v142
v_mfma_f32_16x16x32_bf16 v[20:23], a[12:15], v[128:131], 0
v_max_u32 v252, v252, v143
v_mfma_f32_16x16x32_bf16 v[24:27], a[16:19], v[128:131], 0
v_cmp_eq_u32 vcc, -1, v252
v_mfma_f32_16x16x32_bf16 v[8:11], a[20:23], v[132:135], v[8:11]
s_cbranch_vccnz ex_64
ex_64_b:
v_mfma_f32_16x16x32_bf16 v[12:15], a[24:27], v[132:135], v[12:15]
ds_write_b128 v255, v[68:71] offset:0
v_mfma_f32_16x16x32_bf16 v[16:19], a[28:31], v[132:135], v[16:19]
ds_write_b128 v255, v[72:75] offset:1024
v_mfma_f32_16x16x32_bf16 v[20:23], a[32:35], v[132:135], v[20:23]
ds_write_b128 v255, v[76:79] offset:2048
v_mfma_f32_16x16x32_bf16 v[24:27], a[36:39], v[132:135], v[24:27]
ds_write_b128 v255, v[80:83] offset:3072
ds_write_b128 v255, v[84:87] offset:4096
s_waitcnt vmcnt(19)
s_waitcnt lgkmcnt(0)
s_barrier
v_mfma_f32_16x16x32_bf16 v[8:11], a[40:43], v[136:139], v[8:11]
v_max3_u32 v252, v144, v145, v146
v_max3_u32 v252, v252, v147, v148
v_mfma_f32_16x16x32_bf16 v[12:15], a[44:47], v[136:139], v[12:15]
v_max3_u32 v252, v252, v149, v150
v_max_u32 v252, v252, v151
v_mfma_f32_16x16x32_bf16 v[16:19], a[48:51], v[136:139], v[16:19]
v_cmp_eq_u32 vcc, -1, v252
s_cbranch_vccnz ex_65
ex_65_b:
v_mfma_f32_16x16x32_bf16 v[20:23], a[52:55], v[136:139], v[20:23]
ds_read_b128 v[28:31], v6 offset:0
ds_read_b128 v[32:35], v6 offset:1024
v_mfma_f32_16x16x32_bf16 v[24:27], a[56:59], v[136:139], v[24:27]
ds_read_b128 v[36:39], v6 offset:2048
ds_read_b128 v[40:43], v6 offset:3072
v_mfma_f32_16x16x32_bf16 v[8:11], a[60:63], v[140:143], v[8:11]
ds_read_b128 v[44:47], v6 offset:4096
ds_read_b128 v[48:51], v6 offset:5120
v_mfma_f32_16x16x32_bf16 v[12:15], a[64:67], v[140:143], v[12:15]
ds_read_b128 v[52:55], v6 offset:6144
ds_read_b128 v[56:59], v6 offset:7168
v_mfma_f32_16x16x32_bf16 v[16:19], a[68:71], v[140:143], v[16:19]
ds_read_b128 v[60:63], v6 offset:8192
ds_read_b128 v[64:67], v6 offset:9216
v_mfma_f32_16x16x32_bf16 v[20:23], a[72:75], v[140:143], v[20:23]
ds_read_b128 v[68:71], v6 offset:10240
ds_read_b128 v[72:75], v6 offset:11264
v_mfma_f32_16x16x32_bf16 v[24:27], a[76:79], v[140:143], v[24:27]
ds_read_b128 v[76:79], v6 offset:12288
ds_read_b128 v[80:83], v6 offset:13312
s_waitcnt vmcnt(17)
v_mfma_f32_16x16x32_bf16 v[8:11], a[80:83], v[144:147], v[8:11]
v_max3_u32 v252, v176, v177, v178
v_max3_u32 v252, v252, v179, v180
v_mfma_f32_16x16x32_bf16 v[12:15], a[84:87], v[144:147], v[12:15]
v_max3_u32 v252, v252, v181, v182
v_max_u32 v252, v252, v183
v_mfma_f32_16x16x32_bf16 v[16:19], a[88:91], v[144:147], v[16:19]
v_cmp_eq_u32 vcc, -1, v252
s_cbranch_vccnz ex_66
ex_66_b:
v_mfma_f32_16x16x32_bf16 v[20:23], a[92:95], v[144:147], v[20:23]
ds_read_b128 v[84:87], v6 offset:14336
s_waitcnt lgkmcnt(5)
v_mfma_f32_16x16x32_bf16 v[24:27], a[96:99], v[144:147], v[24:27]
wu_66:
s_cbranch_execz wu_ret2
v_add_f32 v28, v28, v48
v_add_f32 v29, v29, v49
v_mfma_f32_16x16x32_bf16 v[8:11], a[100:103], v[148:151], v[8:11]
v_add_f32 v30, v30, v50
v_add_f32 v31, v31, v51
v_mfma_f32_16x16x32_bf16 v[12:15], a[104:107], v[148:151], v[12:15]
v_add_f32 v32, v32, v52
v_add_f32 v33, v33, v53
v_mfma_f32_16x16x32_bf16 v[16:19], a[108:111], v[148:151], v[16:19]
v_add_f32 v34, v34, v54
v_add_f32 v35, v35, v55
v_mfma_f32_16x16x32_bf16 v[20:23], a[112:115], v[148:151], v[20:23]
v_add_f32 v36, v36, v56
v_add_f32 v37, v37, v57
v_mfma_f32_16x16x32_bf16 v[24:27], a[116:119], v[148:151], v[24:27]
v_add_f32 v38, v38, v58
v_add_f32 v39, v39, v59
s_waitcnt vmcnt(15)
v_mfma_f32_16x16x32_bf16 v[8:11], a[120:123], v[176:179], v[8:11]
v_max3_u32 v252, v184, v185, v186
v_max3_u32 v252, v252, v187, v188
v_mfma_f32_16x16x32_bf16 v[12:15], a[124:127], v[176:179], v[12:15]
v_max3_u32 v252, v252, v189, v190
v_max_u32 v252, v252, v191
v_mfma_f32_16x16x32_bf16 v[16:19], a[128:131], v[176:179], v[16:19]
v_cmp_eq_u32 vcc, -1, v252
s_cbranch_vccnz ex_67
ex_67_b:
v_mfma_f32_16x16x32_bf16 v[20:23], a[132:135], v[176:179], v[20:23]
v_add_f32 v40, v40, v60
v_add_f32 v41, v41, v61
v_mfma_f32_16x16x32_bf16 v[24:27], a[136:139], v[176:179], v[24:27]
v_add_f32 v42, v42, v62
v_add_f32 v43, v43, v63
v_mfma_f32_16x16x32_bf16 v[8:11], a[140:143], v[180:183], v[8:11]
v_add_f32 v44, v44, v64
v_add_f32 v45, v45, v65
v_mfma_f32_16x16x32_bf16 v[12:15], a[144:147], v[180:183], v[12:15]
v_add_f32 v46, v46, v66
v_add_f32 v47, v47, v67
v_mfma_f32_16x16x32_bf16 v[16:19], a[148:151], v[180:183], v[16:19]
s_waitcnt lgkmcnt(0)
v_add_f32 v28, v28, v68
v_mfma_f32_16x16x32_bf16 v[20:23], a[152:155], v[180:183], v[20:23]
v_add_f32 v29, v29, v69
v_add_f32 v30, v30, v70
v_mfma_f32_16x16x32_bf16 v[24:27], a[156:159], v[180:183], v[24:27]
v_add_f32 v31, v31, v71
v_add_f32 v32, v32, v72
s_waitcnt vmcnt(12)
v_mfma_f32_16x16x32_bf16 v[8:11], a[160:163], v[184:187], v[8:11]
v_max3_u32 v252, v192, v193, v194
v_max3_u32 v252, v252, v195, v196
v_mfma_f32_16x16x32_bf16 v[12:15], a[164:167], v[184:187], v[12:15]
v_max3_u32 v252, v252, v197, v198
v_max_u32 v252, v252, v199
v_mfma_f32_16x16x32_bf16 v[16:19], a[168:171], v[184:187], v[16:19]
v_cmp_eq_u32 vcc, -1, v252
s_cbranch_vccnz ex_68
ex_68_b:
v_mfma_f32_16x16x32_bf16 v[20:23], a[172:175], v[184:187], v[20:23]
v_add_f32 v33, v33, v73
v_add_f32 v34, v34, v74
v_mfma_f32_16x16x32_bf16 v[24:27], a[176:179], v[184:187], v[24:27]
v_add_f32 v35, v35, v75
v_add_f32 v36, v36, v76
v_mfma_f32_16x16x32_bf16 v[8:11], a[180:183], v[188:191], v[8:11]
v_add_f32 v37, v37, v77
v_add_f32 v38, v38, v78
v_mfma_f32_16x16x32_bf16 v[12:15], a[184:187], v[188:191], v[12:15]
v_add_f32 v39, v39, v79
v_add_f32 v40, v40, v80
v_mfma_f32_16x16x32_bf16 v[16:19], a[188:191], v[188:191], v[16:19]
v_add_f32 v41, v41, v81
v_add_f32 v42, v42, v82
v_mfma_f32_16x16x32_bf16 v[20:23], a[192:195], v[188:191], v[20:23]
v_add_f32 v43, v43, v83
v_add_f32 v44, v44, v84
v_mfma_f32_16x16x32_bf16 v[24:27], a[196:199], v[188:191], v[24:27]
v_add_f32 v45, v45, v85
v_add_f32 v46, v46, v86
s_waitcnt vmcnt(10)
v_mfma_f32_16x16x32_bf16 v[8:11], a[200:203], v[192:195], v[8:11]
v_max3_u32 v252, v200, v201, v202
v_max3_u32 v252, v252, v203, v204
v_mfma_f32_16x16x32_bf16 v[12:15], a[204:207], v[192:195], v[12:15]
v_max3_u32 v252, v252, v205, v206
v_max_u32 v252, v252, v207
v_mfma_f32_16x16x32_bf16 v[16:19], a[208:211], v[192:195], v[16:19]
v_cmp_eq_u32 vcc, -1, v252
s_cbranch_vccnz ex_69
ex_69_b:
wu_67:
s_cbranch_execz wu_ret2
v_mfma_f32_16x16x32_bf16 v[20:23], a[212:215], v[192:195], v[20:23]
v_add_f32 v47, v47, v87
v_mfma_f32_16x16x32_bf16 v[24:27], a[216:219], v[192:195], v[24:27]
v_mfma_f32_16x16x32_bf16 v[8:11], a[220:223], v[196:199], v[8:11]
v_mfma_f32_16x16x32_bf16 v[12:15], a[224:227], v[196:199], v[12:15]
v_mfma_f32_16x16x32_bf16 v[16:19], a[228:231], v[196:199], v[16:19]
v_mfma_f32_16x16x32_bf16 v[20:23], a[232:235], v[196:199], v[20:23]
v_mfma_f32_16x16x32_bf16 v[24:27], a[236:239], v[196:199], v[24:27]
v_mfma_f32_16x16x32_bf16 v[8:11], a[240:243], v[200:203], v[8:11]
v_mfma_f32_16x16x32_bf16 v[12:15], a[244:247], v[200:203], v[12:15]
v_mfma_f32_16x16x32_bf16 v[16:19], a[248:251], v[200:203], v[16:19]
v_mfma_f32_16x16x32_bf16 v[20:23], a[252:255], v[200:203], v[20:23]
v_mfma_f32_16x16x32_bf16 v[24:27], v[152:155], v[200:203], v[24:27]
v_mfma_f32_16x16x32_bf16 v[8:11], v[156:159], v[204:207], v[8:11]
v_mfma_f32_16x16x32_bf16 v[12:15], v[160:163], v[204:207], v[12:15]
v_mfma_f32_16x16x32_bf16 v[16:19], v[164:167], v[204:207], v[16:19]
v_mfma_f32_16x16x32_bf16 v[20:23], v[168:171], v[204:207], v[20:23]
v_mfma_f32_16x16x32_bf16 v[24:27], v[172:175], v[204:207], v[24:27]
s_waitcnt vmcnt(0)
    s_nop 2
v_pk_add_f32 v[8:9], v[8:9], v[28:29]
v_lshlrev_b32 v4, 16, v208
v_and_b32 v5, 0xffff0000, v208
v_pk_fma_f32 v[4:5], v[220:221], v[8:9], v[4:5]
v_cvt_pk_bf16_f32 v88, v4, v5
v_pk_add_f32 v[10:11], v[10:11], v[30:31]
v_lshlrev_b32 v4, 16, v209
v_and_b32 v5, 0xffff0000, v209
v_pk_fma_f32 v[4:5], v[222:223], v[10:11], v[4:5]
v_cvt_pk_bf16_f32 v89, v4, v5
buffer_store_dwordx2 v[88:89], v244, s[36:39], 0 offen offset:0
v_pk_add_f32 v[12:13], v[12:13], v[32:33]
v_lshlrev_b32 v4, 16, v210
v_and_b32 v5, 0xffff0000, v210
v_pk_fma_f32 v[4:5], v[224:225], v[12:13], v[4:5]
v_cvt_pk_bf16_f32 v90, v4, v5
v_pk_add_f32 v[14:15], v[14:15], v[34:35]
v_lshlrev_b32 v4, 16, v211
v_and_b32 v5, 0xffff0000, v211
v_pk_fma_f32 v[4:5], v[226:227], v[14:15], v[4:5]
v_cvt_pk_bf16_f32 v91, v4, v5
buffer_store_dwordx2 v[90:91], v244, s[36:39], 0 offen offset:32
v_pk_add_f32 v[16:17], v[16:17], v[36:37]
v_lshlrev_b32 v4, 16, v212
v_and_b32 v5, 0xffff0000, v212
v_pk_fma_f32 v[4:5], v[228:229], v[16:17], v[4:5]
v_cvt_pk_bf16_f32 v92, v4, v5
v_pk_add_f32 v[18:19], v[18:19], v[38:39]
v_lshlrev_b32 v4, 16, v213
v_and_b32 v5, 0xffff0000, v213
v_pk_fma_f32 v[4:5], v[230:231], v[18:19], v[4:5]
v_cvt_pk_bf16_f32 v93, v4, v5
buffer_store_dwordx2 v[92:93], v244, s[36:39], 0 offen offset:64
v_pk_add_f32 v[20:21], v[20:21], v[40:41]
v_lshlrev_b32 v4, 16, v214
v_and_b32 v5, 0xffff0000, v214
v_pk_fma_f32 v[4:5], v[232:233], v[20:21], v[4:5]
v_cvt_pk_bf16_f32 v94, v4, v5
v_pk_add_f32 v[22:23], v[22:23], v[42:43]
v_lshlrev_b32 v4, 16, v215
v_and_b32 v5, 0xffff0000, v215
v_pk_fma_f32 v[4:5], v[234:235], v[22:23], v[4:5]
v_cvt_pk_bf16_f32 v95, v4, v5
buffer_store_dwordx2 v[94:95], v244, s[36:39], 0 offen offset:96
v_pk_add_f32 v[24:25], v[24:25], v[44:45]
v_lshlrev_b32 v4, 16, v216
v_and_b32 v5, 0xffff0000, v216
v_pk_fma_f32 v[4:5], v[236:237], v[24:25], v[4:5]
v_cvt_pk_bf16_f32 v96, v4, v5
v_pk_add_f32 v[26:27], v[26:27], v[46:47]
wu_68:
s_cbranch_execz wu_ret2
v_lshlrev_b32 v4, 16, v217
v_and_b32 v5, 0xffff0000, v217
v_pk_fma_f32 v[4:5], v[238:239], v[26:27], v[4:5]
v_cvt_pk_bf16_f32 v97, v4, v5
buffer_store_dwordx2 v[96:97], v244, s[36:39], 0 offen offset:128
s_or_b32 s50, s2, s3
s_cmp_lg_u32 s50, 0
s_cbranch_scc1 ep_70
s_add_u32 s16, s4, 0x80000
s_addc_u32 s17, s5, 0
s_mov_b32 s18, 0x80
s_mov_b32 s19, 0x20000
v_mov_b32 v4, 0
v_mov_b32 v5, s55
s_mov_b64 exec, 1
buffer_store_dword v5, v4, s[16:19], 0 offen sc0 sc1
s_mov_b64 exec, -1
ep_70:
all_end:
s_endpgm
fa_7:
rt_71:
buffer_load_dword v244, v247, s[12:15], 0 offen offset:0 sc1
s_add_u32 s53, s53, 1
s_waitcnt vmcnt(0)
v_cmp_ne_u32 vcc, s55, v244
s_cmp_ge_u32 s53, 4000000
s_cbranch_scc1 rt_71_x
s_cbranch_vccnz rt_71
rt_71_x:
s_branch fa_7_b
fw_20:
rt_72:
s_mov_b32 s26, 32768
buffer_load_dword v253, v252, s[12:15], s26 offen sc1
s_add_u32 s53, s53, 1
s_waitcnt vmcnt(0)
v_cmp_ne_u32 vcc, s55, v253
s_cmp_ge_u32 s53, 4000000
s_cbranch_scc1 rt_72_x
s_cbranch_vccnz rt_72
rt_72_x:
s_branch fw_20_b
fx_24:
rt_73:
s_movk_i32 s54, 3072
buffer_load_dwordx4 v[176:179], v237, s[16:19], s54 offen sc1
buffer_load_dwordx4 v[180:183], v238, s[16:19], s54 offen sc1
s_add_u32 s53, s53, 1
s_waitcnt vmcnt(0)
v_max3_u32 v239, v176, v177, v178
v_max3_u32 v239, v239, v179, v180
v_max3_u32 v239, v239, v181, v182
v_max_u32 v239, v239, v183
v_cmp_eq_u32 vcc, -1, v239
s_cmp_ge_u32 s53, 4000000
s_cbranch_scc1 rt_73_x
s_cbranch_vccnz rt_73
rt_73_x:
s_branch fx_24_b
fx_25:
rt_74:
s_movk_i32 s54, 4096
buffer_load_dwordx4 v[184:187], v237, s[16:19], s54 offen sc1
buffer_load_dwordx4 v[188:191], v238, s[16:19], s54 offen sc1
s_add_u32 s53, s53, 1
s_waitcnt vmcnt(0)
v_max3_u32 v239, v184, v185, v186
v_max3_u32 v239, v239, v187, v188
v_max3_u32 v239, v239, v189, v190
v_max_u32 v239, v239, v191
v_cmp_eq_u32 vcc, -1, v239
s_cmp_ge_u32 s53, 4000000
s_cbranch_scc1 rt_74_x
s_cbranch_vccnz rt_74
rt_74_x:
s_branch fx_25_b
fx_26:
rt_75:
s_movk_i32 s54, 5120
buffer_load_dwordx4 v[192:195], v237, s[16:19], s54 offen sc1
buffer_load_dwordx4 v[196:199], v238, s[16:19], s54 offen sc1
s_add_u32 s53, s53, 1
s_waitcnt vmcnt(0)
v_max3_u32 v239, v192, v193, v194
v_max3_u32 v239, v239, v195, v196
v_max3_u32 v239, v239, v197, v198
v_max_u32 v239, v239, v199
v_cmp_eq_u32 vcc, -1, v239
s_cmp_ge_u32 s53, 4000000
s_cbranch_scc1 rt_75_x
s_cbranch_vccnz rt_75
rt_75_x:
s_branch fx_26_b
fx_27:
rt_76:
s_movk_i32 s54, 6144
buffer_load_dwordx4 v[200:203], v237, s[16:19], s54 offen sc1
buffer_load_dwordx4 v[204:207], v238, s[16:19], s54 offen sc1
s_add_u32 s53, s53, 1
s_waitcnt vmcnt(0)
v_max3_u32 v239, v200, v201, v202
v_max3_u32 v239, v239, v203, v204
v_max3_u32 v239, v239, v205, v206
v_max_u32 v239, v239, v207
v_cmp_eq_u32 vcc, -1, v239
s_cmp_ge_u32 s53, 4000000
s_cbranch_scc1 rt_76_x
wu_69:
s_cbranch_execz wu_ret2
s_cbranch_vccnz rt_76
rt_76_x:
s_branch fx_27_b
fx_28:
rt_77:
s_movk_i32 s54, 7168
buffer_load_dwordx4 v[208:211], v237, s[16:19], s54 offen sc1
buffer_load_dwordx4 v[212:215], v238, s[16:19], s54 offen sc1
s_add_u32 s53, s53, 1
s_waitcnt vmcnt(0)
v_max3_u32 v239, v208, v209, v210
v_max3_u32 v239, v239, v211, v212
v_max3_u32 v239, v239, v213, v214
v_max_u32 v239, v239, v215
v_cmp_eq_u32 vcc, -1, v239
s_cmp_ge_u32 s53, 4000000
s_cbranch_scc1 rt_77_x
s_cbranch_vccnz rt_77
rt_77_x:
s_branch fx_28_b
fx_29:
rt_78:
s_movk_i32 s54, 8192
buffer_load_dwordx4 v[216:219], v237, s[16:19], s54 offen sc1
buffer_load_dwordx4 v[220:223], v238, s[16:19], s54 offen sc1
s_add_u32 s53, s53, 1
s_waitcnt vmcnt(0)
v_max3_u32 v239, v216, v217, v218
v_max3_u32 v239, v239, v219, v220
v_max3_u32 v239, v239, v221, v222
v_max_u32 v239, v239, v223
v_cmp_eq_u32 vcc, -1, v239
s_cmp_ge_u32 s53, 4000000
s_cbranch_scc1 rt_78_x
s_cbranch_vccnz rt_78
rt_78_x:
s_branch fx_29_b
fx_30:
rt_79:
s_movk_i32 s54, 9216
buffer_load_dwordx4 v[224:227], v237, s[16:19], s54 offen sc1
buffer_load_dwordx4 v[228:231], v238, s[16:19], s54 offen sc1
s_add_u32 s53, s53, 1
s_waitcnt vmcnt(0)
v_max3_u32 v239, v224, v225, v226
v_max3_u32 v239, v239, v227, v228
v_max3_u32 v239, v239, v229, v230
v_max_u32 v239, v239, v231
v_cmp_eq_u32 vcc, -1, v239
s_cmp_ge_u32 s53, 4000000
s_cbranch_scc1 rt_79_x
s_cbranch_vccnz rt_79
rt_79_x:
s_branch fx_30_b
fx_31:
rt_80:
s_movk_i32 s54, 10240
buffer_load_dwordx4 v[152:155], v237, s[16:19], s54 offen sc1
buffer_load_dwordx4 v[156:159], v238, s[16:19], s54 offen sc1
s_add_u32 s53, s53, 1
s_waitcnt vmcnt(0)
v_max3_u32 v239, v152, v153, v154
v_max3_u32 v239, v239, v155, v156
v_max3_u32 v239, v239, v157, v158
v_max_u32 v239, v239, v159
v_cmp_eq_u32 vcc, -1, v239
s_cmp_ge_u32 s53, 4000000
s_cbranch_scc1 rt_80_x
s_cbranch_vccnz rt_80
rt_80_x:
s_branch fx_31_b
fx_32:
rt_81:
s_movk_i32 s54, 11264
buffer_load_dwordx4 v[160:163], v237, s[16:19], s54 offen sc1
buffer_load_dwordx4 v[164:167], v238, s[16:19], s54 offen sc1
s_add_u32 s53, s53, 1
s_waitcnt vmcnt(0)
v_max3_u32 v239, v160, v161, v162
v_max3_u32 v239, v239, v163, v164
v_max3_u32 v239, v239, v165, v166
v_max_u32 v239, v239, v167
v_cmp_eq_u32 vcc, -1, v239
s_cmp_ge_u32 s53, 4000000
s_cbranch_scc1 rt_81_x
s_cbranch_vccnz rt_81
rt_81_x:
s_branch fx_32_b
fx_33:
rt_82:
s_movk_i32 s54, 12288
buffer_load_dwordx4 v[168:171], v237, s[16:19], s54 offen sc1
buffer_load_dwordx4 v[172:175], v238, s[16:19], s54 offen sc1
s_add_u32 s53, s53, 1
s_waitcnt vmcnt(0)
v_max3_u32 v239, v168, v169, v170
v_max3_u32 v239, v239, v171, v172
v_max3_u32 v239, v239, v173, v174
v_max_u32 v239, v239, v175
v_cmp_eq_u32 vcc, -1, v239
s_cmp_ge_u32 s53, 4000000
s_cbranch_scc1 rt_82_x
s_cbranch_vccnz rt_82
rt_82_x:
s_branch fx_33_b
fx_34:
rt_83:
s_movk_i32 s54, 13312
buffer_load_dwordx4 v[176:179], v237, s[16:19], s54 offen sc1
buffer_load_dwordx4 v[180:183], v238, s[16:19], s54 offen sc1
wu_70:
s_cbranch_execz wu_ret2
s_add_u32 s53, s53, 1
s_waitcnt vmcnt(0)
v_max3_u32 v239, v176, v177, v178
v_max3_u32 v239, v239, v179, v180
v_max3_u32 v239, v239, v181, v182
v_max_u32 v239, v239, v183
v_cmp_eq_u32 vcc, -1, v239
s_cmp_ge_u32 s53, 4000000
s_cbranch_scc1 rt_83_x
s_cbranch_vccnz rt_83
rt_83_x:
s_branch fx_34_b
fx_35:
rt_84:
s_movk_i32 s54, 14336
buffer_load_dwordx4 v[184:187], v237, s[16:19], s54 offen sc1
buffer_load_dwordx4 v[188:191], v238, s[16:19], s54 offen sc1
s_add_u32 s53, s53, 1
s_waitcnt vmcnt(0)
v_max3_u32 v239, v184, v185, v186
v_max3_u32 v239, v239, v187, v188
v_max3_u32 v239, v239, v189, v190
v_max_u32 v239, v239, v191
v_cmp_eq_u32 vcc, -1, v239
s_cmp_ge_u32 s53, 4000000
s_cbranch_scc1 rt_84_x
s_cbranch_vccnz rt_84
rt_84_x:
s_branch fx_35_b
fx_36:
rt_85:
s_movk_i32 s54, 17408
buffer_load_dwordx4 v[208:211], v237, s[16:19], s54 offen sc1
buffer_load_dwordx4 v[212:215], v238, s[16:19], s54 offen sc1
s_add_u32 s53, s53, 1
s_waitcnt vmcnt(0)
v_max3_u32 v239, v208, v209, v210
v_max3_u32 v239, v239, v211, v212
v_max3_u32 v239, v239, v213, v214
v_max_u32 v239, v239, v215
v_cmp_eq_u32 vcc, -1, v239
s_cmp_ge_u32 s53, 4000000
s_cbranch_scc1 rt_85_x
s_cbranch_vccnz rt_85
rt_85_x:
s_branch fx_36_b
fx_37:
rt_86:
s_movk_i32 s54, 15360
buffer_load_dwordx4 v[192:195], v237, s[16:19], s54 offen sc1
buffer_load_dwordx4 v[196:199], v238, s[16:19], s54 offen sc1
s_add_u32 s53, s53, 1
s_waitcnt vmcnt(0)
v_max3_u32 v239, v192, v193, v194
v_max3_u32 v239, v239, v195, v196
v_max3_u32 v239, v239, v197, v198
v_max_u32 v239, v239, v199
v_cmp_eq_u32 vcc, -1, v239
s_cmp_ge_u32 s53, 4000000
s_cbranch_scc1 rt_86_x
s_cbranch_vccnz rt_86
rt_86_x:
s_branch fx_37_b
fx_38:
rt_87:
s_movk_i32 s54, 18432
buffer_load_dwordx4 v[216:219], v237, s[16:19], s54 offen sc1
buffer_load_dwordx4 v[220:223], v238, s[16:19], s54 offen sc1
s_add_u32 s53, s53, 1
s_waitcnt vmcnt(0)
v_max3_u32 v239, v216, v217, v218
v_max3_u32 v239, v239, v219, v220
v_max3_u32 v239, v239, v221, v222
v_max_u32 v239, v239, v223
v_cmp_eq_u32 vcc, -1, v239
s_cmp_ge_u32 s53, 4000000
s_cbranch_scc1 rt_87_x
s_cbranch_vccnz rt_87
rt_87_x:
s_branch fx_38_b
fx_39:
rt_88:
s_movk_i32 s54, 16384
buffer_load_dwordx4 v[200:203], v237, s[16:19], s54 offen sc1
buffer_load_dwordx4 v[204:207], v238, s[16:19], s54 offen sc1
s_add_u32 s53, s53, 1
s_waitcnt vmcnt(0)
v_max3_u32 v239, v200, v201, v202
v_max3_u32 v239, v239, v203, v204
v_max3_u32 v239, v239, v205, v206
v_max_u32 v239, v239, v207
v_cmp_eq_u32 vcc, -1, v239
s_cmp_ge_u32 s53, 4000000
s_cbranch_scc1 rt_88_x
s_cbranch_vccnz rt_88
rt_88_x:
s_branch fx_39_b
fx_40:
rt_89:
s_movk_i32 s54, 19456
buffer_load_dwordx4 v[224:227], v237, s[16:19], s54 offen sc1
buffer_load_dwordx4 v[228:231], v238, s[16:19], s54 offen sc1
s_add_u32 s53, s53, 1
s_waitcnt vmcnt(0)
v_max3_u32 v239, v224, v225, v226
v_max3_u32 v239, v239, v227, v228
v_max3_u32 v239, v239, v229, v230
wu_71:
s_cbranch_execz wu_ret2
v_max_u32 v239, v239, v231
v_cmp_eq_u32 vcc, -1, v239
s_cmp_ge_u32 s53, 4000000
s_cbranch_scc1 rt_89_x
s_cbranch_vccnz rt_89
rt_89_x:
s_branch fx_40_b
fx_42:
rt_90:
buffer_load_dword v253, v252, s[12:15], 0 offen sc1
s_add_u32 s53, s53, 1
s_waitcnt vmcnt(0)
v_cmp_ne_u32 vcc, s55, v253
s_cmp_ge_u32 s53, 4000000
s_cbranch_scc1 rt_90_x
s_cbranch_vccnz rt_90
rt_90_x:
s_branch fx_42_b
ex_44:
rt_91:
buffer_load_dwordx4 v[104:107], v241, s[16:19], s20 offen offset:0 sc1
buffer_load_dwordx4 v[108:111], v241, s[16:19], s20 offen offset:1024 sc1
buffer_load_dwordx4 v[112:115], v241, s[16:19], s20 offen offset:2048 sc1
buffer_load_dwordx4 v[116:119], v241, s[16:19], s20 offen offset:3072 sc1
buffer_load_dwordx4 v[120:123], v241, s[16:19], s21 offen offset:0 sc1
buffer_load_dwordx4 v[124:127], v241, s[16:19], s21 offen offset:1024 sc1
buffer_load_dwordx2 v[128:129], v249, s[16:19], s21 offen offset:2048 sc1
buffer_load_dwordx2 v[130:131], v249, s[16:19], s21 offen offset:2560 sc1
buffer_load_dwordx4 v[132:135], v241, s[16:19], s21 offen offset:3072 sc1
buffer_load_dwordx4 v[136:139], v241, s[16:19], s47 offen offset:0 sc1
buffer_load_dwordx4 v[140:143], v241, s[16:19], s47 offen offset:1024 sc1
buffer_load_dwordx4 v[144:147], v242, s[16:19], 0 offen offset:0 sc1
buffer_load_dwordx4 v[148:151], v242, s[16:19], 0 offen offset:1024 sc1
buffer_load_dwordx4 v[176:179], v242, s[16:19], 0 offen offset:2048 sc1
buffer_load_dwordx2 v[180:181], v250, s[16:19], 0 offen offset:3072 sc1
buffer_load_dwordx2 v[182:183], v250, s[16:19], 0 offen offset:3584 sc1
buffer_load_dwordx4 v[184:187], v242, s[16:19], s20 offen offset:0 sc1
buffer_load_dwordx4 v[188:191], v242, s[16:19], s20 offen offset:1024 sc1
buffer_load_dwordx4 v[192:195], v242, s[16:19], s20 offen offset:2048 sc1
buffer_load_dwordx4 v[196:199], v242, s[16:19], s20 offen offset:3072 sc1
buffer_load_dwordx4 v[200:203], v242, s[16:19], s21 offen offset:0 sc1
buffer_load_dwordx4 v[204:207], v242, s[16:19], s21 offen offset:1024 sc1
buffer_load_dwordx2 v[208:209], v250, s[16:19], s21 offen offset:2048 sc1
buffer_load_dwordx2 v[210:211], v250, s[16:19], s21 offen offset:2560 sc1
buffer_load_dwordx4 v[212:215], v242, s[16:19], s21 offen offset:3072 sc1
buffer_load_dwordx4 v[216:219], v242, s[16:19], s47 offen offset:0 sc1
buffer_load_dwordx4 v[220:223], v242, s[16:19], s47 offen offset:1024 sc1
buffer_load_dwordx4 v[224:227], v243, s[16:19], 0 offen offset:0 sc1
buffer_load_dwordx4 v[228:231], v243, s[16:19], 0 offen offset:1024 sc1
buffer_load_dwordx4 v[232:235], v243, s[16:19], 0 offen offset:2048 sc1
buffer_load_dwordx2 v[236:237], v251, s[16:19], 0 offen offset:3072 sc1
buffer_load_dwordx2 v[238:239], v251, s[16:19], 0 offen offset:3584 sc1
buffer_load_dwordx4 v[88:91], v243, s[16:19], s20 offen offset:0 sc1
buffer_load_dwordx4 v[92:95], v243, s[16:19], s20 offen offset:1024 sc1
buffer_load_dwordx4 v[96:99], v243, s[16:19], s20 offen offset:2048 sc1
s_add_u32 s53, s53, 1
s_waitcnt vmcnt(0)
v_max3_u32 v252, v104, v105, v106
v_max3_u32 v252, v252, v107, v108
v_max3_u32 v252, v252, v109, v110
v_max_u32 v252, v252, v111
v_cmp_eq_u32 vcc, -1, v252
s_cmp_ge_u32 s53, 4000000
s_cbranch_scc1 rt_91_x
s_cbranch_vccnz rt_91
rt_91_x:
s_branch ex_44_b
ex_45:
rt_92:
buffer_load_dwordx4 v[112:115], v241, s[16:19], s20 offen offset:2048 sc1
buffer_load_dwordx4 v[116:119], v241, s[16:19], s20 offen offset:3072 sc1
buffer_load_dwordx4 v[120:123], v241, s[16:19], s21 offen offset:0 sc1
buffer_load_dwordx4 v[124:127], v241, s[16:19], s21 offen offset:1024 sc1
buffer_load_dwordx2 v[128:129], v249, s[16:19], s21 offen offset:2048 sc1
buffer_load_dwordx2 v[130:131], v249, s[16:19], s21 offen offset:2560 sc1
buffer_load_dwordx4 v[132:135], v241, s[16:19], s21 offen offset:3072 sc1
buffer_load_dwordx4 v[136:139], v241, s[16:19], s47 offen offset:0 sc1
buffer_load_dwordx4 v[140:143], v241, s[16:19], s47 offen offset:1024 sc1
buffer_load_dwordx4 v[144:147], v242, s[16:19], 0 offen offset:0 sc1
buffer_load_dwordx4 v[148:151], v242, s[16:19], 0 offen offset:1024 sc1
buffer_load_dwordx4 v[176:179], v242, s[16:19], 0 offen offset:2048 sc1
wu_72:
s_cbranch_execz wu_ret2
buffer_load_dwordx2 v[180:181], v250, s[16:19], 0 offen offset:3072 sc1
buffer_load_dwordx2 v[182:183], v250, s[16:19], 0 offen offset:3584 sc1
buffer_load_dwordx4 v[184:187], v242, s[16:19], s20 offen offset:0 sc1
buffer_load_dwordx4 v[188:191], v242, s[16:19], s20 offen offset:1024 sc1
buffer_load_dwordx4 v[192:195], v242, s[16:19], s20 offen offset:2048 sc1
buffer_load_dwordx4 v[196:199], v242, s[16:19], s20 offen offset:3072 sc1
buffer_load_dwordx4 v[200:203], v242, s[16:19], s21 offen offset:0 sc1
buffer_load_dwordx4 v[204:207], v242, s[16:19], s21 offen offset:1024 sc1
buffer_load_dwordx2 v[208:209], v250, s[16:19], s21 offen offset:2048 sc1
buffer_load_dwordx2 v[210:211], v250, s[16:19], s21 offen offset:2560 sc1
buffer_load_dwordx4 v[212:215], v242, s[16:19], s21 offen offset:3072 sc1
buffer_load_dwordx4 v[216:219], v242, s[16:19], s47 offen offset:0 sc1
buffer_load_dwordx4 v[220:223], v242, s[16:19], s47 offen offset:1024 sc1
buffer_load_dwordx4 v[224:227], v243, s[16:19], 0 offen offset:0 sc1
buffer_load_dwordx4 v[228:231], v243, s[16:19], 0 offen offset:1024 sc1
buffer_load_dwordx4 v[232:235], v243, s[16:19], 0 offen offset:2048 sc1
buffer_load_dwordx2 v[236:237], v251, s[16:19], 0 offen offset:3072 sc1
buffer_load_dwordx2 v[238:239], v251, s[16:19], 0 offen offset:3584 sc1
buffer_load_dwordx4 v[88:91], v243, s[16:19], s20 offen offset:0 sc1
buffer_load_dwordx4 v[92:95], v243, s[16:19], s20 offen offset:1024 sc1
buffer_load_dwordx4 v[96:99], v243, s[16:19], s20 offen offset:2048 sc1
buffer_load_dwordx4 v[100:103], v243, s[16:19], s20 offen offset:3072 sc1
buffer_load_dwordx4 v[104:107], v243, s[16:19], s21 offen offset:0 sc1
s_add_u32 s53, s53, 1
s_waitcnt vmcnt(0)
v_max3_u32 v252, v112, v113, v114
v_max3_u32 v252, v252, v115, v116
v_max3_u32 v252, v252, v117, v118
v_max_u32 v252, v252, v119
v_cmp_eq_u32 vcc, -1, v252
s_cmp_ge_u32 s53, 4000000
s_cbranch_scc1 rt_92_x
s_cbranch_vccnz rt_92
rt_92_x:
s_branch ex_45_b
ex_46:
rt_93:
buffer_load_dwordx4 v[120:123], v241, s[16:19], s21 offen offset:0 sc1
buffer_load_dwordx4 v[124:127], v241, s[16:19], s21 offen offset:1024 sc1
buffer_load_dwordx2 v[128:129], v249, s[16:19], s21 offen offset:2048 sc1
buffer_load_dwordx2 v[130:131], v249, s[16:19], s21 offen offset:2560 sc1
buffer_load_dwordx4 v[132:135], v241, s[16:19], s21 offen offset:3072 sc1
buffer_load_dwordx4 v[136:139], v241, s[16:19], s47 offen offset:0 sc1
buffer_load_dwordx4 v[140:143], v241, s[16:19], s47 offen offset:1024 sc1
buffer_load_dwordx4 v[144:147], v242, s[16:19], 0 offen offset:0 sc1
buffer_load_dwordx4 v[148:151], v242, s[16:19], 0 offen offset:1024 sc1
buffer_load_dwordx4 v[176:179], v242, s[16:19], 0 offen offset:2048 sc1
buffer_load_dwordx2 v[180:181], v250, s[16:19], 0 offen offset:3072 sc1
buffer_load_dwordx2 v[182:183], v250, s[16:19], 0 offen offset:3584 sc1
buffer_load_dwordx4 v[184:187], v242, s[16:19], s20 offen offset:0 sc1
buffer_load_dwordx4 v[188:191], v242, s[16:19], s20 offen offset:1024 sc1
buffer_load_dwordx4 v[192:195], v242, s[16:19], s20 offen offset:2048 sc1
buffer_load_dwordx4 v[196:199], v242, s[16:19], s20 offen offset:3072 sc1
buffer_load_dwordx4 v[200:203], v242, s[16:19], s21 offen offset:0 sc1
buffer_load_dwordx4 v[204:207], v242, s[16:19], s21 offen offset:1024 sc1
buffer_load_dwordx2 v[208:209], v250, s[16:19], s21 offen offset:2048 sc1
buffer_load_dwordx2 v[210:211], v250, s[16:19], s21 offen offset:2560 sc1
buffer_load_dwordx4 v[212:215], v242, s[16:19], s21 offen offset:3072 sc1
buffer_load_dwordx4 v[216:219], v242, s[16:19], s47 offen offset:0 sc1
buffer_load_dwordx4 v[220:223], v242, s[16:19], s47 offen offset:1024 sc1
buffer_load_dwordx4 v[224:227], v243, s[16:19], 0 offen offset:0 sc1
buffer_load_dwordx4 v[228:231], v243, s[16:19], 0 offen offset:1024 sc1
buffer_load_dwordx4 v[232:235], v243, s[16:19], 0 offen offset:2048 sc1
buffer_load_dwordx2 v[236:237], v251, s[16:19], 0 offen offset:3072 sc1
buffer_load_dwordx2 v[238:239], v251, s[16:19], 0 offen offset:3584 sc1
buffer_load_dwordx4 v[88:91], v243, s[16:19], s20 offen offset:0 sc1
buffer_load_dwordx4 v[92:95], v243, s[16:19], s20 offen offset:1024 sc1
buffer_load_dwordx4 v[96:99], v243, s[16:19], s20 offen offset:2048 sc1
buffer_load_dwordx4 v[100:103], v243, s[16:19], s20 offen offset:3072 sc1
buffer_load_dwordx4 v[104:107], v243, s[16:19], s21 offen offset:0 sc1
wu_73:
s_cbranch_execz wu_ret2
buffer_load_dwordx4 v[108:111], v243, s[16:19], s21 offen offset:1024 sc1
buffer_load_dwordx2 v[112:113], v251, s[16:19], s21 offen offset:2048 sc1
buffer_load_dwordx2 v[114:115], v251, s[16:19], s21 offen offset:2560 sc1
s_add_u32 s53, s53, 1
s_waitcnt vmcnt(0)
v_max3_u32 v252, v120, v121, v122
v_max3_u32 v252, v252, v123, v124
v_max3_u32 v252, v252, v125, v126
v_max_u32 v252, v252, v127
v_cmp_eq_u32 vcc, -1, v252
s_cmp_ge_u32 s53, 4000000
s_cbranch_scc1 rt_93_x
s_cbranch_vccnz rt_93
rt_93_x:
s_branch ex_46_b
ex_47:
rt_94:
buffer_load_dwordx2 v[128:129], v249, s[16:19], s21 offen offset:2048 sc1
buffer_load_dwordx2 v[130:131], v249, s[16:19], s21 offen offset:2560 sc1
buffer_load_dwordx4 v[132:135], v241, s[16:19], s21 offen offset:3072 sc1
buffer_load_dwordx4 v[136:139], v241, s[16:19], s47 offen offset:0 sc1
buffer_load_dwordx4 v[140:143], v241, s[16:19], s47 offen offset:1024 sc1
buffer_load_dwordx4 v[144:147], v242, s[16:19], 0 offen offset:0 sc1
buffer_load_dwordx4 v[148:151], v242, s[16:19], 0 offen offset:1024 sc1
buffer_load_dwordx4 v[176:179], v242, s[16:19], 0 offen offset:2048 sc1
buffer_load_dwordx2 v[180:181], v250, s[16:19], 0 offen offset:3072 sc1
buffer_load_dwordx2 v[182:183], v250, s[16:19], 0 offen offset:3584 sc1
buffer_load_dwordx4 v[184:187], v242, s[16:19], s20 offen offset:0 sc1
buffer_load_dwordx4 v[188:191], v242, s[16:19], s20 offen offset:1024 sc1
buffer_load_dwordx4 v[192:195], v242, s[16:19], s20 offen offset:2048 sc1
buffer_load_dwordx4 v[196:199], v242, s[16:19], s20 offen offset:3072 sc1
buffer_load_dwordx4 v[200:203], v242, s[16:19], s21 offen offset:0 sc1
buffer_load_dwordx4 v[204:207], v242, s[16:19], s21 offen offset:1024 sc1
buffer_load_dwordx2 v[208:209], v250, s[16:19], s21 offen offset:2048 sc1
buffer_load_dwordx2 v[210:211], v250, s[16:19], s21 offen offset:2560 sc1
buffer_load_dwordx4 v[212:215], v242, s[16:19], s21 offen offset:3072 sc1
buffer_load_dwordx4 v[216:219], v242, s[16:19], s47 offen offset:0 sc1
buffer_load_dwordx4 v[220:223], v242, s[16:19], s47 offen offset:1024 sc1
buffer_load_dwordx4 v[224:227], v243, s[16:19], 0 offen offset:0 sc1
buffer_load_dwordx4 v[228:231], v243, s[16:19], 0 offen offset:1024 sc1
buffer_load_dwordx4 v[232:235], v243, s[16:19], 0 offen offset:2048 sc1
buffer_load_dwordx2 v[236:237], v251, s[16:19], 0 offen offset:3072 sc1
buffer_load_dwordx2 v[238:239], v251, s[16:19], 0 offen offset:3584 sc1
buffer_load_dwordx4 v[88:91], v243, s[16:19], s20 offen offset:0 sc1
buffer_load_dwordx4 v[92:95], v243, s[16:19], s20 offen offset:1024 sc1
buffer_load_dwordx4 v[96:99], v243, s[16:19], s20 offen offset:2048 sc1
buffer_load_dwordx4 v[100:103], v243, s[16:19], s20 offen offset:3072 sc1
buffer_load_dwordx4 v[104:107], v243, s[16:19], s21 offen offset:0 sc1
buffer_load_dwordx4 v[108:111], v243, s[16:19], s21 offen offset:1024 sc1
buffer_load_dwordx2 v[112:113], v251, s[16:19], s21 offen offset:2048 sc1
buffer_load_dwordx2 v[114:115], v251, s[16:19], s21 offen offset:2560 sc1
buffer_load_dwordx4 v[116:119], v243, s[16:19], s21 offen offset:3072 sc1
buffer_load_dwordx4 v[120:123], v243, s[16:19], s47 offen offset:0 sc1
s_add_u32 s53, s53, 1
s_waitcnt vmcnt(0)
v_max3_u32 v252, v128, v129, v130
v_max3_u32 v252, v252, v131, v132
v_max3_u32 v252, v252, v133, v134
v_max_u32 v252, v252, v135
v_cmp_eq_u32 vcc, -1, v252
s_cmp_ge_u32 s53, 4000000
s_cbranch_scc1 rt_94_x
s_cbranch_vccnz rt_94
rt_94_x:
s_branch ex_47_b
ex_48:
rt_95:
buffer_load_dwordx4 v[136:139], v241, s[16:19], s47 offen offset:0 sc1
buffer_load_dwordx4 v[140:143], v241, s[16:19], s47 offen offset:1024 sc1
buffer_load_dwordx4 v[144:147], v242, s[16:19], 0 offen offset:0 sc1
buffer_load_dwordx4 v[148:151], v242, s[16:19], 0 offen offset:1024 sc1
buffer_load_dwordx4 v[176:179], v242, s[16:19], 0 offen offset:2048 sc1
buffer_load_dwordx2 v[180:181], v250, s[16:19], 0 offen offset:3072 sc1
buffer_load_dwordx2 v[182:183], v250, s[16:19], 0 offen offset:3584 sc1
buffer_load_dwordx4 v[184:187], v242, s[16:19], s20 offen offset:0 sc1
buffer_load_dwordx4 v[188:191], v242, s[16:19], s20 offen offset:1024 sc1
buffer_load_dwordx4 v[192:195], v242, s[16:19], s20 offen offset:2048 sc1
wu_74:
s_cbranch_execz wu_ret2
buffer_load_dwordx4 v[196:199], v242, s[16:19], s20 offen offset:3072 sc1
buffer_load_dwordx4 v[200:203], v242, s[16:19], s21 offen offset:0 sc1
buffer_load_dwordx4 v[204:207], v242, s[16:19], s21 offen offset:1024 sc1
buffer_load_dwordx2 v[208:209], v250, s[16:19], s21 offen offset:2048 sc1
buffer_load_dwordx2 v[210:211], v250, s[16:19], s21 offen offset:2560 sc1
buffer_load_dwordx4 v[212:215], v242, s[16:19], s21 offen offset:3072 sc1
buffer_load_dwordx4 v[216:219], v242, s[16:19], s47 offen offset:0 sc1
buffer_load_dwordx4 v[220:223], v242, s[16:19], s47 offen offset:1024 sc1
buffer_load_dwordx4 v[224:227], v243, s[16:19], 0 offen offset:0 sc1
buffer_load_dwordx4 v[228:231], v243, s[16:19], 0 offen offset:1024 sc1
buffer_load_dwordx4 v[232:235], v243, s[16:19], 0 offen offset:2048 sc1
buffer_load_dwordx2 v[236:237], v251, s[16:19], 0 offen offset:3072 sc1
buffer_load_dwordx2 v[238:239], v251, s[16:19], 0 offen offset:3584 sc1
buffer_load_dwordx4 v[88:91], v243, s[16:19], s20 offen offset:0 sc1
buffer_load_dwordx4 v[92:95], v243, s[16:19], s20 offen offset:1024 sc1
buffer_load_dwordx4 v[96:99], v243, s[16:19], s20 offen offset:2048 sc1
buffer_load_dwordx4 v[100:103], v243, s[16:19], s20 offen offset:3072 sc1
buffer_load_dwordx4 v[104:107], v243, s[16:19], s21 offen offset:0 sc1
buffer_load_dwordx4 v[108:111], v243, s[16:19], s21 offen offset:1024 sc1
buffer_load_dwordx2 v[112:113], v251, s[16:19], s21 offen offset:2048 sc1
buffer_load_dwordx2 v[114:115], v251, s[16:19], s21 offen offset:2560 sc1
buffer_load_dwordx4 v[116:119], v243, s[16:19], s21 offen offset:3072 sc1
buffer_load_dwordx4 v[120:123], v243, s[16:19], s47 offen offset:0 sc1
buffer_load_dwordx4 v[124:127], v243, s[16:19], s47 offen offset:1024 sc1
buffer_load_dwordx4 v[128:131], v240, s[16:19], 0 offen offset:0 sc1
s_add_u32 s53, s53, 1
s_waitcnt vmcnt(0)
v_max3_u32 v252, v136, v137, v138
v_max3_u32 v252, v252, v139, v140
v_max3_u32 v252, v252, v141, v142
v_max_u32 v252, v252, v143
v_cmp_eq_u32 vcc, -1, v252
s_cmp_ge_u32 s53, 4000000
s_cbranch_scc1 rt_95_x
s_cbranch_vccnz rt_95
rt_95_x:
s_branch ex_48_b
ex_49:
rt_96:
buffer_load_dwordx4 v[144:147], v242, s[16:19], 0 offen offset:0 sc1
buffer_load_dwordx4 v[148:151], v242, s[16:19], 0 offen offset:1024 sc1
buffer_load_dwordx4 v[176:179], v242, s[16:19], 0 offen offset:2048 sc1
buffer_load_dwordx2 v[180:181], v250, s[16:19], 0 offen offset:3072 sc1
buffer_load_dwordx2 v[182:183], v250, s[16:19], 0 offen offset:3584 sc1
buffer_load_dwordx4 v[184:187], v242, s[16:19], s20 offen offset:0 sc1
buffer_load_dwordx4 v[188:191], v242, s[16:19], s20 offen offset:1024 sc1
buffer_load_dwordx4 v[192:195], v242, s[16:19], s20 offen offset:2048 sc1
buffer_load_dwordx4 v[196:199], v242, s[16:19], s20 offen offset:3072 sc1
buffer_load_dwordx4 v[200:203], v242, s[16:19], s21 offen offset:0 sc1
buffer_load_dwordx4 v[204:207], v242, s[16:19], s21 offen offset:1024 sc1
buffer_load_dwordx2 v[208:209], v250, s[16:19], s21 offen offset:2048 sc1
buffer_load_dwordx2 v[210:211], v250, s[16:19], s21 offen offset:2560 sc1
buffer_load_dwordx4 v[212:215], v242, s[16:19], s21 offen offset:3072 sc1
buffer_load_dwordx4 v[216:219], v242, s[16:19], s47 offen offset:0 sc1
buffer_load_dwordx4 v[220:223], v242, s[16:19], s47 offen offset:1024 sc1
buffer_load_dwordx4 v[224:227], v243, s[16:19], 0 offen offset:0 sc1
buffer_load_dwordx4 v[228:231], v243, s[16:19], 0 offen offset:1024 sc1
buffer_load_dwordx4 v[232:235], v243, s[16:19], 0 offen offset:2048 sc1
buffer_load_dwordx2 v[236:237], v251, s[16:19], 0 offen offset:3072 sc1
buffer_load_dwordx2 v[238:239], v251, s[16:19], 0 offen offset:3584 sc1
buffer_load_dwordx4 v[88:91], v243, s[16:19], s20 offen offset:0 sc1
buffer_load_dwordx4 v[92:95], v243, s[16:19], s20 offen offset:1024 sc1
buffer_load_dwordx4 v[96:99], v243, s[16:19], s20 offen offset:2048 sc1
buffer_load_dwordx4 v[100:103], v243, s[16:19], s20 offen offset:3072 sc1
buffer_load_dwordx4 v[104:107], v243, s[16:19], s21 offen offset:0 sc1
buffer_load_dwordx4 v[108:111], v243, s[16:19], s21 offen offset:1024 sc1
buffer_load_dwordx2 v[112:113], v251, s[16:19], s21 offen offset:2048 sc1
buffer_load_dwordx2 v[114:115], v251, s[16:19], s21 offen offset:2560 sc1
buffer_load_dwordx4 v[116:119], v243, s[16:19], s21 offen offset:3072 sc1
buffer_load_dwordx4 v[120:123], v243, s[16:19], s47 offen offset:0 sc1
wu_75:
s_cbranch_execz wu_ret2
buffer_load_dwordx4 v[124:127], v243, s[16:19], s47 offen offset:1024 sc1
buffer_load_dwordx4 v[128:131], v240, s[16:19], 0 offen offset:0 sc1
buffer_load_dwordx4 v[132:135], v240, s[16:19], 0 offen offset:1024 sc1
buffer_load_dwordx4 v[136:139], v240, s[16:19], 0 offen offset:2048 sc1
s_add_u32 s53, s53, 1
s_waitcnt vmcnt(0)
v_max3_u32 v252, v144, v145, v146
v_max3_u32 v252, v252, v147, v148
v_max3_u32 v252, v252, v149, v150
v_max_u32 v252, v252, v151
v_cmp_eq_u32 vcc, -1, v252
s_cmp_ge_u32 s53, 4000000
s_cbranch_scc1 rt_96_x
s_cbranch_vccnz rt_96
rt_96_x:
s_branch ex_49_b
ex_50:
rt_97:
buffer_load_dwordx4 v[176:179], v242, s[16:19], 0 offen offset:2048 sc1
buffer_load_dwordx2 v[180:181], v250, s[16:19], 0 offen offset:3072 sc1
buffer_load_dwordx2 v[182:183], v250, s[16:19], 0 offen offset:3584 sc1
buffer_load_dwordx4 v[184:187], v242, s[16:19], s20 offen offset:0 sc1
buffer_load_dwordx4 v[188:191], v242, s[16:19], s20 offen offset:1024 sc1
buffer_load_dwordx4 v[192:195], v242, s[16:19], s20 offen offset:2048 sc1
buffer_load_dwordx4 v[196:199], v242, s[16:19], s20 offen offset:3072 sc1
buffer_load_dwordx4 v[200:203], v242, s[16:19], s21 offen offset:0 sc1
buffer_load_dwordx4 v[204:207], v242, s[16:19], s21 offen offset:1024 sc1
buffer_load_dwordx2 v[208:209], v250, s[16:19], s21 offen offset:2048 sc1
buffer_load_dwordx2 v[210:211], v250, s[16:19], s21 offen offset:2560 sc1
buffer_load_dwordx4 v[212:215], v242, s[16:19], s21 offen offset:3072 sc1
buffer_load_dwordx4 v[216:219], v242, s[16:19], s47 offen offset:0 sc1
buffer_load_dwordx4 v[220:223], v242, s[16:19], s47 offen offset:1024 sc1
buffer_load_dwordx4 v[224:227], v243, s[16:19], 0 offen offset:0 sc1
buffer_load_dwordx4 v[228:231], v243, s[16:19], 0 offen offset:1024 sc1
buffer_load_dwordx4 v[232:235], v243, s[16:19], 0 offen offset:2048 sc1
buffer_load_dwordx2 v[236:237], v251, s[16:19], 0 offen offset:3072 sc1
buffer_load_dwordx2 v[238:239], v251, s[16:19], 0 offen offset:3584 sc1
buffer_load_dwordx4 v[88:91], v243, s[16:19], s20 offen offset:0 sc1
buffer_load_dwordx4 v[92:95], v243, s[16:19], s20 offen offset:1024 sc1
buffer_load_dwordx4 v[96:99], v243, s[16:19], s20 offen offset:2048 sc1
buffer_load_dwordx4 v[100:103], v243, s[16:19], s20 offen offset:3072 sc1
buffer_load_dwordx4 v[104:107], v243, s[16:19], s21 offen offset:0 sc1
buffer_load_dwordx4 v[108:111], v243, s[16:19], s21 offen offset:1024 sc1
buffer_load_dwordx2 v[112:113], v251, s[16:19], s21 offen offset:2048 sc1
buffer_load_dwordx2 v[114:115], v251, s[16:19], s21 offen offset:2560 sc1
buffer_load_dwordx4 v[116:119], v243, s[16:19], s21 offen offset:3072 sc1
buffer_load_dwordx4 v[120:123], v243, s[16:19], s47 offen offset:0 sc1
buffer_load_dwordx4 v[124:127], v243, s[16:19], s47 offen offset:1024 sc1
buffer_load_dwordx4 v[128:131], v240, s[16:19], 0 offen offset:0 sc1
buffer_load_dwordx4 v[132:135], v240, s[16:19], 0 offen offset:1024 sc1
buffer_load_dwordx4 v[136:139], v240, s[16:19], 0 offen offset:2048 sc1
buffer_load_dwordx2 v[140:141], v248, s[16:19], 0 offen offset:3072 sc1
buffer_load_dwordx2 v[142:143], v248, s[16:19], 0 offen offset:3584 sc1
buffer_load_dwordx4 v[144:147], v240, s[16:19], s20 offen offset:0 sc1
s_add_u32 s53, s53, 1
s_waitcnt vmcnt(0)
v_max3_u32 v252, v176, v177, v178
v_max3_u32 v252, v252, v179, v180
v_max3_u32 v252, v252, v181, v182
v_max_u32 v252, v252, v183
v_cmp_eq_u32 vcc, -1, v252
s_cmp_ge_u32 s53, 4000000
s_cbranch_scc1 rt_97_x
s_cbranch_vccnz rt_97
rt_97_x:
s_branch ex_50_b
ex_51:
rt_98:
buffer_load_dwordx4 v[184:187], v242, s[16:19], s20 offen offset:0 sc1
buffer_load_dwordx4 v[188:191], v242, s[16:19], s20 offen offset:1024 sc1
buffer_load_dwordx4 v[192:195], v242, s[16:19], s20 offen offset:2048 sc1
buffer_load_dwordx4 v[196:199], v242, s[16:19], s20 offen offset:3072 sc1
buffer_load_dwordx4 v[200:203], v242, s[16:19], s21 offen offset:0 sc1
buffer_load_dwordx4 v[204:207], v242, s[16:19], s21 offen offset:1024 sc1
buffer_load_dwordx2 v[208:209], v250, s[16:19], s21 offen offset:2048 sc1
buffer_load_dwordx2 v[210:211], v250, s[16:19], s21 offen offset:2560 sc1
wu_76:
s_cbranch_execz wu_ret2
buffer_load_dwordx4 v[212:215], v242, s[16:19], s21 offen offset:3072 sc1
buffer_load_dwordx4 v[216:219], v242, s[16:19], s47 offen offset:0 sc1
buffer_load_dwordx4 v[220:223], v242, s[16:19], s47 offen offset:1024 sc1
buffer_load_dwordx4 v[224:227], v243, s[16:19], 0 offen offset:0 sc1
buffer_load_dwordx4 v[228:231], v243, s[16:19], 0 offen offset:1024 sc1
buffer_load_dwordx4 v[232:235], v243, s[16:19], 0 offen offset:2048 sc1
buffer_load_dwordx2 v[236:237], v251, s[16:19], 0 offen offset:3072 sc1
buffer_load_dwordx2 v[238:239], v251, s[16:19], 0 offen offset:3584 sc1
buffer_load_dwordx4 v[88:91], v243, s[16:19], s20 offen offset:0 sc1
buffer_load_dwordx4 v[92:95], v243, s[16:19], s20 offen offset:1024 sc1
buffer_load_dwordx4 v[96:99], v243, s[16:19], s20 offen offset:2048 sc1
buffer_load_dwordx4 v[100:103], v243, s[16:19], s20 offen offset:3072 sc1
buffer_load_dwordx4 v[104:107], v243, s[16:19], s21 offen offset:0 sc1
buffer_load_dwordx4 v[108:111], v243, s[16:19], s21 offen offset:1024 sc1
buffer_load_dwordx2 v[112:113], v251, s[16:19], s21 offen offset:2048 sc1
buffer_load_dwordx2 v[114:115], v251, s[16:19], s21 offen offset:2560 sc1
buffer_load_dwordx4 v[116:119], v243, s[16:19], s21 offen offset:3072 sc1
buffer_load_dwordx4 v[120:123], v243, s[16:19], s47 offen offset:0 sc1
buffer_load_dwordx4 v[124:127], v243, s[16:19], s47 offen offset:1024 sc1
buffer_load_dwordx4 v[128:131], v240, s[16:19], 0 offen offset:0 sc1
buffer_load_dwordx4 v[132:135], v240, s[16:19], 0 offen offset:1024 sc1
buffer_load_dwordx4 v[136:139], v240, s[16:19], 0 offen offset:2048 sc1
buffer_load_dwordx2 v[140:141], v248, s[16:19], 0 offen offset:3072 sc1
buffer_load_dwordx2 v[142:143], v248, s[16:19], 0 offen offset:3584 sc1
buffer_load_dwordx4 v[144:147], v240, s[16:19], s20 offen offset:0 sc1
buffer_load_dwordx4 v[148:151], v240, s[16:19], s20 offen offset:1024 sc1
buffer_load_dwordx4 v[176:179], v240, s[16:19], s20 offen offset:2048 sc1
s_add_u32 s53, s53, 1
s_waitcnt vmcnt(0)
v_max3_u32 v252, v184, v185, v186
v_max3_u32 v252, v252, v187, v188
v_max3_u32 v252, v252, v189, v190
v_max_u32 v252, v252, v191
v_cmp_eq_u32 vcc, -1, v252
s_cmp_ge_u32 s53, 4000000
s_cbranch_scc1 rt_98_x
s_cbranch_vccnz rt_98
rt_98_x:
s_branch ex_51_b
ex_52:
rt_99:
buffer_load_dwordx4 v[192:195], v242, s[16:19], s20 offen offset:2048 sc1
buffer_load_dwordx4 v[196:199], v242, s[16:19], s20 offen offset:3072 sc1
buffer_load_dwordx4 v[200:203], v242, s[16:19], s21 offen offset:0 sc1
buffer_load_dwordx4 v[204:207], v242, s[16:19], s21 offen offset:1024 sc1
buffer_load_dwordx2 v[208:209], v250, s[16:19], s21 offen offset:2048 sc1
buffer_load_dwordx2 v[210:211], v250, s[16:19], s21 offen offset:2560 sc1
buffer_load_dwordx4 v[212:215], v242, s[16:19], s21 offen offset:3072 sc1
buffer_load_dwordx4 v[216:219], v242, s[16:19], s47 offen offset:0 sc1
buffer_load_dwordx4 v[220:223], v242, s[16:19], s47 offen offset:1024 sc1
buffer_load_dwordx4 v[224:227], v243, s[16:19], 0 offen offset:0 sc1
buffer_load_dwordx4 v[228:231], v243, s[16:19], 0 offen offset:1024 sc1
buffer_load_dwordx4 v[232:235], v243, s[16:19], 0 offen offset:2048 sc1
buffer_load_dwordx2 v[236:237], v251, s[16:19], 0 offen offset:3072 sc1
buffer_load_dwordx2 v[238:239], v251, s[16:19], 0 offen offset:3584 sc1
buffer_load_dwordx4 v[88:91], v243, s[16:19], s20 offen offset:0 sc1
buffer_load_dwordx4 v[92:95], v243, s[16:19], s20 offen offset:1024 sc1
buffer_load_dwordx4 v[96:99], v243, s[16:19], s20 offen offset:2048 sc1
buffer_load_dwordx4 v[100:103], v243, s[16:19], s20 offen offset:3072 sc1
buffer_load_dwordx4 v[104:107], v243, s[16:19], s21 offen offset:0 sc1
buffer_load_dwordx4 v[108:111], v243, s[16:19], s21 offen offset:1024 sc1
buffer_load_dwordx2 v[112:113], v251, s[16:19], s21 offen offset:2048 sc1
buffer_load_dwordx2 v[114:115], v251, s[16:19], s21 offen offset:2560 sc1
buffer_load_dwordx4 v[116:119], v243, s[16:19], s21 offen offset:3072 sc1
buffer_load_dwordx4 v[120:123], v243, s[16:19], s47 offen offset:0 sc1
buffer_load_dwordx4 v[124:127], v243, s[16:19], s47 offen offset:1024 sc1
buffer_load_dwordx4 v[128:131], v240, s[16:19], 0 offen offset:0 sc1
buffer_load_dwordx4 v[132:135], v240, s[16:19], 0 offen offset:1024 sc1
buffer_load_dwordx4 v[136:139], v240, s[16:19], 0 offen offset:2048 sc1
buffer_load_dwordx2 v[140:141], v248, s[16:19], 0 offen offset:3072 sc1
wu_77:
s_cbranch_execz wu_ret2
buffer_load_dwordx2 v[142:143], v248, s[16:19], 0 offen offset:3584 sc1
buffer_load_dwordx4 v[144:147], v240, s[16:19], s20 offen offset:0 sc1
buffer_load_dwordx4 v[148:151], v240, s[16:19], s20 offen offset:1024 sc1
buffer_load_dwordx4 v[176:179], v240, s[16:19], s20 offen offset:2048 sc1
buffer_load_dwordx4 v[180:183], v240, s[16:19], s20 offen offset:3072 sc1
buffer_load_dwordx4 v[184:187], v240, s[16:19], s21 offen offset:0 sc1
s_add_u32 s53, s53, 1
s_waitcnt vmcnt(0)
v_max3_u32 v252, v192, v193, v194
v_max3_u32 v252, v252, v195, v196
v_max3_u32 v252, v252, v197, v198
v_max_u32 v252, v252, v199
v_cmp_eq_u32 vcc, -1, v252
s_cmp_ge_u32 s53, 4000000
s_cbranch_scc1 rt_99_x
s_cbranch_vccnz rt_99
rt_99_x:
s_branch ex_52_b
ex_53:
rt_100:
buffer_load_dwordx4 v[200:203], v242, s[16:19], s21 offen offset:0 sc1
buffer_load_dwordx4 v[204:207], v242, s[16:19], s21 offen offset:1024 sc1
buffer_load_dwordx2 v[208:209], v250, s[16:19], s21 offen offset:2048 sc1
buffer_load_dwordx2 v[210:211], v250, s[16:19], s21 offen offset:2560 sc1
buffer_load_dwordx4 v[212:215], v242, s[16:19], s21 offen offset:3072 sc1
buffer_load_dwordx4 v[216:219], v242, s[16:19], s47 offen offset:0 sc1
buffer_load_dwordx4 v[220:223], v242, s[16:19], s47 offen offset:1024 sc1
buffer_load_dwordx4 v[224:227], v243, s[16:19], 0 offen offset:0 sc1
buffer_load_dwordx4 v[228:231], v243, s[16:19], 0 offen offset:1024 sc1
buffer_load_dwordx4 v[232:235], v243, s[16:19], 0 offen offset:2048 sc1
buffer_load_dwordx2 v[236:237], v251, s[16:19], 0 offen offset:3072 sc1
buffer_load_dwordx2 v[238:239], v251, s[16:19], 0 offen offset:3584 sc1
buffer_load_dwordx4 v[88:91], v243, s[16:19], s20 offen offset:0 sc1
buffer_load_dwordx4 v[92:95], v243, s[16:19], s20 offen offset:1024 sc1
buffer_load_dwordx4 v[96:99], v243, s[16:19], s20 offen offset:2048 sc1
buffer_load_dwordx4 v[100:103], v243, s[16:19], s20 offen offset:3072 sc1
buffer_load_dwordx4 v[104:107], v243, s[16:19], s21 offen offset:0 sc1
buffer_load_dwordx4 v[108:111], v243, s[16:19], s21 offen offset:1024 sc1
buffer_load_dwordx2 v[112:113], v251, s[16:19], s21 offen offset:2048 sc1
buffer_load_dwordx2 v[114:115], v251, s[16:19], s21 offen offset:2560 sc1
buffer_load_dwordx4 v[116:119], v243, s[16:19], s21 offen offset:3072 sc1
buffer_load_dwordx4 v[120:123], v243, s[16:19], s47 offen offset:0 sc1
buffer_load_dwordx4 v[124:127], v243, s[16:19], s47 offen offset:1024 sc1
buffer_load_dwordx4 v[128:131], v240, s[16:19], 0 offen offset:0 sc1
buffer_load_dwordx4 v[132:135], v240, s[16:19], 0 offen offset:1024 sc1
buffer_load_dwordx4 v[136:139], v240, s[16:19], 0 offen offset:2048 sc1
buffer_load_dwordx2 v[140:141], v248, s[16:19], 0 offen offset:3072 sc1
buffer_load_dwordx2 v[142:143], v248, s[16:19], 0 offen offset:3584 sc1
buffer_load_dwordx4 v[144:147], v240, s[16:19], s20 offen offset:0 sc1
buffer_load_dwordx4 v[148:151], v240, s[16:19], s20 offen offset:1024 sc1
buffer_load_dwordx4 v[176:179], v240, s[16:19], s20 offen offset:2048 sc1
buffer_load_dwordx4 v[180:183], v240, s[16:19], s20 offen offset:3072 sc1
buffer_load_dwordx4 v[184:187], v240, s[16:19], s21 offen offset:0 sc1
buffer_load_dwordx4 v[188:191], v240, s[16:19], s21 offen offset:1024 sc1
buffer_load_dwordx2 v[192:193], v248, s[16:19], s21 offen offset:2048 sc1
buffer_load_dwordx2 v[194:195], v248, s[16:19], s21 offen offset:2560 sc1
s_add_u32 s53, s53, 1
s_waitcnt vmcnt(0)
v_max3_u32 v252, v200, v201, v202
v_max3_u32 v252, v252, v203, v204
v_max3_u32 v252, v252, v205, v206
v_max_u32 v252, v252, v207
v_cmp_eq_u32 vcc, -1, v252
s_cmp_ge_u32 s53, 4000000
s_cbranch_scc1 rt_100_x
s_cbranch_vccnz rt_100
rt_100_x:
s_branch ex_53_b
ex_54:
rt_101:
buffer_load_dwordx2 v[208:209], v250, s[16:19], s21 offen offset:2048 sc1
buffer_load_dwordx2 v[210:211], v250, s[16:19], s21 offen offset:2560 sc1
buffer_load_dwordx4 v[212:215], v242, s[16:19], s21 offen offset:3072 sc1
buffer_load_dwordx4 v[216:219], v242, s[16:19], s47 offen offset:0 sc1
buffer_load_dwordx4 v[220:223], v242, s[16:19], s47 offen offset:1024 sc1
buffer_load_dwordx4 v[224:227], v243, s[16:19], 0 offen offset:0 sc1
buffer_load_dwordx4 v[228:231], v243, s[16:19], 0 offen offset:1024 sc1
wu_78:
s_cbranch_execz wu_ret2
buffer_load_dwordx4 v[232:235], v243, s[16:19], 0 offen offset:2048 sc1
buffer_load_dwordx2 v[236:237], v251, s[16:19], 0 offen offset:3072 sc1
buffer_load_dwordx2 v[238:239], v251, s[16:19], 0 offen offset:3584 sc1
buffer_load_dwordx4 v[88:91], v243, s[16:19], s20 offen offset:0 sc1
buffer_load_dwordx4 v[92:95], v243, s[16:19], s20 offen offset:1024 sc1
buffer_load_dwordx4 v[96:99], v243, s[16:19], s20 offen offset:2048 sc1
buffer_load_dwordx4 v[100:103], v243, s[16:19], s20 offen offset:3072 sc1
buffer_load_dwordx4 v[104:107], v243, s[16:19], s21 offen offset:0 sc1
buffer_load_dwordx4 v[108:111], v243, s[16:19], s21 offen offset:1024 sc1
buffer_load_dwordx2 v[112:113], v251, s[16:19], s21 offen offset:2048 sc1
buffer_load_dwordx2 v[114:115], v251, s[16:19], s21 offen offset:2560 sc1
buffer_load_dwordx4 v[116:119], v243, s[16:19], s21 offen offset:3072 sc1
buffer_load_dwordx4 v[120:123], v243, s[16:19], s47 offen offset:0 sc1
buffer_load_dwordx4 v[124:127], v243, s[16:19], s47 offen offset:1024 sc1
buffer_load_dwordx4 v[128:131], v240, s[16:19], 0 offen offset:0 sc1
buffer_load_dwordx4 v[132:135], v240, s[16:19], 0 offen offset:1024 sc1
buffer_load_dwordx4 v[136:139], v240, s[16:19], 0 offen offset:2048 sc1
buffer_load_dwordx2 v[140:141], v248, s[16:19], 0 offen offset:3072 sc1
buffer_load_dwordx2 v[142:143], v248, s[16:19], 0 offen offset:3584 sc1
buffer_load_dwordx4 v[144:147], v240, s[16:19], s20 offen offset:0 sc1
buffer_load_dwordx4 v[148:151], v240, s[16:19], s20 offen offset:1024 sc1
buffer_load_dwordx4 v[176:179], v240, s[16:19], s20 offen offset:2048 sc1
buffer_load_dwordx4 v[180:183], v240, s[16:19], s20 offen offset:3072 sc1
buffer_load_dwordx4 v[184:187], v240, s[16:19], s21 offen offset:0 sc1
buffer_load_dwordx4 v[188:191], v240, s[16:19], s21 offen offset:1024 sc1
buffer_load_dwordx2 v[192:193], v248, s[16:19], s21 offen offset:2048 sc1
buffer_load_dwordx2 v[194:195], v248, s[16:19], s21 offen offset:2560 sc1
buffer_load_dwordx4 v[196:199], v240, s[16:19], s21 offen offset:3072 sc1
buffer_load_dwordx4 v[200:203], v240, s[16:19], s47 offen offset:0 sc1
s_add_u32 s53, s53, 1
s_waitcnt vmcnt(0)
v_max3_u32 v252, v208, v209, v210
v_max3_u32 v252, v252, v211, v212
v_max3_u32 v252, v252, v213, v214
v_max_u32 v252, v252, v215
v_cmp_eq_u32 vcc, -1, v252
s_cmp_ge_u32 s53, 4000000
s_cbranch_scc1 rt_101_x
s_cbranch_vccnz rt_101
rt_101_x:
s_branch ex_54_b
ex_55:
rt_102:
buffer_load_dwordx4 v[216:219], v242, s[16:19], s47 offen offset:0 sc1
buffer_load_dwordx4 v[220:223], v242, s[16:19], s47 offen offset:1024 sc1
buffer_load_dwordx4 v[224:227], v243, s[16:19], 0 offen offset:0 sc1
buffer_load_dwordx4 v[228:231], v243, s[16:19], 0 offen offset:1024 sc1
buffer_load_dwordx4 v[232:235], v243, s[16:19], 0 offen offset:2048 sc1
buffer_load_dwordx2 v[236:237], v251, s[16:19], 0 offen offset:3072 sc1
buffer_load_dwordx2 v[238:239], v251, s[16:19], 0 offen offset:3584 sc1
buffer_load_dwordx4 v[88:91], v243, s[16:19], s20 offen offset:0 sc1
buffer_load_dwordx4 v[92:95], v243, s[16:19], s20 offen offset:1024 sc1
buffer_load_dwordx4 v[96:99], v243, s[16:19], s20 offen offset:2048 sc1
buffer_load_dwordx4 v[100:103], v243, s[16:19], s20 offen offset:3072 sc1
buffer_load_dwordx4 v[104:107], v243, s[16:19], s21 offen offset:0 sc1
buffer_load_dwordx4 v[108:111], v243, s[16:19], s21 offen offset:1024 sc1
buffer_load_dwordx2 v[112:113], v251, s[16:19], s21 offen offset:2048 sc1
buffer_load_dwordx2 v[114:115], v251, s[16:19], s21 offen offset:2560 sc1
buffer_load_dwordx4 v[116:119], v243, s[16:19], s21 offen offset:3072 sc1
buffer_load_dwordx4 v[120:123], v243, s[16:19], s47 offen offset:0 sc1
buffer_load_dwordx4 v[124:127], v243, s[16:19], s47 offen offset:1024 sc1
buffer_load_dwordx4 v[128:131], v240, s[16:19], 0 offen offset:0 sc1
buffer_load_dwordx4 v[132:135], v240, s[16:19], 0 offen offset:1024 sc1
buffer_load_dwordx4 v[136:139], v240, s[16:19], 0 offen offset:2048 sc1
buffer_load_dwordx2 v[140:141], v248, s[16:19], 0 offen offset:3072 sc1
buffer_load_dwordx2 v[142:143], v248, s[16:19], 0 offen offset:3584 sc1
buffer_load_dwordx4 v[144:147], v240, s[16:19], s20 offen offset:0 sc1
buffer_load_dwordx4 v[148:151], v240, s[16:19], s20 offen offset:1024 sc1
buffer_load_dwordx4 v[176:179], v240, s[16:19], s20 offen offset:2048 sc1
buffer_load_dwordx4 v[180:183], v240, s[16:19], s20 offen offset:3072 sc1
wu_79:
s_cbranch_execz wu_ret2
buffer_load_dwordx4 v[184:187], v240, s[16:19], s21 offen offset:0 sc1
buffer_load_dwordx4 v[188:191], v240, s[16:19], s21 offen offset:1024 sc1
buffer_load_dwordx2 v[192:193], v248, s[16:19], s21 offen offset:2048 sc1
buffer_load_dwordx2 v[194:195], v248, s[16:19], s21 offen offset:2560 sc1
buffer_load_dwordx4 v[196:199], v240, s[16:19], s21 offen offset:3072 sc1
buffer_load_dwordx4 v[200:203], v240, s[16:19], s47 offen offset:0 sc1
buffer_load_dwordx4 v[204:207], v240, s[16:19], s47 offen offset:1024 sc1
s_add_u32 s53, s53, 1
s_waitcnt vmcnt(0)
v_max3_u32 v252, v216, v217, v218
v_max3_u32 v252, v252, v219, v220
v_max3_u32 v252, v252, v221, v222
v_max_u32 v252, v252, v223
v_cmp_eq_u32 vcc, -1, v252
s_cmp_ge_u32 s53, 4000000
s_cbranch_scc1 rt_102_x
s_cbranch_vccnz rt_102
rt_102_x:
s_branch ex_55_b
ex_56:
rt_103:
buffer_load_dwordx4 v[224:227], v243, s[16:19], 0 offen offset:0 sc1
buffer_load_dwordx4 v[228:231], v243, s[16:19], 0 offen offset:1024 sc1
buffer_load_dwordx4 v[232:235], v243, s[16:19], 0 offen offset:2048 sc1
buffer_load_dwordx2 v[236:237], v251, s[16:19], 0 offen offset:3072 sc1
buffer_load_dwordx2 v[238:239], v251, s[16:19], 0 offen offset:3584 sc1
buffer_load_dwordx4 v[88:91], v243, s[16:19], s20 offen offset:0 sc1
buffer_load_dwordx4 v[92:95], v243, s[16:19], s20 offen offset:1024 sc1
buffer_load_dwordx4 v[96:99], v243, s[16:19], s20 offen offset:2048 sc1
buffer_load_dwordx4 v[100:103], v243, s[16:19], s20 offen offset:3072 sc1
buffer_load_dwordx4 v[104:107], v243, s[16:19], s21 offen offset:0 sc1
buffer_load_dwordx4 v[108:111], v243, s[16:19], s21 offen offset:1024 sc1
buffer_load_dwordx2 v[112:113], v251, s[16:19], s21 offen offset:2048 sc1
buffer_load_dwordx2 v[114:115], v251, s[16:19], s21 offen offset:2560 sc1
buffer_load_dwordx4 v[116:119], v243, s[16:19], s21 offen offset:3072 sc1
buffer_load_dwordx4 v[120:123], v243, s[16:19], s47 offen offset:0 sc1
buffer_load_dwordx4 v[124:127], v243, s[16:19], s47 offen offset:1024 sc1
buffer_load_dwordx4 v[128:131], v240, s[16:19], 0 offen offset:0 sc1
buffer_load_dwordx4 v[132:135], v240, s[16:19], 0 offen offset:1024 sc1
buffer_load_dwordx4 v[136:139], v240, s[16:19], 0 offen offset:2048 sc1
buffer_load_dwordx2 v[140:141], v248, s[16:19], 0 offen offset:3072 sc1
buffer_load_dwordx2 v[142:143], v248, s[16:19], 0 offen offset:3584 sc1
buffer_load_dwordx4 v[144:147], v240, s[16:19], s20 offen offset:0 sc1
buffer_load_dwordx4 v[148:151], v240, s[16:19], s20 offen offset:1024 sc1
buffer_load_dwordx4 v[176:179], v240, s[16:19], s20 offen offset:2048 sc1
buffer_load_dwordx4 v[180:183], v240, s[16:19], s20 offen offset:3072 sc1
buffer_load_dwordx4 v[184:187], v240, s[16:19], s21 offen offset:0 sc1
buffer_load_dwordx4 v[188:191], v240, s[16:19], s21 offen offset:1024 sc1
buffer_load_dwordx2 v[192:193], v248, s[16:19], s21 offen offset:2048 sc1
buffer_load_dwordx2 v[194:195], v248, s[16:19], s21 offen offset:2560 sc1
buffer_load_dwordx4 v[196:199], v240, s[16:19], s21 offen offset:3072 sc1
buffer_load_dwordx4 v[200:203], v240, s[16:19], s47 offen offset:0 sc1
buffer_load_dwordx4 v[204:207], v240, s[16:19], s47 offen offset:1024 sc1
s_add_u32 s53, s53, 1
s_waitcnt vmcnt(0)
v_max3_u32 v252, v224, v225, v226
v_max3_u32 v252, v252, v227, v228
v_max3_u32 v252, v252, v229, v230
v_max_u32 v252, v252, v231
v_cmp_eq_u32 vcc, -1, v252
s_cmp_ge_u32 s53, 4000000
s_cbranch_scc1 rt_103_x
s_cbranch_vccnz rt_103
rt_103_x:
s_branch ex_56_b
ex_57:
rt_104:
buffer_load_dwordx4 v[232:235], v243, s[16:19], 0 offen offset:2048 sc1
buffer_load_dwordx2 v[236:237], v251, s[16:19], 0 offen offset:3072 sc1
buffer_load_dwordx2 v[238:239], v251, s[16:19], 0 offen offset:3584 sc1
buffer_load_dwordx4 v[88:91], v243, s[16:19], s20 offen offset:0 sc1
buffer_load_dwordx4 v[92:95], v243, s[16:19], s20 offen offset:1024 sc1
buffer_load_dwordx4 v[96:99], v243, s[16:19], s20 offen offset:2048 sc1
buffer_load_dwordx4 v[100:103], v243, s[16:19], s20 offen offset:3072 sc1
buffer_load_dwordx4 v[104:107], v243, s[16:19], s21 offen offset:0 sc1
buffer_load_dwordx4 v[108:111], v243, s[16:19], s21 offen offset:1024 sc1
wu_80:
s_cbranch_execz wu_ret2
buffer_load_dwordx2 v[112:113], v251, s[16:19], s21 offen offset:2048 sc1
buffer_load_dwordx2 v[114:115], v251, s[16:19], s21 offen offset:2560 sc1
buffer_load_dwordx4 v[116:119], v243, s[16:19], s21 offen offset:3072 sc1
buffer_load_dwordx4 v[120:123], v243, s[16:19], s47 offen offset:0 sc1
buffer_load_dwordx4 v[124:127], v243, s[16:19], s47 offen offset:1024 sc1
buffer_load_dwordx4 v[128:131], v240, s[16:19], 0 offen offset:0 sc1
buffer_load_dwordx4 v[132:135], v240, s[16:19], 0 offen offset:1024 sc1
buffer_load_dwordx4 v[136:139], v240, s[16:19], 0 offen offset:2048 sc1
buffer_load_dwordx2 v[140:141], v248, s[16:19], 0 offen offset:3072 sc1
buffer_load_dwordx2 v[142:143], v248, s[16:19], 0 offen offset:3584 sc1
buffer_load_dwordx4 v[144:147], v240, s[16:19], s20 offen offset:0 sc1
buffer_load_dwordx4 v[148:151], v240, s[16:19], s20 offen offset:1024 sc1
buffer_load_dwordx4 v[176:179], v240, s[16:19], s20 offen offset:2048 sc1
buffer_load_dwordx4 v[180:183], v240, s[16:19], s20 offen offset:3072 sc1
buffer_load_dwordx4 v[184:187], v240, s[16:19], s21 offen offset:0 sc1
buffer_load_dwordx4 v[188:191], v240, s[16:19], s21 offen offset:1024 sc1
buffer_load_dwordx2 v[192:193], v248, s[16:19], s21 offen offset:2048 sc1
buffer_load_dwordx2 v[194:195], v248, s[16:19], s21 offen offset:2560 sc1
buffer_load_dwordx4 v[196:199], v240, s[16:19], s21 offen offset:3072 sc1
buffer_load_dwordx4 v[200:203], v240, s[16:19], s47 offen offset:0 sc1
buffer_load_dwordx4 v[204:207], v240, s[16:19], s47 offen offset:1024 sc1
s_add_u32 s53, s53, 1
s_waitcnt vmcnt(0)
v_max3_u32 v252, v232, v233, v234
v_max3_u32 v252, v252, v235, v236
v_max3_u32 v252, v252, v237, v238
v_max_u32 v252, v252, v239
v_cmp_eq_u32 vcc, -1, v252
s_cmp_ge_u32 s53, 4000000
s_cbranch_scc1 rt_104_x
s_cbranch_vccnz rt_104
rt_104_x:
s_branch ex_57_b
ex_58:
rt_105:
buffer_load_dwordx4 v[88:91], v243, s[16:19], s20 offen offset:0 sc1
buffer_load_dwordx4 v[92:95], v243, s[16:19], s20 offen offset:1024 sc1
buffer_load_dwordx4 v[96:99], v243, s[16:19], s20 offen offset:2048 sc1
buffer_load_dwordx4 v[100:103], v243, s[16:19], s20 offen offset:3072 sc1
buffer_load_dwordx4 v[104:107], v243, s[16:19], s21 offen offset:0 sc1
buffer_load_dwordx4 v[108:111], v243, s[16:19], s21 offen offset:1024 sc1
buffer_load_dwordx2 v[112:113], v251, s[16:19], s21 offen offset:2048 sc1
buffer_load_dwordx2 v[114:115], v251, s[16:19], s21 offen offset:2560 sc1
buffer_load_dwordx4 v[116:119], v243, s[16:19], s21 offen offset:3072 sc1
buffer_load_dwordx4 v[120:123], v243, s[16:19], s47 offen offset:0 sc1
buffer_load_dwordx4 v[124:127], v243, s[16:19], s47 offen offset:1024 sc1
buffer_load_dwordx4 v[128:131], v240, s[16:19], 0 offen offset:0 sc1
buffer_load_dwordx4 v[132:135], v240, s[16:19], 0 offen offset:1024 sc1
buffer_load_dwordx4 v[136:139], v240, s[16:19], 0 offen offset:2048 sc1
buffer_load_dwordx2 v[140:141], v248, s[16:19], 0 offen offset:3072 sc1
buffer_load_dwordx2 v[142:143], v248, s[16:19], 0 offen offset:3584 sc1
buffer_load_dwordx4 v[144:147], v240, s[16:19], s20 offen offset:0 sc1
buffer_load_dwordx4 v[148:151], v240, s[16:19], s20 offen offset:1024 sc1
buffer_load_dwordx4 v[176:179], v240, s[16:19], s20 offen offset:2048 sc1
buffer_load_dwordx4 v[180:183], v240, s[16:19], s20 offen offset:3072 sc1
buffer_load_dwordx4 v[184:187], v240, s[16:19], s21 offen offset:0 sc1
buffer_load_dwordx4 v[188:191], v240, s[16:19], s21 offen offset:1024 sc1
buffer_load_dwordx2 v[192:193], v248, s[16:19], s21 offen offset:2048 sc1
buffer_load_dwordx2 v[194:195], v248, s[16:19], s21 offen offset:2560 sc1
buffer_load_dwordx4 v[196:199], v240, s[16:19], s21 offen offset:3072 sc1
buffer_load_dwordx4 v[200:203], v240, s[16:19], s47 offen offset:0 sc1
buffer_load_dwordx4 v[204:207], v240, s[16:19], s47 offen offset:1024 sc1
s_add_u32 s53, s53, 1
s_waitcnt vmcnt(0)
v_max3_u32 v252, v88, v89, v90
v_max3_u32 v252, v252, v91, v92
v_max3_u32 v252, v252, v93, v94
v_max_u32 v252, v252, v95
v_cmp_eq_u32 vcc, -1, v252
s_cmp_ge_u32 s53, 4000000
s_cbranch_scc1 rt_105_x
s_cbranch_vccnz rt_105
rt_105_x:
s_branch ex_58_b
ex_59:
rt_106:
buffer_load_dwordx4 v[96:99], v243, s[16:19], s20 offen offset:2048 sc1
wu_81:
s_cbranch_execz wu_ret2
buffer_load_dwordx4 v[100:103], v243, s[16:19], s20 offen offset:3072 sc1
buffer_load_dwordx4 v[104:107], v243, s[16:19], s21 offen offset:0 sc1
buffer_load_dwordx4 v[108:111], v243, s[16:19], s21 offen offset:1024 sc1
buffer_load_dwordx2 v[112:113], v251, s[16:19], s21 offen offset:2048 sc1
buffer_load_dwordx2 v[114:115], v251, s[16:19], s21 offen offset:2560 sc1
buffer_load_dwordx4 v[116:119], v243, s[16:19], s21 offen offset:3072 sc1
buffer_load_dwordx4 v[120:123], v243, s[16:19], s47 offen offset:0 sc1
buffer_load_dwordx4 v[124:127], v243, s[16:19], s47 offen offset:1024 sc1
buffer_load_dwordx4 v[128:131], v240, s[16:19], 0 offen offset:0 sc1
buffer_load_dwordx4 v[132:135], v240, s[16:19], 0 offen offset:1024 sc1
buffer_load_dwordx4 v[136:139], v240, s[16:19], 0 offen offset:2048 sc1
buffer_load_dwordx2 v[140:141], v248, s[16:19], 0 offen offset:3072 sc1
buffer_load_dwordx2 v[142:143], v248, s[16:19], 0 offen offset:3584 sc1
buffer_load_dwordx4 v[144:147], v240, s[16:19], s20 offen offset:0 sc1
buffer_load_dwordx4 v[148:151], v240, s[16:19], s20 offen offset:1024 sc1
buffer_load_dwordx4 v[176:179], v240, s[16:19], s20 offen offset:2048 sc1
buffer_load_dwordx4 v[180:183], v240, s[16:19], s20 offen offset:3072 sc1
buffer_load_dwordx4 v[184:187], v240, s[16:19], s21 offen offset:0 sc1
buffer_load_dwordx4 v[188:191], v240, s[16:19], s21 offen offset:1024 sc1
buffer_load_dwordx2 v[192:193], v248, s[16:19], s21 offen offset:2048 sc1
buffer_load_dwordx2 v[194:195], v248, s[16:19], s21 offen offset:2560 sc1
buffer_load_dwordx4 v[196:199], v240, s[16:19], s21 offen offset:3072 sc1
buffer_load_dwordx4 v[200:203], v240, s[16:19], s47 offen offset:0 sc1
buffer_load_dwordx4 v[204:207], v240, s[16:19], s47 offen offset:1024 sc1
s_add_u32 s53, s53, 1
s_waitcnt vmcnt(0)
v_max3_u32 v252, v96, v97, v98
v_max3_u32 v252, v252, v99, v100
v_max3_u32 v252, v252, v101, v102
v_max_u32 v252, v252, v103
v_cmp_eq_u32 vcc, -1, v252
s_cmp_ge_u32 s53, 4000000
s_cbranch_scc1 rt_106_x
s_cbranch_vccnz rt_106
rt_106_x:
s_branch ex_59_b
ex_60:
rt_107:
buffer_load_dwordx4 v[104:107], v243, s[16:19], s21 offen offset:0 sc1
buffer_load_dwordx4 v[108:111], v243, s[16:19], s21 offen offset:1024 sc1
buffer_load_dwordx2 v[112:113], v251, s[16:19], s21 offen offset:2048 sc1
buffer_load_dwordx2 v[114:115], v251, s[16:19], s21 offen offset:2560 sc1
buffer_load_dwordx4 v[116:119], v243, s[16:19], s21 offen offset:3072 sc1
buffer_load_dwordx4 v[120:123], v243, s[16:19], s47 offen offset:0 sc1
buffer_load_dwordx4 v[124:127], v243, s[16:19], s47 offen offset:1024 sc1
buffer_load_dwordx4 v[128:131], v240, s[16:19], 0 offen offset:0 sc1
buffer_load_dwordx4 v[132:135], v240, s[16:19], 0 offen offset:1024 sc1
buffer_load_dwordx4 v[136:139], v240, s[16:19], 0 offen offset:2048 sc1
buffer_load_dwordx2 v[140:141], v248, s[16:19], 0 offen offset:3072 sc1
buffer_load_dwordx2 v[142:143], v248, s[16:19], 0 offen offset:3584 sc1
buffer_load_dwordx4 v[144:147], v240, s[16:19], s20 offen offset:0 sc1
buffer_load_dwordx4 v[148:151], v240, s[16:19], s20 offen offset:1024 sc1
buffer_load_dwordx4 v[176:179], v240, s[16:19], s20 offen offset:2048 sc1
buffer_load_dwordx4 v[180:183], v240, s[16:19], s20 offen offset:3072 sc1
buffer_load_dwordx4 v[184:187], v240, s[16:19], s21 offen offset:0 sc1
buffer_load_dwordx4 v[188:191], v240, s[16:19], s21 offen offset:1024 sc1
buffer_load_dwordx2 v[192:193], v248, s[16:19], s21 offen offset:2048 sc1
buffer_load_dwordx2 v[194:195], v248, s[16:19], s21 offen offset:2560 sc1
buffer_load_dwordx4 v[196:199], v240, s[16:19], s21 offen offset:3072 sc1
buffer_load_dwordx4 v[200:203], v240, s[16:19], s47 offen offset:0 sc1
buffer_load_dwordx4 v[204:207], v240, s[16:19], s47 offen offset:1024 sc1
s_add_u32 s53, s53, 1
s_waitcnt vmcnt(0)
v_max3_u32 v252, v104, v105, v106
v_max3_u32 v252, v252, v107, v108
v_max3_u32 v252, v252, v109, v110
v_max_u32 v252, v252, v111
v_cmp_eq_u32 vcc, -1, v252
s_cmp_ge_u32 s53, 4000000
s_cbranch_scc1 rt_107_x
s_cbranch_vccnz rt_107
rt_107_x:
s_branch ex_60_b
ex_61:
rt_108:
buffer_load_dwordx2 v[112:113], v251, s[16:19], s21 offen offset:2048 sc1
wu_82:
s_cbranch_execz wu_ret2
buffer_load_dwordx2 v[114:115], v251, s[16:19], s21 offen offset:2560 sc1
buffer_load_dwordx4 v[116:119], v243, s[16:19], s21 offen offset:3072 sc1
buffer_load_dwordx4 v[120:123], v243, s[16:19], s47 offen offset:0 sc1
buffer_load_dwordx4 v[124:127], v243, s[16:19], s47 offen offset:1024 sc1
buffer_load_dwordx4 v[128:131], v240, s[16:19], 0 offen offset:0 sc1
buffer_load_dwordx4 v[132:135], v240, s[16:19], 0 offen offset:1024 sc1
buffer_load_dwordx4 v[136:139], v240, s[16:19], 0 offen offset:2048 sc1
buffer_load_dwordx2 v[140:141], v248, s[16:19], 0 offen offset:3072 sc1
buffer_load_dwordx2 v[142:143], v248, s[16:19], 0 offen offset:3584 sc1
buffer_load_dwordx4 v[144:147], v240, s[16:19], s20 offen offset:0 sc1
buffer_load_dwordx4 v[148:151], v240, s[16:19], s20 offen offset:1024 sc1
buffer_load_dwordx4 v[176:179], v240, s[16:19], s20 offen offset:2048 sc1
buffer_load_dwordx4 v[180:183], v240, s[16:19], s20 offen offset:3072 sc1
buffer_load_dwordx4 v[184:187], v240, s[16:19], s21 offen offset:0 sc1
buffer_load_dwordx4 v[188:191], v240, s[16:19], s21 offen offset:1024 sc1
buffer_load_dwordx2 v[192:193], v248, s[16:19], s21 offen offset:2048 sc1
buffer_load_dwordx2 v[194:195], v248, s[16:19], s21 offen offset:2560 sc1
buffer_load_dwordx4 v[196:199], v240, s[16:19], s21 offen offset:3072 sc1
buffer_load_dwordx4 v[200:203], v240, s[16:19], s47 offen offset:0 sc1
buffer_load_dwordx4 v[204:207], v240, s[16:19], s47 offen offset:1024 sc1
s_add_u32 s53, s53, 1
s_waitcnt vmcnt(0)
v_max3_u32 v252, v112, v113, v114
v_max3_u32 v252, v252, v115, v116
v_max3_u32 v252, v252, v117, v118
v_max_u32 v252, v252, v119
v_cmp_eq_u32 vcc, -1, v252
s_cmp_ge_u32 s53, 4000000
s_cbranch_scc1 rt_108_x
s_cbranch_vccnz rt_108
rt_108_x:
s_branch ex_61_b
ex_62:
rt_109:
buffer_load_dwordx4 v[120:123], v243, s[16:19], s47 offen offset:0 sc1
buffer_load_dwordx4 v[124:127], v243, s[16:19], s47 offen offset:1024 sc1
buffer_load_dwordx4 v[128:131], v240, s[16:19], 0 offen offset:0 sc1
buffer_load_dwordx4 v[132:135], v240, s[16:19], 0 offen offset:1024 sc1
buffer_load_dwordx4 v[136:139], v240, s[16:19], 0 offen offset:2048 sc1
buffer_load_dwordx2 v[140:141], v248, s[16:19], 0 offen offset:3072 sc1
buffer_load_dwordx2 v[142:143], v248, s[16:19], 0 offen offset:3584 sc1
buffer_load_dwordx4 v[144:147], v240, s[16:19], s20 offen offset:0 sc1
buffer_load_dwordx4 v[148:151], v240, s[16:19], s20 offen offset:1024 sc1
buffer_load_dwordx4 v[176:179], v240, s[16:19], s20 offen offset:2048 sc1
buffer_load_dwordx4 v[180:183], v240, s[16:19], s20 offen offset:3072 sc1
buffer_load_dwordx4 v[184:187], v240, s[16:19], s21 offen offset:0 sc1
buffer_load_dwordx4 v[188:191], v240, s[16:19], s21 offen offset:1024 sc1
buffer_load_dwordx2 v[192:193], v248, s[16:19], s21 offen offset:2048 sc1
buffer_load_dwordx2 v[194:195], v248, s[16:19], s21 offen offset:2560 sc1
buffer_load_dwordx4 v[196:199], v240, s[16:19], s21 offen offset:3072 sc1
buffer_load_dwordx4 v[200:203], v240, s[16:19], s47 offen offset:0 sc1
buffer_load_dwordx4 v[204:207], v240, s[16:19], s47 offen offset:1024 sc1
s_add_u32 s53, s53, 1
s_waitcnt vmcnt(0)
v_max3_u32 v252, v120, v121, v122
v_max3_u32 v252, v252, v123, v124
v_max3_u32 v252, v252, v125, v126
v_max_u32 v252, v252, v127
v_cmp_eq_u32 vcc, -1, v252
s_cmp_ge_u32 s53, 4000000
s_cbranch_scc1 rt_109_x
s_cbranch_vccnz rt_109
rt_109_x:
s_branch ex_62_b
ex_63:
rt_110:
buffer_load_dwordx4 v[128:131], v240, s[16:19], 0 offen offset:0 sc1
buffer_load_dwordx4 v[132:135], v240, s[16:19], 0 offen offset:1024 sc1
buffer_load_dwordx4 v[136:139], v240, s[16:19], 0 offen offset:2048 sc1
buffer_load_dwordx2 v[140:141], v248, s[16:19], 0 offen offset:3072 sc1
buffer_load_dwordx2 v[142:143], v248, s[16:19], 0 offen offset:3584 sc1
buffer_load_dwordx4 v[144:147], v240, s[16:19], s20 offen offset:0 sc1
buffer_load_dwordx4 v[148:151], v240, s[16:19], s20 offen offset:1024 sc1
buffer_load_dwordx4 v[176:179], v240, s[16:19], s20 offen offset:2048 sc1
buffer_load_dwordx4 v[180:183], v240, s[16:19], s20 offen offset:3072 sc1
buffer_load_dwordx4 v[184:187], v240, s[16:19], s21 offen offset:0 sc1
buffer_load_dwordx4 v[188:191], v240, s[16:19], s21 offen offset:1024 sc1
wu_83:
s_cbranch_execz wu_ret2
buffer_load_dwordx2 v[192:193], v248, s[16:19], s21 offen offset:2048 sc1
buffer_load_dwordx2 v[194:195], v248, s[16:19], s21 offen offset:2560 sc1
buffer_load_dwordx4 v[196:199], v240, s[16:19], s21 offen offset:3072 sc1
buffer_load_dwordx4 v[200:203], v240, s[16:19], s47 offen offset:0 sc1
buffer_load_dwordx4 v[204:207], v240, s[16:19], s47 offen offset:1024 sc1
s_add_u32 s53, s53, 1
s_waitcnt vmcnt(0)
v_max3_u32 v252, v128, v129, v130
v_max3_u32 v252, v252, v131, v132
v_max3_u32 v252, v252, v133, v134
v_max_u32 v252, v252, v135
v_cmp_eq_u32 vcc, -1, v252
s_cmp_ge_u32 s53, 4000000
s_cbranch_scc1 rt_110_x
s_cbranch_vccnz rt_110
rt_110_x:
s_branch ex_63_b
ex_64:
rt_111:
buffer_load_dwordx4 v[136:139], v240, s[16:19], 0 offen offset:2048 sc1
buffer_load_dwordx2 v[140:141], v248, s[16:19], 0 offen offset:3072 sc1
buffer_load_dwordx2 v[142:143], v248, s[16:19], 0 offen offset:3584 sc1
buffer_load_dwordx4 v[144:147], v240, s[16:19], s20 offen offset:0 sc1
buffer_load_dwordx4 v[148:151], v240, s[16:19], s20 offen offset:1024 sc1
buffer_load_dwordx4 v[176:179], v240, s[16:19], s20 offen offset:2048 sc1
buffer_load_dwordx4 v[180:183], v240, s[16:19], s20 offen offset:3072 sc1
buffer_load_dwordx4 v[184:187], v240, s[16:19], s21 offen offset:0 sc1
buffer_load_dwordx4 v[188:191], v240, s[16:19], s21 offen offset:1024 sc1
buffer_load_dwordx2 v[192:193], v248, s[16:19], s21 offen offset:2048 sc1
buffer_load_dwordx2 v[194:195], v248, s[16:19], s21 offen offset:2560 sc1
buffer_load_dwordx4 v[196:199], v240, s[16:19], s21 offen offset:3072 sc1
buffer_load_dwordx4 v[200:203], v240, s[16:19], s47 offen offset:0 sc1
buffer_load_dwordx4 v[204:207], v240, s[16:19], s47 offen offset:1024 sc1
s_add_u32 s53, s53, 1
s_waitcnt vmcnt(0)
v_max3_u32 v252, v136, v137, v138
v_max3_u32 v252, v252, v139, v140
v_max3_u32 v252, v252, v141, v142
v_max_u32 v252, v252, v143
v_cmp_eq_u32 vcc, -1, v252
s_cmp_ge_u32 s53, 4000000
s_cbranch_scc1 rt_111_x
s_cbranch_vccnz rt_111
rt_111_x:
s_branch ex_64_b
ex_65:
rt_112:
buffer_load_dwordx4 v[144:147], v240, s[16:19], s20 offen offset:0 sc1
buffer_load_dwordx4 v[148:151], v240, s[16:19], s20 offen offset:1024 sc1
buffer_load_dwordx4 v[176:179], v240, s[16:19], s20 offen offset:2048 sc1
buffer_load_dwordx4 v[180:183], v240, s[16:19], s20 offen offset:3072 sc1
buffer_load_dwordx4 v[184:187], v240, s[16:19], s21 offen offset:0 sc1
buffer_load_dwordx4 v[188:191], v240, s[16:19], s21 offen offset:1024 sc1
buffer_load_dwordx2 v[192:193], v248, s[16:19], s21 offen offset:2048 sc1
buffer_load_dwordx2 v[194:195], v248, s[16:19], s21 offen offset:2560 sc1
buffer_load_dwordx4 v[196:199], v240, s[16:19], s21 offen offset:3072 sc1
buffer_load_dwordx4 v[200:203], v240, s[16:19], s47 offen offset:0 sc1
buffer_load_dwordx4 v[204:207], v240, s[16:19], s47 offen offset:1024 sc1
s_add_u32 s53, s53, 1
s_waitcnt vmcnt(0)
v_max3_u32 v252, v144, v145, v146
v_max3_u32 v252, v252, v147, v148
v_max3_u32 v252, v252, v149, v150
v_max_u32 v252, v252, v151
v_cmp_eq_u32 vcc, -1, v252
s_cmp_ge_u32 s53, 4000000
s_cbranch_scc1 rt_112_x
s_cbranch_vccnz rt_112
rt_112_x:
s_branch ex_65_b
ex_66:
rt_113:
buffer_load_dwordx4 v[176:179], v240, s[16:19], s20 offen offset:2048 sc1
buffer_load_dwordx4 v[180:183], v240, s[16:19], s20 offen offset:3072 sc1
buffer_load_dwordx4 v[184:187], v240, s[16:19], s21 offen offset:0 sc1
buffer_load_dwordx4 v[188:191], v240, s[16:19], s21 offen offset:1024 sc1
buffer_load_dwordx2 v[192:193], v248, s[16:19], s21 offen offset:2048 sc1
buffer_load_dwordx2 v[194:195], v248, s[16:19], s21 offen offset:2560 sc1
buffer_load_dwordx4 v[196:199], v240, s[16:19], s21 offen offset:3072 sc1
buffer_load_dwordx4 v[200:203], v240, s[16:19], s47 offen offset:0 sc1
buffer_load_dwordx4 v[204:207], v240, s[16:19], s47 offen offset:1024 sc1
s_add_u32 s53, s53, 1
s_waitcnt vmcnt(0)
v_max3_u32 v252, v176, v177, v178
wu_84:
s_cbranch_execz wu_ret2
v_max3_u32 v252, v252, v179, v180
v_max3_u32 v252, v252, v181, v182
v_max_u32 v252, v252, v183
v_cmp_eq_u32 vcc, -1, v252
s_cmp_ge_u32 s53, 4000000
s_cbranch_scc1 rt_113_x
s_cbranch_vccnz rt_113
rt_113_x:
s_branch ex_66_b
ex_67:
rt_114:
buffer_load_dwordx4 v[184:187], v240, s[16:19], s21 offen offset:0 sc1
buffer_load_dwordx4 v[188:191], v240, s[16:19], s21 offen offset:1024 sc1
buffer_load_dwordx2 v[192:193], v248, s[16:19], s21 offen offset:2048 sc1
buffer_load_dwordx2 v[194:195], v248, s[16:19], s21 offen offset:2560 sc1
buffer_load_dwordx4 v[196:199], v240, s[16:19], s21 offen offset:3072 sc1
buffer_load_dwordx4 v[200:203], v240, s[16:19], s47 offen offset:0 sc1
buffer_load_dwordx4 v[204:207], v240, s[16:19], s47 offen offset:1024 sc1
s_add_u32 s53, s53, 1
s_waitcnt vmcnt(0)
v_max3_u32 v252, v184, v185, v186
v_max3_u32 v252, v252, v187, v188
v_max3_u32 v252, v252, v189, v190
v_max_u32 v252, v252, v191
v_cmp_eq_u32 vcc, -1, v252
s_cmp_ge_u32 s53, 4000000
s_cbranch_scc1 rt_114_x
s_cbranch_vccnz rt_114
rt_114_x:
s_branch ex_67_b
ex_68:
rt_115:
buffer_load_dwordx2 v[192:193], v248, s[16:19], s21 offen offset:2048 sc1
buffer_load_dwordx2 v[194:195], v248, s[16:19], s21 offen offset:2560 sc1
buffer_load_dwordx4 v[196:199], v240, s[16:19], s21 offen offset:3072 sc1
buffer_load_dwordx4 v[200:203], v240, s[16:19], s47 offen offset:0 sc1
buffer_load_dwordx4 v[204:207], v240, s[16:19], s47 offen offset:1024 sc1
s_add_u32 s53, s53, 1
s_waitcnt vmcnt(0)
v_max3_u32 v252, v192, v193, v194
v_max3_u32 v252, v252, v195, v196
v_max3_u32 v252, v252, v197, v198
v_max_u32 v252, v252, v199
v_cmp_eq_u32 vcc, -1, v252
s_cmp_ge_u32 s53, 4000000
s_cbranch_scc1 rt_115_x
s_cbranch_vccnz rt_115
rt_115_x:
s_branch ex_68_b
ex_69:
rt_116:
buffer_load_dwordx4 v[200:203], v240, s[16:19], s47 offen offset:0 sc1
buffer_load_dwordx4 v[204:207], v240, s[16:19], s47 offen offset:1024 sc1
s_add_u32 s53, s53, 1
s_waitcnt vmcnt(0)
v_max3_u32 v252, v200, v201, v202
v_max3_u32 v252, v252, v203, v204
v_max3_u32 v252, v252, v205, v206
v_max_u32 v252, v252, v207
v_cmp_eq_u32 vcc, -1, v252
s_cmp_ge_u32 s53, 4000000
s_cbranch_scc1 rt_116_x
s_cbranch_vccnz rt_116
rt_116_x:
s_branch ex_69_b
code_end:
.section .rodata,"a"
.p2align 6
.amdhsa_kernel adaLN_cond__spectral_gfnet__glu_gated_swiglu__prompt_kernel
  .amdhsa_next_free_vgpr 512
  .amdhsa_next_free_sgpr 102
  .amdhsa_accum_offset 256
  .amdhsa_group_segment_fixed_size 0
  .amdhsa_kernarg_size 96
  .amdhsa_user_sgpr_count 2
  .amdhsa_user_sgpr_kernarg_segment_ptr 1
  .amdhsa_system_sgpr_workgroup_id_x 1
  .amdhsa_float_denorm_mode_32 3
  .amdhsa_float_denorm_mode_16_64 3
.end_amdhsa_kernel
.text
```
